```python
import torch

def _softmax(x, axis=-1):
    return torch.softmax(x, dim=axis)
def _gelu(x):
    return torch.nn.functional.gelu(x, approximate="tanh")
def _silu(x):
    return torch.nn.functional.silu(x)
def _sigmoid(x):
    return torch.sigmoid(x)
def _layernorm(x, axis=-1, eps=1e-5):
    m = x.mean(dim=axis, keepdim=True)
    v = x.var(dim=axis, keepdim=True, unbiased=False)
    return (x - m) / torch.sqrt(v + eps)
def _scatter_add(tgt, idx, src, axis=0):
    return tgt.clone().index_add_(axis, idx, src)
def _segment_sum(src, seg, n):
    out = torch.zeros((n,) + src.shape[1:], dtype=src.dtype)
    return out.index_add_(0, seg, src)
def _pad(x, pw):
    flat = tuple(v for pair in reversed(pw) for v in pair)
    return torch.nn.functional.pad(x, flat)

kernel_name = 'concat_heads__mha_block_cached__gqa_block_cached__decode'

def setup_inputs():

    _w = (lambda a: (lambda t: t.to(torch.bfloat16) if t.is_floating_point() else t)(torch.as_tensor(a)))
    def _A_setup():
        B, Sq, D = 4, 1, 640
        H, Sk, Dh = 32, 4096, 128
        return {
            "x": _w((lambda *s: torch.randn(*s, dtype=torch.bfloat16) * 0.8)(B, Sq, D)),
            "k_cache": _w((lambda *s: torch.randn(*s, dtype=torch.bfloat16) * 0.8)(B, H, Sk, Dh)),
            "v_cache": _w((lambda *s: torch.randn(*s, dtype=torch.bfloat16) * 0.05)(B, H, Sk, Dh)),
            "wq": _w((lambda *s: torch.randn(*s, dtype=torch.bfloat16) * 0.8)(D, H * Dh) * (D ** -0.5)),
            "wo": _w((lambda *s: torch.randn(*s, dtype=torch.bfloat16) * 0.05)(H * Dh, D) * ((H * Dh) ** -0.5)),
        }
    _A_in = _A_setup()

    def _B_setup():
        B, Sq, D = 4, 1, 640
        Hq, Hkv, Sk, Dh = 32, 32, 4096, 128
        assert Hq % Hkv == 0, (Hq, Hkv)
        return {
            "x": _w((lambda *s: torch.randn(*s, dtype=torch.bfloat16) * 0.8)(B, Sq, D)),
            "k_cache": _w((lambda *s: torch.randn(*s, dtype=torch.bfloat16) * 0.8)(B, Hkv, Sk, Dh)),
            "v_cache": _w((lambda *s: torch.randn(*s, dtype=torch.bfloat16) * 0.05)(B, Hkv, Sk, Dh)),
            "wq": _w((lambda *s: torch.randn(*s, dtype=torch.bfloat16) * 0.8)(D, Hq * Dh) * (D ** -0.5)),
            "wo": _w((lambda *s: torch.randn(*s, dtype=torch.bfloat16) * 0.05)(Hq * Dh, D) * ((Hq * Dh) ** -0.5)),
        }
    _B_in = _B_setup()

    return {
        "A_x": _A_in["x"],
        "A_k_cache": _A_in["k_cache"],
        "A_v_cache": _A_in["v_cache"],
        "A_wq": _A_in["wq"],
        "A_wo": _A_in["wo"],
        "B_x": _B_in["x"],
        "B_k_cache": _B_in["k_cache"],
        "B_v_cache": _B_in["v_cache"],
        "B_wq": _B_in["wq"],
        "B_wo": _B_in["wo"],
    }

def reference(A_x, A_k_cache, A_v_cache, A_wq, A_wo, B_x, B_k_cache, B_v_cache, B_wq, B_wo):
    def _A_ref(x, k_cache, v_cache, wq, wo):
        B, Sq, D = x.shape
        H, Dh = 32, 128
        q = (lambda x, *d: x.permute(*d))((x @ wq).reshape(B, Sq, H, Dh), 0, 2, 1, 3)
        scores = torch.einsum("bhqd,bhkd->bhqk", q, k_cache) * (Dh ** -0.5)
        p = _softmax(scores, axis=-1)
        o = torch.einsum("bhqk,bhkd->bhqd", p, v_cache)
        return (lambda x, *d: x.permute(*d))(o, 0, 2, 1, 3).reshape(B, Sq, H * Dh) @ wo

    def _B_ref(x, k_cache, v_cache, wq, wo):
        B, Sq, D = x.shape
        Hq, Dh = 32, 128
        Hkv = k_cache.shape[1]
        rep = Hq // Hkv
        q = (lambda x, *d: x.permute(*d))((x @ wq).reshape(B, Sq, Hq, Dh), 0, 2, 1, 3)
        k = (lambda x, n, axis: torch.repeat_interleave(x, n, dim=axis))(k_cache, rep, axis=1)
        v = (lambda x, n, axis: torch.repeat_interleave(x, n, dim=axis))(v_cache, rep, axis=1)
        scores = torch.einsum("bhqd,bhkd->bhqk", q, k) * (Dh ** -0.5)
        p = _softmax(scores, axis=-1)
        o = torch.einsum("bhqk,bhkd->bhqd", p, v)
        return (lambda x, *d: x.permute(*d))(o, 0, 2, 1, 3).reshape(B, Sq, Hq * Dh) @ wo

    a = _A_ref(A_x, A_k_cache, A_v_cache, A_wq, A_wo)
    b = _B_ref(B_x, B_k_cache, B_v_cache, B_wq, B_wo)
    return torch.concatenate([a, b], axis=-1)
```

```asm
; @launch grid=(256,1,1) block=(256,1,1) lds=16384
.amdgcn_target "amdgcn-amd-amdhsa--gfx950"
.text
.globl concat_heads__mha_block_cached__gqa_block_cached__decode_kernel
.p2align 8
.type concat_heads__mha_block_cached__gqa_block_cached__decode_kernel,@function
concat_heads__mha_block_cached__gqa_block_cached__decode_kernel:
    s_cmp_ge_u32 s2, 256
    s_cbranch_scc1 L_end
    s_load_dwordx16 s[4:19], s[0:1], 0
    s_load_dwordx8 s[20:27], s[0:1], 64
    s_load_dwordx2 s[28:29], s[0:1], 96
    v_lshrrev_b32 v8, 6, v0
    v_and_b32 v1, 63, v0
    v_readfirstlane_b32 s3, v8
    s_lshr_b32 s48, s2, 6
    s_and_b32 s49, s2, 31
    s_bfe_u32 s50, s2, 0x10005
    v_and_b32 v10, 15, v0
    v_lshrrev_b32 v8, 4, v1
    v_lshlrev_b32 v9, 4, v10
    v_lshl_add_u32 v2, v8, 13, v9
    s_lshr_b32 s71, s2, 5
    s_mul_i32 s59, s3, 1310720
    s_lshl_b32 s54, s49, 8
    s_add_u32 s59, s59, s54
    s_mul_i32 s54, s71, 163840
    s_add_u32 s59, s59, s54
    s_mov_b32 s38, 5242880
    s_mov_b32 s39, 0x20000
    s_mov_b32 s58, s59
    s_lshr_b32 s56, s2, 3
    s_add_u32 s56, s56, s2
    s_and_b32 s56, s56, 31
    v_lshlrev_b32 v62, 4, v1
    s_add_u32 s54, s56, 0
    s_bfe_u32 s55, s54, 0x10000
    v_lshl_add_u32 v128, s55, 11, v62
    s_bfe_u32 s55, s54, 0x10001
    v_lshl_add_u32 v128, s55, 12, v128
    s_bfe_u32 s55, s54, 0x10002
    v_lshl_add_u32 v128, s55, 10, v128
    s_lshr_b32 s54, s56, 3
    s_xor_b32 s54, s54, s3
    s_lshl_b32 s54, s54, 13
    s_lshl_b32 s53, s48, 6
    s_lshl_b32 s55, s49, 1
    s_add_u32 s53, s53, s55
    s_add_u32 s53, s53, s50
    s_mul_i32 s61, s53, 2560
    s_lshr_b32 s53, s53, 1
    s_lshl_b32 s53, s53, 20
    s_lshl_b32 s55, s50, 16
    s_add_u32 s53, s53, s55
    s_add_u32 s53, s53, s54
    s_mov_b32 s51, s53
    s_mov_b32 s34, 134217728
    s_mov_b32 s35, 0x20000
    s_waitcnt lgkmcnt(0)
    s_mov_b64 s[36:37], s[10:11]
    s_mov_b64 s[32:33], s[6:7]
    buffer_load_dwordx4 a[0:3], v2, s[36:39], s58 offen
    s_add_u32 s58, s58, 32768
    s_mov_b32 s72, 32768
    s_movk_i32 s73, 5120
    s_add_u32 s52, s53, 0x8000
    buffer_load_dwordx4 a[4:7], v2, s[36:39], s58 offen
    s_add_u32 s58, s58, 32768
    buffer_load_dwordx4 a[8:11], v2, s[36:39], s58 offen
    s_add_u32 s58, s58, 32768
    buffer_load_dwordx4 a[12:15], v2, s[36:39], s58 offen
    s_add_u32 s58, s58, 32768
    buffer_load_dwordx4 v[176:179], v128, s[32:35], s51 offen nt
    s_add_u32 s54, s56, 1
    s_bfe_u32 s55, s54, 0x10000
    v_lshl_add_u32 v129, s55, 11, v62
    s_bfe_u32 s55, s54, 0x10001
    v_lshl_add_u32 v129, s55, 12, v129
    s_bfe_u32 s55, s54, 0x10002
    v_lshl_add_u32 v129, s55, 10, v129
    buffer_load_dwordx4 a[16:19], v2, s[36:39], s58 offen
    s_cmp_eq_u32 s71, 7
    s_cselect_b32 s63, 0xffec8000, s72
    s_add_u32 s58, s58, s63
    v_mul_u32_u24 v3, 1280, v8
    v_add_u32 v3, v3, v9
    s_mul_i32 s54, s3, 320
    s_mul_i32 s55, s48, 1280
    s_add_u32 s54, s54, s55
    v_lshl_add_u32 v9, v8, 1, s54
    s_mul_i32 s54, s71, 5
    v_add_u32 v4, s54, v10
    s_add_u32 s54, s54, 16
    v_add_u32 v24, s54, v10
    s_add_u32 s54, s54, 16
    v_add_u32 v25, s54, v10
    v_subrev_u32 v44, 40, v4
    v_subrev_u32 v45, 40, v24
    v_subrev_u32 v46, 40, v25
    v_min_u32 v4, v4, v44
    v_min_u32 v24, v24, v45
    v_min_u32 v25, v25, v46
    v_lshl_add_u32 v4, v4, 3, v9
    v_lshl_add_u32 v24, v24, 3, v9
    v_lshl_add_u32 v25, v25, 3, v9
    s_mov_b64 s[44:45], s[4:5]
    s_mov_b32 s46, 5120
    s_mov_b32 s47, 0x20000
    buffer_load_ushort v56, v4, s[44:47], 0 offen
    buffer_load_ushort v57, v24, s[44:47], 0 offen
    buffer_load_ushort v58, v25, s[44:47], 0 offen
    buffer_load_dwordx4 a[20:23], v2, s[36:39], s58 offen
    s_add_u32 s58, s58, 32768
    buffer_load_dwordx4 v[180:183], v129, s[32:35], s51 offen nt
    s_add_u32 s54, s56, 2
    s_bfe_u32 s55, s54, 0x10000
    v_lshl_add_u32 v130, s55, 11, v62
    s_bfe_u32 s55, s54, 0x10001
    v_lshl_add_u32 v130, s55, 12, v130
    s_bfe_u32 s55, s54, 0x10002
    v_lshl_add_u32 v130, s55, 10, v130
    buffer_load_dwordx4 a[24:27], v2, s[36:39], s58 offen
    s_add_u32 s58, s58, 32768
    buffer_load_dwordx4 v[184:187], v130, s[32:35], s51 offen nt
    s_add_u32 s54, s56, 3
    s_bfe_u32 s55, s54, 0x10000
    v_lshl_add_u32 v131, s55, 11, v62
    s_bfe_u32 s55, s54, 0x10001
    v_lshl_add_u32 v131, s55, 12, v131
    s_bfe_u32 s55, s54, 0x10002
    v_lshl_add_u32 v131, s55, 10, v131
    buffer_load_dwordx4 a[28:31], v2, s[36:39], s58 offen
    s_add_u32 s58, s58, 32768
    buffer_load_dwordx4 v[188:191], v131, s[32:35], s51 offen nt
    s_add_u32 s54, s56, 4
    s_bfe_u32 s55, s54, 0x10000
    v_lshl_add_u32 v132, s55, 11, v62
    s_bfe_u32 s55, s54, 0x10001
    v_lshl_add_u32 v132, s55, 12, v132
    s_bfe_u32 s55, s54, 0x10002
    v_lshl_add_u32 v132, s55, 10, v132
    buffer_load_dwordx4 a[32:35], v2, s[36:39], s58 offen
    s_add_u32 s58, s58, 32768
    buffer_load_dwordx4 a[36:39], v2, s[36:39], s58 offen
    s_cmp_eq_u32 s71, 6
    s_cselect_b32 s63, 0xffec8000, s72
    s_add_u32 s58, s58, s63
    buffer_load_dwordx4 v[192:195], v132, s[32:35], s51 offen nt
    s_add_u32 s54, s56, 5
    s_bfe_u32 s55, s54, 0x10000
    v_lshl_add_u32 v133, s55, 11, v62
    s_bfe_u32 s55, s54, 0x10001
    v_lshl_add_u32 v133, s55, 12, v133
    s_bfe_u32 s55, s54, 0x10002
    v_lshl_add_u32 v133, s55, 10, v133
    buffer_load_dwordx4 a[40:43], v2, s[36:39], s58 offen
    s_add_u32 s58, s58, 32768
    s_mov_b64 s[40:41], s[28:29]
    s_mov_b32 s42, 1343488
    s_mov_b32 s43, 0x20000
    s_mov_b32 s64, 0x22222222
    s_mov_b32 s65, 0x22222222
    s_mov_b32 s66, 0x44444444
    s_mov_b32 s67, 0x44444444
    s_mov_b32 s68, 0x88888888
    s_mov_b32 s69, 0x88888888
    s_lshl_b32 s60, s49, 2
    s_add_u32 s60, s60, s3
    s_lshl_b32 s60, s60, 3
    s_add_u32 s60, s60, s71
    s_mul_i32 s60, s60, 5120
    v_mov_b32 v9, 0x7fffffff
    v_cmp_gt_u32 vcc, 160, v0
    v_lshlrev_b32 v5, 4, v0
    v_add_u32 v5, s61, v5
    v_cndmask_b32 v5, v9, v5, vcc
    s_lshl_b32 s54, s50, 2
    s_add_u32 s54, s54, s48
    s_lshl_b32 s54, s54, 2
    s_add_u32 s54, s54, s3
    s_mul_i32 s61, s54, 40960
    s_lshl_b32 s54, s49, 7
    s_add_u32 s61, s61, s54
    s_cmp_lt_u32 s49, 20
    s_cselect_b32 s61, s61, 0x40000000
    s_add_u32 s62, s61, 20480
    v_lshrrev_b32 v6, 3, v1
    v_mul_u32_u24 v6, 2560, v6
    v_and_b32 v8, 7, v1
    v_lshl_add_u32 v6, v8, 4, v6
    s_mul_i32 s54, s48, 2560
    s_mul_i32 s55, s50, 1280
    s_add_u32 s54, s54, s55
    s_lshl_b32 s55, s49, 6
    s_add_u32 s54, s54, s55
    s_lshl_b32 s55, s3, 4
    s_add_u32 s54, s54, s55
    v_lshrrev_b32 v7, 4, v1
    v_lshl_add_u32 v7, v7, 3, s54
    v_and_b32 v8, 1, v10
    v_lshlrev_b32 v8, 4, v8
    v_mov_b32 v9, 0xffff
    v_lshlrev_b32 v9, v8, v9
    v_lshrrev_b32 v8, 1, v10
    v_cmp_eq_u32 vcc, 0, v8
    s_nop 1
    v_cndmask_b32 v16, 0, v9, vcc
    v_cmp_eq_u32 vcc, 1, v8
    s_nop 1
    v_cndmask_b32 v17, 0, v9, vcc
    v_cmp_eq_u32 vcc, 2, v8
    s_nop 1
    v_cndmask_b32 v18, 0, v9, vcc
    v_cmp_eq_u32 vcc, 3, v8
    s_nop 1
    v_cndmask_b32 v19, 0, v9, vcc
    v_lshrrev_b32 v8, 4, v1
    v_lshlrev_b32 v11, 5, v10
    v_lshl_add_u32 v11, v8, 4, v11
    v_and_b32 v9, 3, v10
    v_lshlrev_b32 v13, 3, v9
    v_mul_u32_u24 v9, 576, v9
    v_and_b32 v63, 1, v8
    v_lshl_add_u32 v9, v63, 3, v9
    s_lshl_b32 s54, s3, 7
    v_add_u32 v9, s54, v9
    v_lshlrev_b32 v8, 1, v8
    v_and_b32 v8, 4, v8
    v_lshrrev_b32 v63, 2, v10
    v_add3_u32 v8, v8, v63, s71
    v_and_b32 v8, 7, v8
    v_lshl_add_u32 v12, v8, 4, v9
    v_mov_b32 v15, 0
    s_mov_b32 s75, 0
    s_mov_b32 s98, 1
    s_lshl_b32 s54, s2, 7
    s_add_u32 s54, s54, 1310720
    s_add_u32 s96, s28, s54
    s_addc_u32 s97, s29, 0
    s_xor_b32 s99, s2, 32
    s_lshl_b32 s99, s99, 7
    s_add_u32 s99, s99, 1310720
    s_waitcnt vmcnt(10)
    v_lshl_or_b32 v56, v56, 16, v56
    v_lshl_or_b32 v57, v57, 16, v57
    v_lshl_or_b32 v58, v58, 16, v58
    v_and_b32_dpp v28, v56, v16 row_newbcast:0 row_mask:0xf bank_mask:0xf
    v_and_b32_dpp v29, v56, v17 row_newbcast:0 row_mask:0xf bank_mask:0xf
    v_and_b32_dpp v30, v56, v18 row_newbcast:0 row_mask:0xf bank_mask:0xf
    v_and_b32_dpp v31, v56, v19 row_newbcast:0 row_mask:0xf bank_mask:0xf
    v_and_b32_dpp v32, v56, v16 row_newbcast:1 row_mask:0xf bank_mask:0xf
    v_and_b32_dpp v33, v56, v17 row_newbcast:1 row_mask:0xf bank_mask:0xf
    v_and_b32_dpp v34, v56, v18 row_newbcast:1 row_mask:0xf bank_mask:0xf
    v_and_b32_dpp v35, v56, v19 row_newbcast:1 row_mask:0xf bank_mask:0xf
    v_mfma_f32_16x16x32_bf16 v[40:43], v[28:31], a[0:3], 0
    buffer_load_dwordx4 v[196:199], v133, s[32:35], s51 offen nt
    s_add_u32 s54, s56, 6
    s_bfe_u32 s55, s54, 0x10000
    v_lshl_add_u32 v134, s55, 11, v62
    s_bfe_u32 s55, s54, 0x10001
    v_lshl_add_u32 v134, s55, 12, v134
    s_bfe_u32 s55, s54, 0x10002
    v_lshl_add_u32 v134, s55, 10, v134
    v_and_b32_dpp v28, v56, v16 row_newbcast:2 row_mask:0xf bank_mask:0xf
    v_and_b32_dpp v29, v56, v17 row_newbcast:2 row_mask:0xf bank_mask:0xf
    v_and_b32_dpp v30, v56, v18 row_newbcast:2 row_mask:0xf bank_mask:0xf
    v_and_b32_dpp v31, v56, v19 row_newbcast:2 row_mask:0xf bank_mask:0xf
    v_mfma_f32_16x16x32_bf16 v[40:43], v[32:35], a[4:7], v[40:43]
    buffer_load_dwordx4 a[44:47], v2, s[36:39], s58 offen
    s_add_u32 s58, s58, 32768
    v_and_b32_dpp v32, v56, v16 row_newbcast:3 row_mask:0xf bank_mask:0xf
    v_and_b32_dpp v33, v56, v17 row_newbcast:3 row_mask:0xf bank_mask:0xf
    v_and_b32_dpp v34, v56, v18 row_newbcast:3 row_mask:0xf bank_mask:0xf
    v_and_b32_dpp v35, v56, v19 row_newbcast:3 row_mask:0xf bank_mask:0xf
    v_mfma_f32_16x16x32_bf16 v[40:43], v[28:31], a[8:11], v[40:43]
    buffer_load_dwordx4 v[200:203], v134, s[32:35], s51 offen nt
    s_add_u32 s54, s56, 7
    s_bfe_u32 s55, s54, 0x10000
    v_lshl_add_u32 v135, s55, 11, v62
    s_bfe_u32 s55, s54, 0x10001
    v_lshl_add_u32 v135, s55, 12, v135
    s_bfe_u32 s55, s54, 0x10002
    v_lshl_add_u32 v135, s55, 10, v135
    v_and_b32_dpp v28, v56, v16 row_newbcast:4 row_mask:0xf bank_mask:0xf
    v_and_b32_dpp v29, v56, v17 row_newbcast:4 row_mask:0xf bank_mask:0xf
    v_and_b32_dpp v30, v56, v18 row_newbcast:4 row_mask:0xf bank_mask:0xf
    v_and_b32_dpp v31, v56, v19 row_newbcast:4 row_mask:0xf bank_mask:0xf
    v_mfma_f32_16x16x32_bf16 v[40:43], v[32:35], a[12:15], v[40:43]
    buffer_load_dwordx4 a[48:51], v2, s[36:39], s58 offen
    s_add_u32 s58, s58, 32768
    buffer_load_dwordx4 a[52:55], v2, s[36:39], s58 offen
    s_add_u32 s58, s58, 32768
    v_and_b32_dpp v32, v56, v16 row_newbcast:5 row_mask:0xf bank_mask:0xf
    v_and_b32_dpp v33, v56, v17 row_newbcast:5 row_mask:0xf bank_mask:0xf
    v_and_b32_dpp v34, v56, v18 row_newbcast:5 row_mask:0xf bank_mask:0xf
    v_and_b32_dpp v35, v56, v19 row_newbcast:5 row_mask:0xf bank_mask:0xf
    v_mfma_f32_16x16x32_bf16 v[40:43], v[28:31], a[16:19], v[40:43]
    buffer_load_dwordx4 v[204:207], v135, s[32:35], s51 offen nt
    v_and_b32_dpp v28, v56, v16 row_newbcast:6 row_mask:0xf bank_mask:0xf
    v_and_b32_dpp v29, v56, v17 row_newbcast:6 row_mask:0xf bank_mask:0xf
    v_and_b32_dpp v30, v56, v18 row_newbcast:6 row_mask:0xf bank_mask:0xf
    v_and_b32_dpp v31, v56, v19 row_newbcast:6 row_mask:0xf bank_mask:0xf
    s_waitcnt vmcnt(15)
    v_mfma_f32_16x16x32_bf16 v[40:43], v[32:35], a[20:23], v[40:43]
    buffer_load_dwordx4 a[56:59], v2, s[36:39], s58 offen
    s_cmp_eq_u32 s71, 5
    s_cselect_b32 s63, 0xffec8000, s72
    s_add_u32 s58, s58, s63
    buffer_load_dwordx4 v[208:211], v128, s[32:35], s52 offen nt
    v_and_b32_dpp v32, v56, v16 row_newbcast:7 row_mask:0xf bank_mask:0xf
    v_and_b32_dpp v33, v56, v17 row_newbcast:7 row_mask:0xf bank_mask:0xf
    v_and_b32_dpp v34, v56, v18 row_newbcast:7 row_mask:0xf bank_mask:0xf
    v_and_b32_dpp v35, v56, v19 row_newbcast:7 row_mask:0xf bank_mask:0xf
    s_waitcnt vmcnt(15)
    v_mfma_f32_16x16x32_bf16 v[40:43], v[28:31], a[24:27], v[40:43]
    buffer_load_dwordx4 a[60:63], v2, s[36:39], s58 offen
    s_add_u32 s58, s58, 32768
    buffer_load_dwordx4 v[212:215], v129, s[32:35], s52 offen nt
    v_and_b32_dpp v28, v56, v16 row_newbcast:8 row_mask:0xf bank_mask:0xf
    v_and_b32_dpp v29, v56, v17 row_newbcast:8 row_mask:0xf bank_mask:0xf
    v_and_b32_dpp v30, v56, v18 row_newbcast:8 row_mask:0xf bank_mask:0xf
    v_and_b32_dpp v31, v56, v19 row_newbcast:8 row_mask:0xf bank_mask:0xf
    s_waitcnt vmcnt(15)
    v_mfma_f32_16x16x32_bf16 v[40:43], v[32:35], a[28:31], v[40:43]
    buffer_load_dwordx4 a[64:67], v2, s[36:39], s58 offen
    s_add_u32 s58, s58, 32768
    buffer_load_dwordx4 v[216:219], v130, s[32:35], s52 offen nt
    v_and_b32_dpp v32, v56, v16 row_newbcast:9 row_mask:0xf bank_mask:0xf
    v_and_b32_dpp v33, v56, v17 row_newbcast:9 row_mask:0xf bank_mask:0xf
    v_and_b32_dpp v34, v56, v18 row_newbcast:9 row_mask:0xf bank_mask:0xf
    v_and_b32_dpp v35, v56, v19 row_newbcast:9 row_mask:0xf bank_mask:0xf
    s_waitcnt vmcnt(15)
    v_mfma_f32_16x16x32_bf16 v[40:43], v[28:31], a[32:35], v[40:43]
    buffer_load_dwordx4 a[68:71], v2, s[36:39], s58 offen
    s_add_u32 s58, s58, 32768
    v_and_b32_dpp v28, v56, v16 row_newbcast:10 row_mask:0xf bank_mask:0xf
    v_and_b32_dpp v29, v56, v17 row_newbcast:10 row_mask:0xf bank_mask:0xf
    v_and_b32_dpp v30, v56, v18 row_newbcast:10 row_mask:0xf bank_mask:0xf
    v_and_b32_dpp v31, v56, v19 row_newbcast:10 row_mask:0xf bank_mask:0xf
    s_waitcnt vmcnt(15)
    v_mfma_f32_16x16x32_bf16 v[40:43], v[32:35], a[36:39], v[40:43]
    buffer_load_dwordx4 a[72:75], v2, s[36:39], s58 offen
    s_add_u32 s58, s58, 32768
    buffer_load_dwordx4 v[220:223], v131, s[32:35], s52 offen nt
    v_and_b32_dpp v32, v56, v16 row_newbcast:11 row_mask:0xf bank_mask:0xf
    v_and_b32_dpp v33, v56, v17 row_newbcast:11 row_mask:0xf bank_mask:0xf
    v_and_b32_dpp v34, v56, v18 row_newbcast:11 row_mask:0xf bank_mask:0xf
    v_and_b32_dpp v35, v56, v19 row_newbcast:11 row_mask:0xf bank_mask:0xf
    s_waitcnt vmcnt(15)
    v_mfma_f32_16x16x32_bf16 v[40:43], v[28:31], a[40:43], v[40:43]
    buffer_load_dwordx4 a[76:79], v2, s[36:39], s58 offen
    s_cmp_eq_u32 s71, 4
    s_cselect_b32 s63, 0xffec8000, s72
    s_add_u32 s58, s58, s63
    buffer_load_dwordx4 v[224:227], v132, s[32:35], s52 offen nt
    v_and_b32_dpp v28, v56, v16 row_newbcast:12 row_mask:0xf bank_mask:0xf
    v_and_b32_dpp v29, v56, v17 row_newbcast:12 row_mask:0xf bank_mask:0xf
    v_and_b32_dpp v30, v56, v18 row_newbcast:12 row_mask:0xf bank_mask:0xf
    v_and_b32_dpp v31, v56, v19 row_newbcast:12 row_mask:0xf bank_mask:0xf
    s_waitcnt vmcnt(15)
    v_mfma_f32_16x16x32_bf16 v[40:43], v[32:35], a[44:47], v[40:43]
    buffer_load_dwordx4 a[80:83], v2, s[36:39], s58 offen
    s_add_u32 s58, s58, 32768
    buffer_load_dwordx4 v[228:231], v133, s[32:35], s52 offen nt
    v_and_b32_dpp v32, v56, v16 row_newbcast:13 row_mask:0xf bank_mask:0xf
    v_and_b32_dpp v33, v56, v17 row_newbcast:13 row_mask:0xf bank_mask:0xf
    v_and_b32_dpp v34, v56, v18 row_newbcast:13 row_mask:0xf bank_mask:0xf
    v_and_b32_dpp v35, v56, v19 row_newbcast:13 row_mask:0xf bank_mask:0xf
    s_waitcnt vmcnt(15)
    v_mfma_f32_16x16x32_bf16 v[40:43], v[28:31], a[48:51], v[40:43]
    buffer_load_dwordx4 a[84:87], v2, s[36:39], s58 offen
    s_add_u32 s58, s58, 32768
    v_and_b32_dpp v28, v56, v16 row_newbcast:14 row_mask:0xf bank_mask:0xf
    v_and_b32_dpp v29, v56, v17 row_newbcast:14 row_mask:0xf bank_mask:0xf
    v_and_b32_dpp v30, v56, v18 row_newbcast:14 row_mask:0xf bank_mask:0xf
    v_and_b32_dpp v31, v56, v19 row_newbcast:14 row_mask:0xf bank_mask:0xf
    s_waitcnt vmcnt(15)
    v_mfma_f32_16x16x32_bf16 v[40:43], v[32:35], a[52:55], v[40:43]
    buffer_load_dwordx4 a[88:91], v2, s[36:39], s58 offen
    s_add_u32 s58, s58, 32768
    buffer_load_dwordx4 v[232:235], v134, s[32:35], s52 offen nt
    v_and_b32_dpp v32, v56, v16 row_newbcast:15 row_mask:0xf bank_mask:0xf
    v_and_b32_dpp v33, v56, v17 row_newbcast:15 row_mask:0xf bank_mask:0xf
    v_and_b32_dpp v34, v56, v18 row_newbcast:15 row_mask:0xf bank_mask:0xf
    v_and_b32_dpp v35, v56, v19 row_newbcast:15 row_mask:0xf bank_mask:0xf
    s_waitcnt vmcnt(15)
    v_mfma_f32_16x16x32_bf16 v[40:43], v[28:31], a[56:59], v[40:43]
    buffer_load_dwordx4 a[92:95], v2, s[36:39], s58 offen
    s_add_u32 s58, s58, 32768
    buffer_load_dwordx4 v[236:239], v135, s[32:35], s52 offen nt
    v_and_b32_dpp v28, v57, v16 row_newbcast:0 row_mask:0xf bank_mask:0xf
    v_and_b32_dpp v29, v57, v17 row_newbcast:0 row_mask:0xf bank_mask:0xf
    v_and_b32_dpp v30, v57, v18 row_newbcast:0 row_mask:0xf bank_mask:0xf
    v_and_b32_dpp v31, v57, v19 row_newbcast:0 row_mask:0xf bank_mask:0xf
    s_waitcnt vmcnt(15)
    v_mfma_f32_16x16x32_bf16 v[40:43], v[32:35], a[60:63], v[40:43]
    buffer_load_dwordx4 a[96:99], v2, s[36:39], s58 offen
    s_cmp_eq_u32 s71, 3
    s_cselect_b32 s63, 0xffec8000, s72
    s_add_u32 s58, s58, s63
    s_add_u32 s51, s51, 0x20000
    s_add_u32 s52, s52, 0x20000
    buffer_load_dwordx4 v[64:67], v128, s[32:35], s51 offen nt
    v_and_b32_dpp v32, v57, v16 row_newbcast:1 row_mask:0xf bank_mask:0xf
    v_and_b32_dpp v33, v57, v17 row_newbcast:1 row_mask:0xf bank_mask:0xf
    v_and_b32_dpp v34, v57, v18 row_newbcast:1 row_mask:0xf bank_mask:0xf
    v_and_b32_dpp v35, v57, v19 row_newbcast:1 row_mask:0xf bank_mask:0xf
    s_waitcnt vmcnt(15)
    v_mfma_f32_16x16x32_bf16 v[40:43], v[28:31], a[64:67], v[40:43]
    buffer_load_dwordx4 a[100:103], v2, s[36:39], s58 offen
    s_add_u32 s58, s58, 32768
    buffer_load_dwordx4 a[104:107], v2, s[36:39], s58 offen
    s_add_u32 s58, s58, 32768
    v_and_b32_dpp v28, v57, v16 row_newbcast:2 row_mask:0xf bank_mask:0xf
    v_and_b32_dpp v29, v57, v17 row_newbcast:2 row_mask:0xf bank_mask:0xf
    v_and_b32_dpp v30, v57, v18 row_newbcast:2 row_mask:0xf bank_mask:0xf
    v_and_b32_dpp v31, v57, v19 row_newbcast:2 row_mask:0xf bank_mask:0xf
    s_waitcnt vmcnt(15)
    v_mfma_f32_16x16x32_bf16 v[40:43], v[32:35], a[68:71], v[40:43]
    buffer_load_dwordx4 v[68:71], v129, s[32:35], s51 offen nt
    v_and_b32_dpp v32, v57, v16 row_newbcast:3 row_mask:0xf bank_mask:0xf
    v_and_b32_dpp v33, v57, v17 row_newbcast:3 row_mask:0xf bank_mask:0xf
    v_and_b32_dpp v34, v57, v18 row_newbcast:3 row_mask:0xf bank_mask:0xf
    v_and_b32_dpp v35, v57, v19 row_newbcast:3 row_mask:0xf bank_mask:0xf
    s_waitcnt vmcnt(15)
    v_mfma_f32_16x16x32_bf16 v[40:43], v[28:31], a[72:75], v[40:43]
    buffer_load_dwordx4 a[108:111], v2, s[36:39], s58 offen
    s_add_u32 s58, s58, 32768
    buffer_load_dwordx4 v[72:75], v130, s[32:35], s51 offen nt
    v_and_b32_dpp v28, v57, v16 row_newbcast:4 row_mask:0xf bank_mask:0xf
    v_and_b32_dpp v29, v57, v17 row_newbcast:4 row_mask:0xf bank_mask:0xf
    v_and_b32_dpp v30, v57, v18 row_newbcast:4 row_mask:0xf bank_mask:0xf
    v_and_b32_dpp v31, v57, v19 row_newbcast:4 row_mask:0xf bank_mask:0xf
    s_waitcnt vmcnt(15)
    v_mfma_f32_16x16x32_bf16 v[40:43], v[32:35], a[76:79], v[40:43]
    buffer_load_dwordx4 a[112:115], v2, s[36:39], s58 offen
    s_add_u32 s58, s58, 32768
    buffer_load_dwordx4 v[76:79], v131, s[32:35], s51 offen nt
    v_and_b32_dpp v32, v57, v16 row_newbcast:5 row_mask:0xf bank_mask:0xf
    v_and_b32_dpp v33, v57, v17 row_newbcast:5 row_mask:0xf bank_mask:0xf
    v_and_b32_dpp v34, v57, v18 row_newbcast:5 row_mask:0xf bank_mask:0xf
    v_and_b32_dpp v35, v57, v19 row_newbcast:5 row_mask:0xf bank_mask:0xf
    s_waitcnt vmcnt(15)
    v_mfma_f32_16x16x32_bf16 v[40:43], v[28:31], a[80:83], v[40:43]
    buffer_load_dwordx4 a[116:119], v2, s[36:39], s58 offen
    s_cmp_eq_u32 s71, 2
    s_cselect_b32 s63, 0xffec8000, s72
    s_add_u32 s58, s58, s63
    buffer_load_dwordx4 v[80:83], v132, s[32:35], s51 offen nt
    v_and_b32_dpp v28, v57, v16 row_newbcast:6 row_mask:0xf bank_mask:0xf
    v_and_b32_dpp v29, v57, v17 row_newbcast:6 row_mask:0xf bank_mask:0xf
    v_and_b32_dpp v30, v57, v18 row_newbcast:6 row_mask:0xf bank_mask:0xf
    v_and_b32_dpp v31, v57, v19 row_newbcast:6 row_mask:0xf bank_mask:0xf
    s_waitcnt vmcnt(15)
    v_mfma_f32_16x16x32_bf16 v[40:43], v[32:35], a[84:87], v[40:43]
    buffer_load_dwordx4 a[120:123], v2, s[36:39], s58 offen
    s_add_u32 s58, s58, 32768
    v_and_b32_dpp v32, v57, v16 row_newbcast:7 row_mask:0xf bank_mask:0xf
    v_and_b32_dpp v33, v57, v17 row_newbcast:7 row_mask:0xf bank_mask:0xf
    v_and_b32_dpp v34, v57, v18 row_newbcast:7 row_mask:0xf bank_mask:0xf
    v_and_b32_dpp v35, v57, v19 row_newbcast:7 row_mask:0xf bank_mask:0xf
    s_waitcnt vmcnt(15)
    v_mfma_f32_16x16x32_bf16 v[40:43], v[28:31], a[88:91], v[40:43]
    buffer_load_dwordx4 a[124:127], v2, s[36:39], s58 offen
    s_add_u32 s58, s58, 32768
    buffer_load_dwordx4 v[84:87], v133, s[32:35], s51 offen nt
    v_and_b32_dpp v28, v57, v16 row_newbcast:8 row_mask:0xf bank_mask:0xf
    v_and_b32_dpp v29, v57, v17 row_newbcast:8 row_mask:0xf bank_mask:0xf
    v_and_b32_dpp v30, v57, v18 row_newbcast:8 row_mask:0xf bank_mask:0xf
    v_and_b32_dpp v31, v57, v19 row_newbcast:8 row_mask:0xf bank_mask:0xf
    s_waitcnt vmcnt(15)
    v_mfma_f32_16x16x32_bf16 v[40:43], v[32:35], a[92:95], v[40:43]
    buffer_load_dwordx4 a[128:131], v2, s[36:39], s58 offen
    s_add_u32 s58, s58, 32768
    buffer_load_dwordx4 v[88:91], v134, s[32:35], s51 offen nt
    v_and_b32_dpp v32, v57, v16 row_newbcast:9 row_mask:0xf bank_mask:0xf
    v_and_b32_dpp v33, v57, v17 row_newbcast:9 row_mask:0xf bank_mask:0xf
    v_and_b32_dpp v34, v57, v18 row_newbcast:9 row_mask:0xf bank_mask:0xf
    v_and_b32_dpp v35, v57, v19 row_newbcast:9 row_mask:0xf bank_mask:0xf
    s_waitcnt vmcnt(15)
    v_mfma_f32_16x16x32_bf16 v[40:43], v[28:31], a[96:99], v[40:43]
    buffer_load_dwordx4 a[132:135], v2, s[36:39], s58 offen
    s_add_u32 s58, s58, 32768
    buffer_load_dwordx4 v[92:95], v135, s[32:35], s51 offen nt
    v_and_b32_dpp v28, v57, v16 row_newbcast:10 row_mask:0xf bank_mask:0xf
    v_and_b32_dpp v29, v57, v17 row_newbcast:10 row_mask:0xf bank_mask:0xf
    v_and_b32_dpp v30, v57, v18 row_newbcast:10 row_mask:0xf bank_mask:0xf
    v_and_b32_dpp v31, v57, v19 row_newbcast:10 row_mask:0xf bank_mask:0xf
    s_waitcnt vmcnt(15)
    v_mfma_f32_16x16x32_bf16 v[40:43], v[32:35], a[100:103], v[40:43]
    buffer_load_dwordx4 a[136:139], v2, s[36:39], s58 offen
    s_cmp_eq_u32 s71, 1
    s_cselect_b32 s63, 0xffec8000, s72
    s_add_u32 s58, s58, s63
    v_and_b32_dpp v32, v57, v16 row_newbcast:11 row_mask:0xf bank_mask:0xf
    v_and_b32_dpp v33, v57, v17 row_newbcast:11 row_mask:0xf bank_mask:0xf
    v_and_b32_dpp v34, v57, v18 row_newbcast:11 row_mask:0xf bank_mask:0xf
    v_and_b32_dpp v35, v57, v19 row_newbcast:11 row_mask:0xf bank_mask:0xf
    s_waitcnt vmcnt(15)
    v_mfma_f32_16x16x32_bf16 v[40:43], v[28:31], a[104:107], v[40:43]
    buffer_load_dwordx4 a[140:143], v2, s[36:39], s58 offen
    s_add_u32 s58, s58, 32768
    buffer_load_dwordx4 v[96:99], v128, s[32:35], s52 offen nt
    v_and_b32_dpp v28, v57, v16 row_newbcast:12 row_mask:0xf bank_mask:0xf
    v_and_b32_dpp v29, v57, v17 row_newbcast:12 row_mask:0xf bank_mask:0xf
    v_and_b32_dpp v30, v57, v18 row_newbcast:12 row_mask:0xf bank_mask:0xf
    v_and_b32_dpp v31, v57, v19 row_newbcast:12 row_mask:0xf bank_mask:0xf
    s_waitcnt vmcnt(15)
    v_mfma_f32_16x16x32_bf16 v[40:43], v[32:35], a[108:111], v[40:43]
    buffer_load_dwordx4 a[144:147], v2, s[36:39], s58 offen
    s_add_u32 s58, s58, 32768
    buffer_load_dwordx4 v[100:103], v129, s[32:35], s52 offen nt
    v_and_b32_dpp v32, v57, v16 row_newbcast:13 row_mask:0xf bank_mask:0xf
    v_and_b32_dpp v33, v57, v17 row_newbcast:13 row_mask:0xf bank_mask:0xf
    v_and_b32_dpp v34, v57, v18 row_newbcast:13 row_mask:0xf bank_mask:0xf
    v_and_b32_dpp v35, v57, v19 row_newbcast:13 row_mask:0xf bank_mask:0xf
    s_waitcnt vmcnt(15)
    v_mfma_f32_16x16x32_bf16 v[40:43], v[28:31], a[112:115], v[40:43]
    buffer_load_dwordx4 a[148:151], v2, s[36:39], s58 offen
    s_add_u32 s58, s58, 32768
    buffer_load_dwordx4 v[104:107], v130, s[32:35], s52 offen nt
    v_and_b32_dpp v28, v57, v16 row_newbcast:14 row_mask:0xf bank_mask:0xf
    v_and_b32_dpp v29, v57, v17 row_newbcast:14 row_mask:0xf bank_mask:0xf
    v_and_b32_dpp v30, v57, v18 row_newbcast:14 row_mask:0xf bank_mask:0xf
    v_and_b32_dpp v31, v57, v19 row_newbcast:14 row_mask:0xf bank_mask:0xf
    s_waitcnt vmcnt(15)
    v_mfma_f32_16x16x32_bf16 v[40:43], v[32:35], a[116:119], v[40:43]
    buffer_load_dwordx4 a[152:155], v2, s[36:39], s58 offen
    s_add_u32 s58, s58, 32768
    buffer_load_dwordx4 a[156:159], v2, s[36:39], s58 offen
    v_and_b32_dpp v32, v57, v16 row_newbcast:15 row_mask:0xf bank_mask:0xf
    v_and_b32_dpp v33, v57, v17 row_newbcast:15 row_mask:0xf bank_mask:0xf
    v_and_b32_dpp v34, v57, v18 row_newbcast:15 row_mask:0xf bank_mask:0xf
    v_and_b32_dpp v35, v57, v19 row_newbcast:15 row_mask:0xf bank_mask:0xf
    s_waitcnt vmcnt(15)
    v_mfma_f32_16x16x32_bf16 v[40:43], v[28:31], a[120:123], v[40:43]
    buffer_load_dwordx4 v[108:111], v131, s[32:35], s52 offen nt
    v_and_b32_dpp v28, v58, v16 row_newbcast:0 row_mask:0xf bank_mask:0xf
    v_and_b32_dpp v29, v58, v17 row_newbcast:0 row_mask:0xf bank_mask:0xf
    v_and_b32_dpp v30, v58, v18 row_newbcast:0 row_mask:0xf bank_mask:0xf
    v_and_b32_dpp v31, v58, v19 row_newbcast:0 row_mask:0xf bank_mask:0xf
    s_waitcnt vmcnt(15)
    v_mfma_f32_16x16x32_bf16 v[40:43], v[32:35], a[124:127], v[40:43]
    s_waitcnt vmcnt(12)
    buffer_load_dwordx4 v[112:115], v132, s[32:35], s52 offen nt
    v_and_b32_dpp v32, v58, v16 row_newbcast:1 row_mask:0xf bank_mask:0xf
    v_and_b32_dpp v33, v58, v17 row_newbcast:1 row_mask:0xf bank_mask:0xf
    v_and_b32_dpp v34, v58, v18 row_newbcast:1 row_mask:0xf bank_mask:0xf
    v_and_b32_dpp v35, v58, v19 row_newbcast:1 row_mask:0xf bank_mask:0xf
    v_mfma_f32_16x16x32_bf16 v[40:43], v[28:31], a[128:131], v[40:43]
    s_waitcnt vmcnt(11)
    buffer_load_dwordx4 v[116:119], v133, s[32:35], s52 offen nt
    v_and_b32_dpp v28, v58, v16 row_newbcast:2 row_mask:0xf bank_mask:0xf
    v_and_b32_dpp v29, v58, v17 row_newbcast:2 row_mask:0xf bank_mask:0xf
    v_and_b32_dpp v30, v58, v18 row_newbcast:2 row_mask:0xf bank_mask:0xf
    v_and_b32_dpp v31, v58, v19 row_newbcast:2 row_mask:0xf bank_mask:0xf
    v_mfma_f32_16x16x32_bf16 v[40:43], v[32:35], a[132:135], v[40:43]
    s_waitcnt vmcnt(9)
    buffer_load_dwordx4 v[120:123], v134, s[32:35], s52 offen nt
    v_and_b32_dpp v32, v58, v16 row_newbcast:3 row_mask:0xf bank_mask:0xf
    v_and_b32_dpp v33, v58, v17 row_newbcast:3 row_mask:0xf bank_mask:0xf
    v_and_b32_dpp v34, v58, v18 row_newbcast:3 row_mask:0xf bank_mask:0xf
    v_and_b32_dpp v35, v58, v19 row_newbcast:3 row_mask:0xf bank_mask:0xf
    v_mfma_f32_16x16x32_bf16 v[40:43], v[28:31], a[136:139], v[40:43]
    s_waitcnt vmcnt(8)
    buffer_load_dwordx4 v[124:127], v135, s[32:35], s52 offen nt
    v_and_b32_dpp v28, v58, v16 row_newbcast:4 row_mask:0xf bank_mask:0xf
    v_and_b32_dpp v29, v58, v17 row_newbcast:4 row_mask:0xf bank_mask:0xf
    v_and_b32_dpp v30, v58, v18 row_newbcast:4 row_mask:0xf bank_mask:0xf
    v_and_b32_dpp v31, v58, v19 row_newbcast:4 row_mask:0xf bank_mask:0xf
    v_mfma_f32_16x16x32_bf16 v[40:43], v[32:35], a[140:143], v[40:43]
    s_waitcnt vmcnt(7)
    s_mov_b64 s[44:45], s[8:9]
    s_mov_b32 s46, 134217728
    s_mov_b32 s47, 0x20000
    s_add_u32 s57, s53, 0x8000
    buffer_load_dwordx4 a[160:163], v128, s[44:47], s53 offen nt
    v_and_b32_dpp v32, v58, v16 row_newbcast:5 row_mask:0xf bank_mask:0xf
    v_and_b32_dpp v33, v58, v17 row_newbcast:5 row_mask:0xf bank_mask:0xf
    v_and_b32_dpp v34, v58, v18 row_newbcast:5 row_mask:0xf bank_mask:0xf
    v_and_b32_dpp v35, v58, v19 row_newbcast:5 row_mask:0xf bank_mask:0xf
    v_mfma_f32_16x16x32_bf16 v[40:43], v[28:31], a[144:147], v[40:43]
    s_waitcnt vmcnt(5)
    buffer_load_dwordx4 a[164:167], v129, s[44:47], s53 offen nt
    v_and_b32_dpp v28, v58, v16 row_newbcast:6 row_mask:0xf bank_mask:0xf
    v_and_b32_dpp v29, v58, v17 row_newbcast:6 row_mask:0xf bank_mask:0xf
    v_and_b32_dpp v30, v58, v18 row_newbcast:6 row_mask:0xf bank_mask:0xf
    v_and_b32_dpp v31, v58, v19 row_newbcast:6 row_mask:0xf bank_mask:0xf
    v_mfma_f32_16x16x32_bf16 v[40:43], v[32:35], a[148:151], v[40:43]
    s_waitcnt vmcnt(5)
    buffer_load_dwordx4 a[168:171], v130, s[44:47], s53 offen nt
    v_and_b32_dpp v32, v58, v16 row_newbcast:7 row_mask:0xf bank_mask:0xf
    v_and_b32_dpp v33, v58, v17 row_newbcast:7 row_mask:0xf bank_mask:0xf
    v_and_b32_dpp v34, v58, v18 row_newbcast:7 row_mask:0xf bank_mask:0xf
    v_and_b32_dpp v35, v58, v19 row_newbcast:7 row_mask:0xf bank_mask:0xf
    v_mfma_f32_16x16x32_bf16 v[40:43], v[28:31], a[152:155], v[40:43]
    s_waitcnt vmcnt(5)
    buffer_load_dwordx4 a[172:175], v131, s[44:47], s53 offen nt
    v_mfma_f32_16x16x32_bf16 v[40:43], v[32:35], a[156:159], v[40:43]
    s_waitcnt vmcnt(5)
    buffer_load_dwordx4 a[176:179], v132, s[44:47], s53 offen nt
    s_mul_i32 s54, s3, 512
    v_add_u32 v62, s54, v11
    s_mov_b32 exec_hi, 0
    s_nop 2
    ds_write_b128 v62, v[40:43] offset:0
    s_mov_b32 exec_hi, -1
    buffer_load_dwordx4 a[180:183], v133, s[44:47], s53 offen nt
    buffer_load_dwordx4 a[184:187], v134, s[44:47], s53 offen nt
    s_waitcnt lgkmcnt(0)
    s_barrier
    v_lshlrev_b32 v62, 5, v10
    ds_read_b128 v[144:147], v62 offset:0
    ds_read_b128 v[148:151], v62 offset:16
    ds_read_b128 v[152:155], v62 offset:512
    ds_read_b128 v[156:159], v62 offset:528
    ds_read_b128 v[160:163], v62 offset:1024
    ds_read_b128 v[164:167], v62 offset:1040
    ds_read_b128 v[168:171], v62 offset:1536
    ds_read_b128 v[172:175], v62 offset:1552
    s_waitcnt lgkmcnt(4)
    v_add_f32 v144, v144, v152
    v_add_f32 v145, v145, v153
    v_add_f32 v146, v146, v154
    v_add_f32 v147, v147, v155
    v_add_f32 v148, v148, v156
    v_add_f32 v149, v149, v157
    v_add_f32 v150, v150, v158
    v_add_f32 v151, v151, v159
    s_waitcnt lgkmcnt(2)
    v_add_f32 v144, v144, v160
    v_add_f32 v145, v145, v161
    v_add_f32 v146, v146, v162
    v_add_f32 v147, v147, v163
    v_add_f32 v148, v148, v164
    v_add_f32 v149, v149, v165
    v_add_f32 v150, v150, v166
    v_add_f32 v151, v151, v167
    s_waitcnt lgkmcnt(0)
    v_add_f32 v144, v144, v168
    v_add_f32 v145, v145, v169
    v_add_f32 v146, v146, v170
    v_add_f32 v147, v147, v171
    v_add_f32 v148, v148, v172
    v_add_f32 v149, v149, v173
    v_add_f32 v150, v150, v174
    v_add_f32 v151, v151, v175
    v_cvt_pk_bf16_f32 v20, v144, v145
    v_cvt_pk_bf16_f32 v21, v146, v147
    v_cvt_pk_bf16_f32 v22, v148, v149
    v_cvt_pk_bf16_f32 v23, v150, v151
    v_dot2_f32_bf16 v44, v176, v20, 0
    v_dot2_f32_bf16 v45, v180, v20, 0
    v_dot2_f32_bf16 v46, v184, v20, 0
    v_dot2_f32_bf16 v47, v188, v20, 0
    v_dot2_f32_bf16 v44, v177, v21, v44
    v_dot2_f32_bf16 v45, v181, v21, v45
    v_dot2_f32_bf16 v46, v185, v21, v46
    v_dot2_f32_bf16 v47, v189, v21, v47
    v_dot2_f32_bf16 v44, v178, v22, v44
    v_dot2_f32_bf16 v45, v182, v22, v45
    v_dot2_f32_bf16 v46, v186, v22, v46
    v_dot2_f32_bf16 v47, v190, v22, v47
    v_dot2_f32_bf16 v44, v179, v23, v44
    v_dot2_f32_bf16 v45, v183, v23, v45
    v_dot2_f32_bf16 v46, v187, v23, v46
    v_dot2_f32_bf16 v47, v191, v23, v47
    s_waitcnt vmcnt(4)
    buffer_load_dwordx4 a[188:191], v135, s[44:47], s53 offen nt
    s_waitcnt vmcnt(4)
    buffer_load_dwordx4 a[192:195], v128, s[44:47], s57 offen nt
    v_dot2_f32_bf16 v48, v192, v20, 0
    v_dot2_f32_bf16 v49, v196, v20, 0
    v_dot2_f32_bf16 v50, v200, v20, 0
    v_dot2_f32_bf16 v51, v204, v20, 0
    v_dot2_f32_bf16 v48, v193, v21, v48
    v_dot2_f32_bf16 v49, v197, v21, v49
    v_dot2_f32_bf16 v50, v201, v21, v50
    v_dot2_f32_bf16 v51, v205, v21, v51
    v_dot2_f32_bf16 v48, v194, v22, v48
    v_dot2_f32_bf16 v49, v198, v22, v49
    v_dot2_f32_bf16 v50, v202, v22, v50
    v_dot2_f32_bf16 v51, v206, v22, v51
    v_dot2_f32_bf16 v48, v195, v23, v48
    v_dot2_f32_bf16 v49, v199, v23, v49
    v_dot2_f32_bf16 v50, v203, v23, v50
    v_dot2_f32_bf16 v51, v207, v23, v51
    s_waitcnt vmcnt(4)
    buffer_load_dwordx4 a[196:199], v129, s[44:47], s57 offen nt
    s_waitcnt vmcnt(4)
    buffer_load_dwordx4 a[200:203], v130, s[44:47], s57 offen nt
    v_add_f32_dpp v44, v44, v44 row_ror:8 row_mask:0xf bank_mask:0x3
    v_add_f32_dpp v48, v48, v48 row_ror:8 row_mask:0xf bank_mask:0x3
    v_add_f32_dpp v45, v45, v45 row_ror:8 row_mask:0xf bank_mask:0x3
    v_add_f32_dpp v49, v49, v49 row_ror:8 row_mask:0xf bank_mask:0x3
    v_add_f32_dpp v44, v46, v46 row_ror:8 row_mask:0xf bank_mask:0xc
    v_add_f32_dpp v48, v50, v50 row_ror:8 row_mask:0xf bank_mask:0xc
    v_add_f32_dpp v45, v47, v47 row_ror:8 row_mask:0xf bank_mask:0xc
    v_add_f32_dpp v49, v51, v51 row_ror:8 row_mask:0xf bank_mask:0xc
    v_add_f32_dpp v44, v44, v44 row_half_mirror row_mask:0xf bank_mask:0x5
    v_add_f32_dpp v48, v48, v48 row_half_mirror row_mask:0xf bank_mask:0x5
    s_nop 0
    v_add_f32_dpp v44, v45, v45 row_half_mirror row_mask:0xf bank_mask:0xa
    v_add_f32_dpp v48, v49, v49 row_half_mirror row_mask:0xf bank_mask:0xa
    s_nop 0
    v_add_f32_dpp v44, v44, v44 quad_perm:[1,0,3,2] row_mask:0xf bank_mask:0xf
    v_add_f32_dpp v48, v48, v48 quad_perm:[1,0,3,2] row_mask:0xf bank_mask:0xf
    s_nop 0
    v_add_f32_dpp v44, v44, v44 quad_perm:[2,3,0,1] row_mask:0xf bank_mask:0xf
    v_add_f32_dpp v48, v48, v48 quad_perm:[2,3,0,1] row_mask:0xf bank_mask:0xf
    s_waitcnt vmcnt(4)
    buffer_load_dwordx4 a[204:207], v131, s[44:47], s57 offen nt
    v_cndmask_b32 v136, v44, v48, s[64:65]
    v_dot2_f32_bf16 v44, v208, v20, 0
    v_dot2_f32_bf16 v45, v212, v20, 0
    v_dot2_f32_bf16 v46, v216, v20, 0
    v_dot2_f32_bf16 v47, v220, v20, 0
    v_dot2_f32_bf16 v44, v209, v21, v44
    v_dot2_f32_bf16 v45, v213, v21, v45
    v_dot2_f32_bf16 v46, v217, v21, v46
    v_dot2_f32_bf16 v47, v221, v21, v47
    v_dot2_f32_bf16 v44, v210, v22, v44
    v_dot2_f32_bf16 v45, v214, v22, v45
    v_dot2_f32_bf16 v46, v218, v22, v46
    v_dot2_f32_bf16 v47, v222, v22, v47
    v_dot2_f32_bf16 v44, v211, v23, v44
    v_dot2_f32_bf16 v45, v215, v23, v45
    v_dot2_f32_bf16 v46, v219, v23, v46
    v_dot2_f32_bf16 v47, v223, v23, v47
    v_dot2_f32_bf16 v48, v224, v20, 0
    v_dot2_f32_bf16 v49, v228, v20, 0
    v_dot2_f32_bf16 v50, v232, v20, 0
    v_dot2_f32_bf16 v51, v236, v20, 0
    v_dot2_f32_bf16 v48, v225, v21, v48
    v_dot2_f32_bf16 v49, v229, v21, v49
    v_dot2_f32_bf16 v50, v233, v21, v50
    v_dot2_f32_bf16 v51, v237, v21, v51
    v_dot2_f32_bf16 v48, v226, v22, v48
    v_dot2_f32_bf16 v49, v230, v22, v49
    v_dot2_f32_bf16 v50, v234, v22, v50
    v_dot2_f32_bf16 v51, v238, v22, v51
    v_dot2_f32_bf16 v48, v227, v23, v48
    v_dot2_f32_bf16 v49, v231, v23, v49
    v_dot2_f32_bf16 v50, v235, v23, v50
    v_dot2_f32_bf16 v51, v239, v23, v51
    v_add_f32_dpp v44, v44, v44 row_ror:8 row_mask:0xf bank_mask:0x3
    v_add_f32_dpp v48, v48, v48 row_ror:8 row_mask:0xf bank_mask:0x3
    v_add_f32_dpp v45, v45, v45 row_ror:8 row_mask:0xf bank_mask:0x3
    v_add_f32_dpp v49, v49, v49 row_ror:8 row_mask:0xf bank_mask:0x3
    v_add_f32_dpp v44, v46, v46 row_ror:8 row_mask:0xf bank_mask:0xc
    v_add_f32_dpp v48, v50, v50 row_ror:8 row_mask:0xf bank_mask:0xc
    v_add_f32_dpp v45, v47, v47 row_ror:8 row_mask:0xf bank_mask:0xc
    v_add_f32_dpp v49, v51, v51 row_ror:8 row_mask:0xf bank_mask:0xc
    v_add_f32_dpp v44, v44, v44 row_half_mirror row_mask:0xf bank_mask:0x5
    v_add_f32_dpp v48, v48, v48 row_half_mirror row_mask:0xf bank_mask:0x5
    s_nop 0
    v_add_f32_dpp v44, v45, v45 row_half_mirror row_mask:0xf bank_mask:0xa
    v_add_f32_dpp v48, v49, v49 row_half_mirror row_mask:0xf bank_mask:0xa
    s_nop 0
    v_add_f32_dpp v44, v44, v44 quad_perm:[1,0,3,2] row_mask:0xf bank_mask:0xf
    v_add_f32_dpp v48, v48, v48 quad_perm:[1,0,3,2] row_mask:0xf bank_mask:0xf
    s_nop 0
    v_add_f32_dpp v44, v44, v44 quad_perm:[2,3,0,1] row_mask:0xf bank_mask:0xf
    v_add_f32_dpp v48, v48, v48 quad_perm:[2,3,0,1] row_mask:0xf bank_mask:0xf
    v_cndmask_b32 v136, v136, v44, s[66:67]
    v_cndmask_b32 v136, v136, v48, s[68:69]
    s_add_u32 s51, s51, 0x20000
    s_add_u32 s52, s52, 0x20000
    v_mul_u32_u24 v230, 9, v1
    v_add_u32 v230, s2, v230
    v_and_b32 v230, 255, v230
    v_lshlrev_b32 v230, 7, v230
    v_mov_b32 v9, 0x7fffffff
    v_cmp_gt_u32 vcc, 8, v0
    v_mov_b32 v8, 4400
    s_nop 0
    v_cndmask_b32 v230, v9, v230, vcc
    ds_write_b32 v8, v15
    v_lshrrev_b32 v8, 2, v10
    v_mov_b32 v9, 0xffff
    v_cmp_eq_u32 vcc, 0, v8
    s_nop 1
    v_cndmask_b32 v208, 0, v9, vcc
    v_cmp_eq_u32 vcc, 1, v8
    s_nop 1
    v_cndmask_b32 v209, 0, v9, vcc
    v_and_b32 v8, 3, v10
    v_mul_u32_u24 v210, 0x1111, v8
    s_mov_b32 s54, 1310720
    buffer_load_dwordx4 v[232:235], v230, s[40:43], s54 offen sc1
    buffer_load_dwordx4 v[200:203], v15, s[40:43], s99 offen offset:16 sc1
    s_xor_b32 s54, s99, 4096
    buffer_load_dwordx4 v[204:207], v15, s[40:43], s54 offen offset:16 sc1
    v_dot2_f32_bf16 v44, v64, v20, 0
    v_dot2_f32_bf16 v45, v68, v20, 0
    v_dot2_f32_bf16 v46, v72, v20, 0
    v_dot2_f32_bf16 v47, v76, v20, 0
    v_dot2_f32_bf16 v44, v65, v21, v44
    v_dot2_f32_bf16 v45, v69, v21, v45
    v_dot2_f32_bf16 v46, v73, v21, v46
    v_dot2_f32_bf16 v47, v77, v21, v47
    v_dot2_f32_bf16 v44, v66, v22, v44
    v_dot2_f32_bf16 v45, v70, v22, v45
    v_dot2_f32_bf16 v46, v74, v22, v46
    v_dot2_f32_bf16 v47, v78, v22, v47
    v_dot2_f32_bf16 v44, v67, v23, v44
    v_dot2_f32_bf16 v45, v71, v23, v45
    v_dot2_f32_bf16 v46, v75, v23, v46
    v_dot2_f32_bf16 v47, v79, v23, v47
    s_waitcnt vmcnt(7)
    buffer_load_dwordx4 v[64:67], v128, s[32:35], s51 offen nt
    s_waitcnt vmcnt(7)
    buffer_load_dwordx4 v[68:71], v129, s[32:35], s51 offen nt
    s_mov_b64 s[44:45], s[14:15]
    s_mov_b32 s46, 5120
    s_mov_b32 s47, 0x20000
    buffer_load_ushort v59, v4, s[44:47], 0 offen
    buffer_load_ushort v60, v24, s[44:47], 0 offen
    buffer_load_ushort v61, v25, s[44:47], 0 offen
    s_mov_b64 s[44:45], s[24:25]
    s_mov_b32 s46, 10240
    s_mov_b32 s47, 0x20000
    s_mov_b64 s[36:37], s[20:21]
    s_mov_b32 s58, s59
    v_dot2_f32_bf16 v48, v80, v20, 0
    v_dot2_f32_bf16 v49, v84, v20, 0
    v_dot2_f32_bf16 v50, v88, v20, 0
    v_dot2_f32_bf16 v51, v92, v20, 0
    v_dot2_f32_bf16 v48, v81, v21, v48
    v_dot2_f32_bf16 v49, v85, v21, v49
    v_dot2_f32_bf16 v50, v89, v21, v50
    v_dot2_f32_bf16 v51, v93, v21, v51
    v_dot2_f32_bf16 v48, v82, v22, v48
    v_dot2_f32_bf16 v49, v86, v22, v49
    v_dot2_f32_bf16 v50, v90, v22, v50
    v_dot2_f32_bf16 v51, v94, v22, v51
    v_dot2_f32_bf16 v48, v83, v23, v48
    v_dot2_f32_bf16 v49, v87, v23, v49
    v_dot2_f32_bf16 v50, v91, v23, v50
    v_dot2_f32_bf16 v51, v95, v23, v51
    s_waitcnt vmcnt(10)
    buffer_load_dwordx4 v[72:75], v130, s[32:35], s51 offen nt
    buffer_load_dwordx4 v[240:243], v5, s[40:43], 0 offen sc1
    s_waitcnt vmcnt(11)
    buffer_load_dwordx4 v[76:79], v131, s[32:35], s51 offen nt
    s_mov_b32 s54, 655360
    buffer_load_dwordx4 v[244:247], v5, s[40:43], s54 offen sc1
    v_add_f32_dpp v44, v44, v44 row_ror:8 row_mask:0xf bank_mask:0x3
    v_add_f32_dpp v48, v48, v48 row_ror:8 row_mask:0xf bank_mask:0x3
    v_add_f32_dpp v45, v45, v45 row_ror:8 row_mask:0xf bank_mask:0x3
    v_add_f32_dpp v49, v49, v49 row_ror:8 row_mask:0xf bank_mask:0x3
    v_add_f32_dpp v44, v46, v46 row_ror:8 row_mask:0xf bank_mask:0xc
    v_add_f32_dpp v48, v50, v50 row_ror:8 row_mask:0xf bank_mask:0xc
    v_add_f32_dpp v45, v47, v47 row_ror:8 row_mask:0xf bank_mask:0xc
    v_add_f32_dpp v49, v51, v51 row_ror:8 row_mask:0xf bank_mask:0xc
    v_add_f32_dpp v44, v44, v44 row_half_mirror row_mask:0xf bank_mask:0x5
    v_add_f32_dpp v48, v48, v48 row_half_mirror row_mask:0xf bank_mask:0x5
    s_nop 0
    v_add_f32_dpp v44, v45, v45 row_half_mirror row_mask:0xf bank_mask:0xa
    v_add_f32_dpp v48, v49, v49 row_half_mirror row_mask:0xf bank_mask:0xa
    s_nop 0
    v_add_f32_dpp v44, v44, v44 quad_perm:[1,0,3,2] row_mask:0xf bank_mask:0xf
    v_add_f32_dpp v48, v48, v48 quad_perm:[1,0,3,2] row_mask:0xf bank_mask:0xf
    s_nop 0
    v_add_f32_dpp v44, v44, v44 quad_perm:[2,3,0,1] row_mask:0xf bank_mask:0xf
    v_add_f32_dpp v48, v48, v48 quad_perm:[2,3,0,1] row_mask:0xf bank_mask:0xf
    s_waitcnt vmcnt(12)
    buffer_load_dwordx4 v[80:83], v132, s[32:35], s51 offen nt
    buffer_load_dwordx4 v[248:251], v6, s[40:43], s61 offen sc1
    s_waitcnt vmcnt(10)
    buffer_load_dwordx4 v[84:87], v133, s[32:35], s51 offen nt
    v_cndmask_b32 v137, v44, v48, s[64:65]
    s_waitcnt vmcnt(10)
    buffer_load_dwordx4 v[88:91], v134, s[32:35], s51 offen nt
    buffer_load_dwordx4 v[252:255], v6, s[40:43], s62 offen sc1
    s_waitcnt vmcnt(8)
    buffer_load_dwordx4 v[92:95], v135, s[32:35], s51 offen nt
    buffer_load_dwordx4 a[0:3], v2, s[36:39], s58 offen
    s_add_u32 s58, s58, 32768
    v_dot2_f32_bf16 v44, v96, v20, 0
    v_dot2_f32_bf16 v45, v100, v20, 0
    v_dot2_f32_bf16 v46, v104, v20, 0
    v_dot2_f32_bf16 v47, v108, v20, 0
    v_dot2_f32_bf16 v44, v97, v21, v44
    v_dot2_f32_bf16 v45, v101, v21, v45
    v_dot2_f32_bf16 v46, v105, v21, v46
    v_dot2_f32_bf16 v47, v109, v21, v47
    v_dot2_f32_bf16 v44, v98, v22, v44
    v_dot2_f32_bf16 v45, v102, v22, v45
    v_dot2_f32_bf16 v46, v106, v22, v46
    v_dot2_f32_bf16 v47, v110, v22, v47
    v_dot2_f32_bf16 v44, v99, v23, v44
    v_dot2_f32_bf16 v45, v103, v23, v45
    v_dot2_f32_bf16 v46, v107, v23, v46
    v_dot2_f32_bf16 v47, v111, v23, v47
    s_waitcnt vmcnt(8)
    buffer_load_dwordx4 v[96:99], v128, s[32:35], s52 offen nt
    buffer_load_dwordx4 a[4:7], v2, s[36:39], s58 offen
    s_add_u32 s58, s58, 32768
    s_waitcnt vmcnt(8)
    buffer_load_dwordx4 v[100:103], v129, s[32:35], s52 offen nt
    buffer_load_dwordx4 a[8:11], v2, s[36:39], s58 offen
    s_add_u32 s58, s58, 32768
    v_dot2_f32_bf16 v48, v112, v20, 0
    v_dot2_f32_bf16 v49, v116, v20, 0
    v_dot2_f32_bf16 v50, v120, v20, 0
    v_dot2_f32_bf16 v51, v124, v20, 0
    v_dot2_f32_bf16 v48, v113, v21, v48
    v_dot2_f32_bf16 v49, v117, v21, v49
    v_dot2_f32_bf16 v50, v121, v21, v50
    v_dot2_f32_bf16 v51, v125, v21, v51
    v_dot2_f32_bf16 v48, v114, v22, v48
    v_dot2_f32_bf16 v49, v118, v22, v49
    v_dot2_f32_bf16 v50, v122, v22, v50
    v_dot2_f32_bf16 v51, v126, v22, v51
    v_dot2_f32_bf16 v48, v115, v23, v48
    v_dot2_f32_bf16 v49, v119, v23, v49
    v_dot2_f32_bf16 v50, v123, v23, v50
    v_dot2_f32_bf16 v51, v127, v23, v51
    s_waitcnt vmcnt(8)
    buffer_load_dwordx4 v[104:107], v130, s[32:35], s52 offen nt
    s_waitcnt vmcnt(8)
    buffer_load_dwordx4 v[108:111], v131, s[32:35], s52 offen nt
    buffer_load_dwordx4 a[12:15], v2, s[36:39], s58 offen
    s_add_u32 s58, s58, 32768
    v_add_f32_dpp v44, v44, v44 row_ror:8 row_mask:0xf bank_mask:0x3
    v_add_f32_dpp v48, v48, v48 row_ror:8 row_mask:0xf bank_mask:0x3
    v_add_f32_dpp v45, v45, v45 row_ror:8 row_mask:0xf bank_mask:0x3
    v_add_f32_dpp v49, v49, v49 row_ror:8 row_mask:0xf bank_mask:0x3
    v_add_f32_dpp v44, v46, v46 row_ror:8 row_mask:0xf bank_mask:0xc
    v_add_f32_dpp v48, v50, v50 row_ror:8 row_mask:0xf bank_mask:0xc
    v_add_f32_dpp v45, v47, v47 row_ror:8 row_mask:0xf bank_mask:0xc
    v_add_f32_dpp v49, v51, v51 row_ror:8 row_mask:0xf bank_mask:0xc
    v_add_f32_dpp v44, v44, v44 row_half_mirror row_mask:0xf bank_mask:0x5
    v_add_f32_dpp v48, v48, v48 row_half_mirror row_mask:0xf bank_mask:0x5
    s_nop 0
    v_add_f32_dpp v44, v45, v45 row_half_mirror row_mask:0xf bank_mask:0xa
    v_add_f32_dpp v48, v49, v49 row_half_mirror row_mask:0xf bank_mask:0xa
    s_nop 0
    v_add_f32_dpp v44, v44, v44 quad_perm:[1,0,3,2] row_mask:0xf bank_mask:0xf
    v_add_f32_dpp v48, v48, v48 quad_perm:[1,0,3,2] row_mask:0xf bank_mask:0xf
    s_nop 0
    v_add_f32_dpp v44, v44, v44 quad_perm:[2,3,0,1] row_mask:0xf bank_mask:0xf
    v_add_f32_dpp v48, v48, v48 quad_perm:[2,3,0,1] row_mask:0xf bank_mask:0xf
    s_waitcnt vmcnt(8)
    buffer_load_dwordx4 v[112:115], v132, s[32:35], s52 offen nt
    buffer_load_dwordx4 a[16:19], v2, s[36:39], s58 offen
    s_cmp_eq_u32 s71, 7
    s_cselect_b32 s63, 0xffec8000, s72
    s_add_u32 s58, s58, s63
    s_waitcnt vmcnt(8)
    buffer_load_dwordx4 v[116:119], v133, s[32:35], s52 offen nt
    buffer_load_dwordx4 a[20:23], v2, s[36:39], s58 offen
    s_add_u32 s58, s58, 32768
    v_cndmask_b32 v137, v137, v44, s[66:67]
    v_cndmask_b32 v137, v137, v48, s[68:69]
    s_waitcnt vmcnt(8)
    buffer_load_dwordx4 v[120:123], v134, s[32:35], s52 offen nt
    buffer_load_dwordx4 a[24:27], v2, s[36:39], s58 offen
    s_add_u32 s58, s58, 32768
    s_waitcnt vmcnt(8)
    buffer_load_dwordx4 v[124:127], v135, s[32:35], s52 offen nt
    buffer_load_dwordx4 a[28:31], v2, s[36:39], s58 offen
    s_add_u32 s58, s58, 32768
    s_add_u32 s51, s51, 0x20000
    s_add_u32 s52, s52, 0x20000
    v_dot2_f32_bf16 v44, v64, v20, 0
    v_dot2_f32_bf16 v45, v68, v20, 0
    v_dot2_f32_bf16 v46, v72, v20, 0
    v_dot2_f32_bf16 v47, v76, v20, 0
    v_dot2_f32_bf16 v44, v65, v21, v44
    v_dot2_f32_bf16 v45, v69, v21, v45
    v_dot2_f32_bf16 v46, v73, v21, v46
    v_dot2_f32_bf16 v47, v77, v21, v47
    v_dot2_f32_bf16 v44, v66, v22, v44
    v_dot2_f32_bf16 v45, v70, v22, v45
    v_dot2_f32_bf16 v46, v74, v22, v46
    v_dot2_f32_bf16 v47, v78, v22, v47
    v_dot2_f32_bf16 v44, v67, v23, v44
    v_dot2_f32_bf16 v45, v71, v23, v45
    v_dot2_f32_bf16 v46, v75, v23, v46
    v_dot2_f32_bf16 v47, v79, v23, v47
    s_waitcnt vmcnt(9)
    buffer_load_dwordx4 v[64:67], v128, s[32:35], s51 offen nt
    s_waitcnt vmcnt(8)
    buffer_load_dwordx4 v[68:71], v129, s[32:35], s51 offen nt
    buffer_load_dwordx4 a[32:35], v2, s[36:39], s58 offen
    s_add_u32 s58, s58, 32768
    v_dot2_f32_bf16 v48, v80, v20, 0
    v_dot2_f32_bf16 v49, v84, v20, 0
    v_dot2_f32_bf16 v50, v88, v20, 0
    v_dot2_f32_bf16 v51, v92, v20, 0
    v_dot2_f32_bf16 v48, v81, v21, v48
    v_dot2_f32_bf16 v49, v85, v21, v49
    v_dot2_f32_bf16 v50, v89, v21, v50
    v_dot2_f32_bf16 v51, v93, v21, v51
    v_dot2_f32_bf16 v48, v82, v22, v48
    v_dot2_f32_bf16 v49, v86, v22, v49
    v_dot2_f32_bf16 v50, v90, v22, v50
    v_dot2_f32_bf16 v51, v94, v22, v51
    v_dot2_f32_bf16 v48, v83, v23, v48
    v_dot2_f32_bf16 v49, v87, v23, v49
    v_dot2_f32_bf16 v50, v91, v23, v50
    v_dot2_f32_bf16 v51, v95, v23, v51
    s_waitcnt vmcnt(8)
    buffer_load_dwordx4 v[72:75], v130, s[32:35], s51 offen nt
    s_waitcnt vmcnt(7)
    buffer_load_dwordx4 v[76:79], v131, s[32:35], s51 offen nt
    buffer_load_dwordx4 a[36:39], v2, s[36:39], s58 offen
    s_cmp_eq_u32 s71, 6
    s_cselect_b32 s63, 0xffec8000, s72
    s_add_u32 s58, s58, s63
    v_add_f32_dpp v44, v44, v44 row_ror:8 row_mask:0xf bank_mask:0x3
    v_add_f32_dpp v48, v48, v48 row_ror:8 row_mask:0xf bank_mask:0x3
    v_add_f32_dpp v45, v45, v45 row_ror:8 row_mask:0xf bank_mask:0x3
    v_add_f32_dpp v49, v49, v49 row_ror:8 row_mask:0xf bank_mask:0x3
    v_add_f32_dpp v44, v46, v46 row_ror:8 row_mask:0xf bank_mask:0xc
    v_add_f32_dpp v48, v50, v50 row_ror:8 row_mask:0xf bank_mask:0xc
    v_add_f32_dpp v45, v47, v47 row_ror:8 row_mask:0xf bank_mask:0xc
    v_add_f32_dpp v49, v51, v51 row_ror:8 row_mask:0xf bank_mask:0xc
    v_add_f32_dpp v44, v44, v44 row_half_mirror row_mask:0xf bank_mask:0x5
    v_add_f32_dpp v48, v48, v48 row_half_mirror row_mask:0xf bank_mask:0x5
    s_nop 0
    v_add_f32_dpp v44, v45, v45 row_half_mirror row_mask:0xf bank_mask:0xa
    v_add_f32_dpp v48, v49, v49 row_half_mirror row_mask:0xf bank_mask:0xa
    s_nop 0
    v_add_f32_dpp v44, v44, v44 quad_perm:[1,0,3,2] row_mask:0xf bank_mask:0xf
    v_add_f32_dpp v48, v48, v48 quad_perm:[1,0,3,2] row_mask:0xf bank_mask:0xf
    s_nop 0
    v_add_f32_dpp v44, v44, v44 quad_perm:[2,3,0,1] row_mask:0xf bank_mask:0xf
    v_add_f32_dpp v48, v48, v48 quad_perm:[2,3,0,1] row_mask:0xf bank_mask:0xf
    s_waitcnt vmcnt(7)
    buffer_load_dwordx4 v[80:83], v132, s[32:35], s51 offen nt
    s_waitcnt vmcnt(6)
    buffer_load_dwordx4 v[84:87], v133, s[32:35], s51 offen nt
    buffer_load_dwordx4 a[40:43], v2, s[36:39], s58 offen
    s_add_u32 s58, s58, 32768
    v_cndmask_b32 v138, v44, v48, s[64:65]
    s_waitcnt vmcnt(7)
    buffer_load_dwordx4 v[88:91], v134, s[32:35], s51 offen nt
    s_waitcnt vmcnt(6)
    buffer_load_dwordx4 v[92:95], v135, s[32:35], s51 offen nt
    buffer_load_dwordx4 a[44:47], v2, s[36:39], s58 offen
    s_add_u32 s58, s58, 32768
    v_dot2_f32_bf16 v44, v96, v20, 0
    v_dot2_f32_bf16 v45, v100, v20, 0
    v_dot2_f32_bf16 v46, v104, v20, 0
    v_dot2_f32_bf16 v47, v108, v20, 0
    v_dot2_f32_bf16 v44, v97, v21, v44
    v_dot2_f32_bf16 v45, v101, v21, v45
    v_dot2_f32_bf16 v46, v105, v21, v46
    v_dot2_f32_bf16 v47, v109, v21, v47
    v_dot2_f32_bf16 v44, v98, v22, v44
    v_dot2_f32_bf16 v45, v102, v22, v45
    v_dot2_f32_bf16 v46, v106, v22, v46
    v_dot2_f32_bf16 v47, v110, v22, v47
    v_dot2_f32_bf16 v44, v99, v23, v44
    v_dot2_f32_bf16 v45, v103, v23, v45
    v_dot2_f32_bf16 v46, v107, v23, v46
    v_dot2_f32_bf16 v47, v111, v23, v47
    s_waitcnt vmcnt(7)
    buffer_load_dwordx4 v[96:99], v128, s[32:35], s52 offen nt
    s_waitcnt vmcnt(6)
    buffer_load_dwordx4 v[100:103], v129, s[32:35], s52 offen nt
    buffer_load_dwordx4 a[48:51], v2, s[36:39], s58 offen
    s_add_u32 s58, s58, 32768
    v_dot2_f32_bf16 v48, v112, v20, 0
    v_dot2_f32_bf16 v49, v116, v20, 0
    v_dot2_f32_bf16 v50, v120, v20, 0
    v_dot2_f32_bf16 v51, v124, v20, 0
    v_dot2_f32_bf16 v48, v113, v21, v48
    v_dot2_f32_bf16 v49, v117, v21, v49
    v_dot2_f32_bf16 v50, v121, v21, v50
    v_dot2_f32_bf16 v51, v125, v21, v51
    v_dot2_f32_bf16 v48, v114, v22, v48
    v_dot2_f32_bf16 v49, v118, v22, v49
    v_dot2_f32_bf16 v50, v122, v22, v50
    v_dot2_f32_bf16 v51, v126, v22, v51
    v_dot2_f32_bf16 v48, v115, v23, v48
    v_dot2_f32_bf16 v49, v119, v23, v49
    v_dot2_f32_bf16 v50, v123, v23, v50
    v_dot2_f32_bf16 v51, v127, v23, v51
    s_waitcnt vmcnt(7)
    buffer_load_dwordx4 v[104:107], v130, s[32:35], s52 offen nt
    s_waitcnt vmcnt(6)
    buffer_load_dwordx4 v[108:111], v131, s[32:35], s52 offen nt
    buffer_load_dwordx4 a[52:55], v2, s[36:39], s58 offen
    s_add_u32 s58, s58, 32768
    v_add_f32_dpp v44, v44, v44 row_ror:8 row_mask:0xf bank_mask:0x3
    v_add_f32_dpp v48, v48, v48 row_ror:8 row_mask:0xf bank_mask:0x3
    v_add_f32_dpp v45, v45, v45 row_ror:8 row_mask:0xf bank_mask:0x3
    v_add_f32_dpp v49, v49, v49 row_ror:8 row_mask:0xf bank_mask:0x3
    v_add_f32_dpp v44, v46, v46 row_ror:8 row_mask:0xf bank_mask:0xc
    v_add_f32_dpp v48, v50, v50 row_ror:8 row_mask:0xf bank_mask:0xc
    v_add_f32_dpp v45, v47, v47 row_ror:8 row_mask:0xf bank_mask:0xc
    v_add_f32_dpp v49, v51, v51 row_ror:8 row_mask:0xf bank_mask:0xc
    v_add_f32_dpp v44, v44, v44 row_half_mirror row_mask:0xf bank_mask:0x5
    v_add_f32_dpp v48, v48, v48 row_half_mirror row_mask:0xf bank_mask:0x5
    s_nop 0
    v_add_f32_dpp v44, v45, v45 row_half_mirror row_mask:0xf bank_mask:0xa
    v_add_f32_dpp v48, v49, v49 row_half_mirror row_mask:0xf bank_mask:0xa
    s_nop 0
    v_add_f32_dpp v44, v44, v44 quad_perm:[1,0,3,2] row_mask:0xf bank_mask:0xf
    v_add_f32_dpp v48, v48, v48 quad_perm:[1,0,3,2] row_mask:0xf bank_mask:0xf
    s_nop 0
    v_add_f32_dpp v44, v44, v44 quad_perm:[2,3,0,1] row_mask:0xf bank_mask:0xf
    v_add_f32_dpp v48, v48, v48 quad_perm:[2,3,0,1] row_mask:0xf bank_mask:0xf
    s_waitcnt vmcnt(7)
    buffer_load_dwordx4 v[112:115], v132, s[32:35], s52 offen nt
    s_waitcnt vmcnt(6)
    buffer_load_dwordx4 v[116:119], v133, s[32:35], s52 offen nt
    buffer_load_dwordx4 a[56:59], v2, s[36:39], s58 offen
    s_cmp_eq_u32 s71, 5
    s_cselect_b32 s63, 0xffec8000, s72
    s_add_u32 s58, s58, s63
    v_cndmask_b32 v138, v138, v44, s[66:67]
    v_cndmask_b32 v138, v138, v48, s[68:69]
    s_waitcnt vmcnt(7)
    buffer_load_dwordx4 v[120:123], v134, s[32:35], s52 offen nt
    s_waitcnt vmcnt(6)
    buffer_load_dwordx4 v[124:127], v135, s[32:35], s52 offen nt
    buffer_load_dwordx4 a[60:63], v2, s[36:39], s58 offen
    s_add_u32 s58, s58, 32768
    s_add_u32 s51, s51, 0x20000
    s_add_u32 s52, s52, 0x20000
    v_dot2_f32_bf16 v44, v64, v20, 0
    v_dot2_f32_bf16 v45, v68, v20, 0
    v_dot2_f32_bf16 v46, v72, v20, 0
    v_dot2_f32_bf16 v47, v76, v20, 0
    v_dot2_f32_bf16 v44, v65, v21, v44
    v_dot2_f32_bf16 v45, v69, v21, v45
    v_dot2_f32_bf16 v46, v73, v21, v46
    v_dot2_f32_bf16 v47, v77, v21, v47
    v_dot2_f32_bf16 v44, v66, v22, v44
    v_dot2_f32_bf16 v45, v70, v22, v45
    v_dot2_f32_bf16 v46, v74, v22, v46
    v_dot2_f32_bf16 v47, v78, v22, v47
    v_dot2_f32_bf16 v44, v67, v23, v44
    v_dot2_f32_bf16 v45, v71, v23, v45
    v_dot2_f32_bf16 v46, v75, v23, v46
    v_dot2_f32_bf16 v47, v79, v23, v47
    s_waitcnt vmcnt(7)
    buffer_load_dwordx4 v[64:67], v128, s[32:35], s51 offen nt
    s_waitcnt vmcnt(6)
    buffer_load_dwordx4 v[68:71], v129, s[32:35], s51 offen nt
    buffer_load_dwordx4 a[64:67], v2, s[36:39], s58 offen
    s_add_u32 s58, s58, 32768
    v_dot2_f32_bf16 v48, v80, v20, 0
    v_dot2_f32_bf16 v49, v84, v20, 0
    v_dot2_f32_bf16 v50, v88, v20, 0
    v_dot2_f32_bf16 v51, v92, v20, 0
    v_dot2_f32_bf16 v48, v81, v21, v48
    v_dot2_f32_bf16 v49, v85, v21, v49
    v_dot2_f32_bf16 v50, v89, v21, v50
    v_dot2_f32_bf16 v51, v93, v21, v51
    v_dot2_f32_bf16 v48, v82, v22, v48
    v_dot2_f32_bf16 v49, v86, v22, v49
    v_dot2_f32_bf16 v50, v90, v22, v50
    v_dot2_f32_bf16 v51, v94, v22, v51
    v_dot2_f32_bf16 v48, v83, v23, v48
    v_dot2_f32_bf16 v49, v87, v23, v49
    v_dot2_f32_bf16 v50, v91, v23, v50
    v_dot2_f32_bf16 v51, v95, v23, v51
    s_waitcnt vmcnt(7)
    buffer_load_dwordx4 v[72:75], v130, s[32:35], s51 offen nt
    s_waitcnt vmcnt(6)
    buffer_load_dwordx4 v[76:79], v131, s[32:35], s51 offen nt
    buffer_load_dwordx4 a[68:71], v2, s[36:39], s58 offen
    s_add_u32 s58, s58, 32768
    v_add_f32_dpp v44, v44, v44 row_ror:8 row_mask:0xf bank_mask:0x3
    v_add_f32_dpp v48, v48, v48 row_ror:8 row_mask:0xf bank_mask:0x3
    v_add_f32_dpp v45, v45, v45 row_ror:8 row_mask:0xf bank_mask:0x3
    v_add_f32_dpp v49, v49, v49 row_ror:8 row_mask:0xf bank_mask:0x3
    v_add_f32_dpp v44, v46, v46 row_ror:8 row_mask:0xf bank_mask:0xc
    v_add_f32_dpp v48, v50, v50 row_ror:8 row_mask:0xf bank_mask:0xc
    v_add_f32_dpp v45, v47, v47 row_ror:8 row_mask:0xf bank_mask:0xc
    v_add_f32_dpp v49, v51, v51 row_ror:8 row_mask:0xf bank_mask:0xc
    v_add_f32_dpp v44, v44, v44 row_half_mirror row_mask:0xf bank_mask:0x5
    v_add_f32_dpp v48, v48, v48 row_half_mirror row_mask:0xf bank_mask:0x5
    s_nop 0
    v_add_f32_dpp v44, v45, v45 row_half_mirror row_mask:0xf bank_mask:0xa
    v_add_f32_dpp v48, v49, v49 row_half_mirror row_mask:0xf bank_mask:0xa
    s_nop 0
    v_add_f32_dpp v44, v44, v44 quad_perm:[1,0,3,2] row_mask:0xf bank_mask:0xf
    v_add_f32_dpp v48, v48, v48 quad_perm:[1,0,3,2] row_mask:0xf bank_mask:0xf
    s_nop 0
    v_add_f32_dpp v44, v44, v44 quad_perm:[2,3,0,1] row_mask:0xf bank_mask:0xf
    v_add_f32_dpp v48, v48, v48 quad_perm:[2,3,0,1] row_mask:0xf bank_mask:0xf
    s_waitcnt vmcnt(7)
    buffer_load_dwordx4 v[80:83], v132, s[32:35], s51 offen nt
    s_waitcnt vmcnt(6)
    buffer_load_dwordx4 v[84:87], v133, s[32:35], s51 offen nt
    buffer_load_dwordx4 a[72:75], v2, s[36:39], s58 offen
    s_add_u32 s58, s58, 32768
    v_cndmask_b32 v139, v44, v48, s[64:65]
    s_waitcnt vmcnt(7)
    buffer_load_dwordx4 v[88:91], v134, s[32:35], s51 offen nt
    s_waitcnt vmcnt(6)
    buffer_load_dwordx4 v[92:95], v135, s[32:35], s51 offen nt
    buffer_load_dwordx4 a[76:79], v2, s[36:39], s58 offen
    s_cmp_eq_u32 s71, 4
    s_cselect_b32 s63, 0xffec8000, s72
    s_add_u32 s58, s58, s63
    v_dot2_f32_bf16 v44, v96, v20, 0
    v_dot2_f32_bf16 v45, v100, v20, 0
    v_dot2_f32_bf16 v46, v104, v20, 0
    v_dot2_f32_bf16 v47, v108, v20, 0
    v_dot2_f32_bf16 v44, v97, v21, v44
    v_dot2_f32_bf16 v45, v101, v21, v45
    v_dot2_f32_bf16 v46, v105, v21, v46
    v_dot2_f32_bf16 v47, v109, v21, v47
    v_dot2_f32_bf16 v44, v98, v22, v44
    v_dot2_f32_bf16 v45, v102, v22, v45
    v_dot2_f32_bf16 v46, v106, v22, v46
    v_dot2_f32_bf16 v47, v110, v22, v47
    v_dot2_f32_bf16 v44, v99, v23, v44
    v_dot2_f32_bf16 v45, v103, v23, v45
    v_dot2_f32_bf16 v46, v107, v23, v46
    v_dot2_f32_bf16 v47, v111, v23, v47
    s_waitcnt vmcnt(7)
    buffer_load_dwordx4 v[96:99], v128, s[32:35], s52 offen nt
    s_waitcnt vmcnt(6)
    buffer_load_dwordx4 v[100:103], v129, s[32:35], s52 offen nt
    buffer_load_dwordx4 a[80:83], v2, s[36:39], s58 offen
    s_add_u32 s58, s58, 32768
    v_dot2_f32_bf16 v48, v112, v20, 0
    v_dot2_f32_bf16 v49, v116, v20, 0
    v_dot2_f32_bf16 v50, v120, v20, 0
    v_dot2_f32_bf16 v51, v124, v20, 0
    v_dot2_f32_bf16 v48, v113, v21, v48
    v_dot2_f32_bf16 v49, v117, v21, v49
    v_dot2_f32_bf16 v50, v121, v21, v50
    v_dot2_f32_bf16 v51, v125, v21, v51
    v_dot2_f32_bf16 v48, v114, v22, v48
    v_dot2_f32_bf16 v49, v118, v22, v49
    v_dot2_f32_bf16 v50, v122, v22, v50
    v_dot2_f32_bf16 v51, v126, v22, v51
    v_dot2_f32_bf16 v48, v115, v23, v48
    v_dot2_f32_bf16 v49, v119, v23, v49
    v_dot2_f32_bf16 v50, v123, v23, v50
    v_dot2_f32_bf16 v51, v127, v23, v51
    s_waitcnt vmcnt(7)
    buffer_load_dwordx4 v[104:107], v130, s[32:35], s52 offen nt
    s_waitcnt vmcnt(6)
    buffer_load_dwordx4 v[108:111], v131, s[32:35], s52 offen nt
    buffer_load_dwordx4 a[84:87], v2, s[36:39], s58 offen
    s_add_u32 s58, s58, 32768
    v_add_f32_dpp v44, v44, v44 row_ror:8 row_mask:0xf bank_mask:0x3
    v_add_f32_dpp v48, v48, v48 row_ror:8 row_mask:0xf bank_mask:0x3
    v_add_f32_dpp v45, v45, v45 row_ror:8 row_mask:0xf bank_mask:0x3
    v_add_f32_dpp v49, v49, v49 row_ror:8 row_mask:0xf bank_mask:0x3
    v_add_f32_dpp v44, v46, v46 row_ror:8 row_mask:0xf bank_mask:0xc
    v_add_f32_dpp v48, v50, v50 row_ror:8 row_mask:0xf bank_mask:0xc
    v_add_f32_dpp v45, v47, v47 row_ror:8 row_mask:0xf bank_mask:0xc
    v_add_f32_dpp v49, v51, v51 row_ror:8 row_mask:0xf bank_mask:0xc
    v_add_f32_dpp v44, v44, v44 row_half_mirror row_mask:0xf bank_mask:0x5
    v_add_f32_dpp v48, v48, v48 row_half_mirror row_mask:0xf bank_mask:0x5
    s_nop 0
    v_add_f32_dpp v44, v45, v45 row_half_mirror row_mask:0xf bank_mask:0xa
    v_add_f32_dpp v48, v49, v49 row_half_mirror row_mask:0xf bank_mask:0xa
    s_nop 0
    v_add_f32_dpp v44, v44, v44 quad_perm:[1,0,3,2] row_mask:0xf bank_mask:0xf
    v_add_f32_dpp v48, v48, v48 quad_perm:[1,0,3,2] row_mask:0xf bank_mask:0xf
    s_nop 0
    v_add_f32_dpp v44, v44, v44 quad_perm:[2,3,0,1] row_mask:0xf bank_mask:0xf
    v_add_f32_dpp v48, v48, v48 quad_perm:[2,3,0,1] row_mask:0xf bank_mask:0xf
    s_waitcnt vmcnt(7)
    buffer_load_dwordx4 v[112:115], v132, s[32:35], s52 offen nt
    s_waitcnt vmcnt(6)
    buffer_load_dwordx4 v[116:119], v133, s[32:35], s52 offen nt
    buffer_load_dwordx4 a[88:91], v2, s[36:39], s58 offen
    s_add_u32 s58, s58, 32768
    v_cndmask_b32 v139, v139, v44, s[66:67]
    v_cndmask_b32 v139, v139, v48, s[68:69]
    s_waitcnt vmcnt(7)
    buffer_load_dwordx4 v[120:123], v134, s[32:35], s52 offen nt
    s_waitcnt vmcnt(6)
    buffer_load_dwordx4 v[124:127], v135, s[32:35], s52 offen nt
    buffer_load_dwordx4 a[92:95], v2, s[36:39], s58 offen
    s_add_u32 s58, s58, 32768
    v_not_b32 v240, v240
    v_not_b32 v241, v241
    v_not_b32 v242, v242
    v_not_b32 v243, v243
    v_not_b32 v244, v244
    v_not_b32 v245, v245
    v_not_b32 v246, v246
    v_not_b32 v247, v247
    v_and_b32 v204, 1, v204
    v_and_b32 v205, 1, v205
    v_and_b32 v206, 1, v206
    v_and_b32 v207, 1, v207
    v_lshl_or_b32 v204, v205, 1, v204
    v_lshl_or_b32 v206, v207, 1, v206
    v_lshl_or_b32 v204, v206, 2, v204
    v_not_b32 v204, v204
    s_nop 0
    v_readfirstlane_b32 s70, v204
    s_add_u32 s51, s51, 0x20000
    s_add_u32 s52, s52, 0x20000
    v_dot2_f32_bf16 v44, v64, v20, 0
    v_dot2_f32_bf16 v45, v68, v20, 0
    v_dot2_f32_bf16 v46, v72, v20, 0
    v_dot2_f32_bf16 v47, v76, v20, 0
    v_dot2_f32_bf16 v44, v65, v21, v44
    v_dot2_f32_bf16 v45, v69, v21, v45
    v_dot2_f32_bf16 v46, v73, v21, v46
    v_dot2_f32_bf16 v47, v77, v21, v47
    v_dot2_f32_bf16 v44, v66, v22, v44
    v_dot2_f32_bf16 v45, v70, v22, v45
    v_dot2_f32_bf16 v46, v74, v22, v46
    v_dot2_f32_bf16 v47, v78, v22, v47
    v_dot2_f32_bf16 v44, v67, v23, v44
    v_dot2_f32_bf16 v45, v71, v23, v45
    v_dot2_f32_bf16 v46, v75, v23, v46
    v_dot2_f32_bf16 v47, v79, v23, v47
    s_waitcnt vmcnt(7)
    buffer_load_dwordx4 v[64:67], v128, s[32:35], s51 offen nt
    s_waitcnt vmcnt(6)
    buffer_load_dwordx4 v[68:71], v129, s[32:35], s51 offen nt
    buffer_load_dwordx4 a[96:99], v2, s[36:39], s58 offen
    s_cmp_eq_u32 s71, 3
    s_cselect_b32 s63, 0xffec8000, s72
    s_add_u32 s58, s58, s63
    v_dot2_f32_bf16 v48, v80, v20, 0
    v_dot2_f32_bf16 v49, v84, v20, 0
    v_dot2_f32_bf16 v50, v88, v20, 0
    v_dot2_f32_bf16 v51, v92, v20, 0
    v_dot2_f32_bf16 v48, v81, v21, v48
    v_dot2_f32_bf16 v49, v85, v21, v49
    v_dot2_f32_bf16 v50, v89, v21, v50
    v_dot2_f32_bf16 v51, v93, v21, v51
    v_dot2_f32_bf16 v48, v82, v22, v48
    v_dot2_f32_bf16 v49, v86, v22, v49
    v_dot2_f32_bf16 v50, v90, v22, v50
    v_dot2_f32_bf16 v51, v94, v22, v51
    v_dot2_f32_bf16 v48, v83, v23, v48
    v_dot2_f32_bf16 v49, v87, v23, v49
    v_dot2_f32_bf16 v50, v91, v23, v50
    v_dot2_f32_bf16 v51, v95, v23, v51
    s_waitcnt vmcnt(7)
    buffer_load_dwordx4 v[72:75], v130, s[32:35], s51 offen nt
    s_waitcnt vmcnt(6)
    buffer_load_dwordx4 v[76:79], v131, s[32:35], s51 offen nt
    buffer_load_dwordx4 a[100:103], v2, s[36:39], s58 offen
    s_add_u32 s58, s58, 32768
    v_add_f32_dpp v44, v44, v44 row_ror:8 row_mask:0xf bank_mask:0x3
    v_add_f32_dpp v48, v48, v48 row_ror:8 row_mask:0xf bank_mask:0x3
    v_add_f32_dpp v45, v45, v45 row_ror:8 row_mask:0xf bank_mask:0x3
    v_add_f32_dpp v49, v49, v49 row_ror:8 row_mask:0xf bank_mask:0x3
    v_add_f32_dpp v44, v46, v46 row_ror:8 row_mask:0xf bank_mask:0xc
    v_add_f32_dpp v48, v50, v50 row_ror:8 row_mask:0xf bank_mask:0xc
    v_add_f32_dpp v45, v47, v47 row_ror:8 row_mask:0xf bank_mask:0xc
    v_add_f32_dpp v49, v51, v51 row_ror:8 row_mask:0xf bank_mask:0xc
    v_add_f32_dpp v44, v44, v44 row_half_mirror row_mask:0xf bank_mask:0x5
    v_add_f32_dpp v48, v48, v48 row_half_mirror row_mask:0xf bank_mask:0x5
    s_nop 0
    v_add_f32_dpp v44, v45, v45 row_half_mirror row_mask:0xf bank_mask:0xa
    v_add_f32_dpp v48, v49, v49 row_half_mirror row_mask:0xf bank_mask:0xa
    s_nop 0
    v_add_f32_dpp v44, v44, v44 quad_perm:[1,0,3,2] row_mask:0xf bank_mask:0xf
    v_add_f32_dpp v48, v48, v48 quad_perm:[1,0,3,2] row_mask:0xf bank_mask:0xf
    s_nop 0
    v_add_f32_dpp v44, v44, v44 quad_perm:[2,3,0,1] row_mask:0xf bank_mask:0xf
    v_add_f32_dpp v48, v48, v48 quad_perm:[2,3,0,1] row_mask:0xf bank_mask:0xf
    s_waitcnt vmcnt(7)
    buffer_load_dwordx4 v[80:83], v132, s[32:35], s51 offen nt
    s_waitcnt vmcnt(6)
    buffer_load_dwordx4 v[84:87], v133, s[32:35], s51 offen nt
    buffer_load_dwordx4 a[104:107], v2, s[36:39], s58 offen
    s_add_u32 s58, s58, 32768
    v_cndmask_b32 v140, v44, v48, s[64:65]
    s_waitcnt vmcnt(7)
    buffer_load_dwordx4 v[88:91], v134, s[32:35], s51 offen nt
    s_waitcnt vmcnt(6)
    buffer_load_dwordx4 v[92:95], v135, s[32:35], s51 offen nt
    buffer_load_dwordx4 a[108:111], v2, s[36:39], s58 offen
    s_add_u32 s58, s58, 32768
    v_dot2_f32_bf16 v44, v96, v20, 0
    v_dot2_f32_bf16 v45, v100, v20, 0
    v_dot2_f32_bf16 v46, v104, v20, 0
    v_dot2_f32_bf16 v47, v108, v20, 0
    v_dot2_f32_bf16 v44, v97, v21, v44
    v_dot2_f32_bf16 v45, v101, v21, v45
    v_dot2_f32_bf16 v46, v105, v21, v46
    v_dot2_f32_bf16 v47, v109, v21, v47
    v_dot2_f32_bf16 v44, v98, v22, v44
    v_dot2_f32_bf16 v45, v102, v22, v45
    v_dot2_f32_bf16 v46, v106, v22, v46
    v_dot2_f32_bf16 v47, v110, v22, v47
    v_dot2_f32_bf16 v44, v99, v23, v44
    v_dot2_f32_bf16 v45, v103, v23, v45
    v_dot2_f32_bf16 v46, v107, v23, v46
    v_dot2_f32_bf16 v47, v111, v23, v47
    s_waitcnt vmcnt(7)
    buffer_load_dwordx4 v[96:99], v128, s[32:35], s52 offen nt
    s_waitcnt vmcnt(6)
    buffer_load_dwordx4 v[100:103], v129, s[32:35], s52 offen nt
    buffer_load_dwordx4 a[112:115], v2, s[36:39], s58 offen
    s_add_u32 s58, s58, 32768
    v_dot2_f32_bf16 v48, v112, v20, 0
    v_dot2_f32_bf16 v49, v116, v20, 0
    v_dot2_f32_bf16 v50, v120, v20, 0
    v_dot2_f32_bf16 v51, v124, v20, 0
    v_dot2_f32_bf16 v48, v113, v21, v48
    v_dot2_f32_bf16 v49, v117, v21, v49
    v_dot2_f32_bf16 v50, v121, v21, v50
    v_dot2_f32_bf16 v51, v125, v21, v51
    v_dot2_f32_bf16 v48, v114, v22, v48
    v_dot2_f32_bf16 v49, v118, v22, v49
    v_dot2_f32_bf16 v50, v122, v22, v50
    v_dot2_f32_bf16 v51, v126, v22, v51
    v_dot2_f32_bf16 v48, v115, v23, v48
    v_dot2_f32_bf16 v49, v119, v23, v49
    v_dot2_f32_bf16 v50, v123, v23, v50
    v_dot2_f32_bf16 v51, v127, v23, v51
    s_waitcnt vmcnt(7)
    buffer_load_dwordx4 v[104:107], v130, s[32:35], s52 offen nt
    s_waitcnt vmcnt(6)
    buffer_load_dwordx4 v[108:111], v131, s[32:35], s52 offen nt
    buffer_load_dwordx4 a[116:119], v2, s[36:39], s58 offen
    s_cmp_eq_u32 s71, 2
    s_cselect_b32 s63, 0xffec8000, s72
    s_add_u32 s58, s58, s63
    v_add_f32_dpp v44, v44, v44 row_ror:8 row_mask:0xf bank_mask:0x3
    v_add_f32_dpp v48, v48, v48 row_ror:8 row_mask:0xf bank_mask:0x3
    v_add_f32_dpp v45, v45, v45 row_ror:8 row_mask:0xf bank_mask:0x3
    v_add_f32_dpp v49, v49, v49 row_ror:8 row_mask:0xf bank_mask:0x3
    v_add_f32_dpp v44, v46, v46 row_ror:8 row_mask:0xf bank_mask:0xc
    v_add_f32_dpp v48, v50, v50 row_ror:8 row_mask:0xf bank_mask:0xc
    v_add_f32_dpp v45, v47, v47 row_ror:8 row_mask:0xf bank_mask:0xc
    v_add_f32_dpp v49, v51, v51 row_ror:8 row_mask:0xf bank_mask:0xc
    v_add_f32_dpp v44, v44, v44 row_half_mirror row_mask:0xf bank_mask:0x5
    v_add_f32_dpp v48, v48, v48 row_half_mirror row_mask:0xf bank_mask:0x5
    s_nop 0
    v_add_f32_dpp v44, v45, v45 row_half_mirror row_mask:0xf bank_mask:0xa
    v_add_f32_dpp v48, v49, v49 row_half_mirror row_mask:0xf bank_mask:0xa
    s_nop 0
    v_add_f32_dpp v44, v44, v44 quad_perm:[1,0,3,2] row_mask:0xf bank_mask:0xf
    v_add_f32_dpp v48, v48, v48 quad_perm:[1,0,3,2] row_mask:0xf bank_mask:0xf
    s_nop 0
    v_add_f32_dpp v44, v44, v44 quad_perm:[2,3,0,1] row_mask:0xf bank_mask:0xf
    v_add_f32_dpp v48, v48, v48 quad_perm:[2,3,0,1] row_mask:0xf bank_mask:0xf
    s_waitcnt vmcnt(7)
    buffer_load_dwordx4 v[112:115], v132, s[32:35], s52 offen nt
    s_waitcnt vmcnt(6)
    buffer_load_dwordx4 v[116:119], v133, s[32:35], s52 offen nt
    buffer_load_dwordx4 a[120:123], v2, s[36:39], s58 offen
    s_add_u32 s58, s58, 32768
    v_cndmask_b32 v140, v140, v44, s[66:67]
    v_cndmask_b32 v140, v140, v48, s[68:69]
    s_waitcnt vmcnt(7)
    buffer_load_dwordx4 v[120:123], v134, s[32:35], s52 offen nt
    s_waitcnt vmcnt(6)
    buffer_load_dwordx4 v[124:127], v135, s[32:35], s52 offen nt
    buffer_load_dwordx4 a[124:127], v2, s[36:39], s58 offen
    s_add_u32 s58, s58, 32768
    s_add_u32 s51, s51, 0x20000
    s_add_u32 s52, s52, 0x20000
    v_dot2_f32_bf16 v44, v64, v20, 0
    v_dot2_f32_bf16 v45, v68, v20, 0
    v_dot2_f32_bf16 v46, v72, v20, 0
    v_dot2_f32_bf16 v47, v76, v20, 0
    v_dot2_f32_bf16 v44, v65, v21, v44
    v_dot2_f32_bf16 v45, v69, v21, v45
    v_dot2_f32_bf16 v46, v73, v21, v46
    v_dot2_f32_bf16 v47, v77, v21, v47
    v_dot2_f32_bf16 v44, v66, v22, v44
    v_dot2_f32_bf16 v45, v70, v22, v45
    v_dot2_f32_bf16 v46, v74, v22, v46
    v_dot2_f32_bf16 v47, v78, v22, v47
    v_dot2_f32_bf16 v44, v67, v23, v44
    v_dot2_f32_bf16 v45, v71, v23, v45
    v_dot2_f32_bf16 v46, v75, v23, v46
    v_dot2_f32_bf16 v47, v79, v23, v47
    s_waitcnt vmcnt(7)
    buffer_load_dwordx4 v[64:67], v128, s[32:35], s51 offen nt
    s_waitcnt vmcnt(6)
    buffer_load_dwordx4 v[68:71], v129, s[32:35], s51 offen nt
    buffer_load_dwordx4 a[128:131], v2, s[36:39], s58 offen
    s_add_u32 s58, s58, 32768
    v_dot2_f32_bf16 v48, v80, v20, 0
    v_dot2_f32_bf16 v49, v84, v20, 0
    v_dot2_f32_bf16 v50, v88, v20, 0
    v_dot2_f32_bf16 v51, v92, v20, 0
    v_dot2_f32_bf16 v48, v81, v21, v48
    v_dot2_f32_bf16 v49, v85, v21, v49
    v_dot2_f32_bf16 v50, v89, v21, v50
    v_dot2_f32_bf16 v51, v93, v21, v51
    v_dot2_f32_bf16 v48, v82, v22, v48
    v_dot2_f32_bf16 v49, v86, v22, v49
    v_dot2_f32_bf16 v50, v90, v22, v50
    v_dot2_f32_bf16 v51, v94, v22, v51
    v_dot2_f32_bf16 v48, v83, v23, v48
    v_dot2_f32_bf16 v49, v87, v23, v49
    v_dot2_f32_bf16 v50, v91, v23, v50
    v_dot2_f32_bf16 v51, v95, v23, v51
    s_waitcnt vmcnt(7)
    buffer_load_dwordx4 v[72:75], v130, s[32:35], s51 offen nt
    s_waitcnt vmcnt(6)
    buffer_load_dwordx4 v[76:79], v131, s[32:35], s51 offen nt
    buffer_load_dwordx4 a[132:135], v2, s[36:39], s58 offen
    s_add_u32 s58, s58, 32768
    v_add_f32_dpp v44, v44, v44 row_ror:8 row_mask:0xf bank_mask:0x3
    v_add_f32_dpp v48, v48, v48 row_ror:8 row_mask:0xf bank_mask:0x3
    v_add_f32_dpp v45, v45, v45 row_ror:8 row_mask:0xf bank_mask:0x3
    v_add_f32_dpp v49, v49, v49 row_ror:8 row_mask:0xf bank_mask:0x3
    v_add_f32_dpp v44, v46, v46 row_ror:8 row_mask:0xf bank_mask:0xc
    v_add_f32_dpp v48, v50, v50 row_ror:8 row_mask:0xf bank_mask:0xc
    v_add_f32_dpp v45, v47, v47 row_ror:8 row_mask:0xf bank_mask:0xc
    v_add_f32_dpp v49, v51, v51 row_ror:8 row_mask:0xf bank_mask:0xc
    v_add_f32_dpp v44, v44, v44 row_half_mirror row_mask:0xf bank_mask:0x5
    v_add_f32_dpp v48, v48, v48 row_half_mirror row_mask:0xf bank_mask:0x5
    s_nop 0
    v_add_f32_dpp v44, v45, v45 row_half_mirror row_mask:0xf bank_mask:0xa
    v_add_f32_dpp v48, v49, v49 row_half_mirror row_mask:0xf bank_mask:0xa
    s_nop 0
    v_add_f32_dpp v44, v44, v44 quad_perm:[1,0,3,2] row_mask:0xf bank_mask:0xf
    v_add_f32_dpp v48, v48, v48 quad_perm:[1,0,3,2] row_mask:0xf bank_mask:0xf
    s_nop 0
    v_add_f32_dpp v44, v44, v44 quad_perm:[2,3,0,1] row_mask:0xf bank_mask:0xf
    v_add_f32_dpp v48, v48, v48 quad_perm:[2,3,0,1] row_mask:0xf bank_mask:0xf
    s_waitcnt vmcnt(7)
    buffer_load_dwordx4 v[80:83], v132, s[32:35], s51 offen nt
    s_waitcnt vmcnt(6)
    buffer_load_dwordx4 v[84:87], v133, s[32:35], s51 offen nt
    buffer_load_dwordx4 a[136:139], v2, s[36:39], s58 offen
    s_cmp_eq_u32 s71, 1
    s_cselect_b32 s63, 0xffec8000, s72
    s_add_u32 s58, s58, s63
    v_cndmask_b32 v141, v44, v48, s[64:65]
    s_waitcnt vmcnt(7)
    buffer_load_dwordx4 v[88:91], v134, s[32:35], s51 offen nt
    s_waitcnt vmcnt(6)
    buffer_load_dwordx4 v[92:95], v135, s[32:35], s51 offen nt
    buffer_load_dwordx4 a[140:143], v2, s[36:39], s58 offen
    s_add_u32 s58, s58, 32768
    v_dot2_f32_bf16 v44, v96, v20, 0
    v_dot2_f32_bf16 v45, v100, v20, 0
    v_dot2_f32_bf16 v46, v104, v20, 0
    v_dot2_f32_bf16 v47, v108, v20, 0
    v_dot2_f32_bf16 v44, v97, v21, v44
    v_dot2_f32_bf16 v45, v101, v21, v45
    v_dot2_f32_bf16 v46, v105, v21, v46
    v_dot2_f32_bf16 v47, v109, v21, v47
    v_dot2_f32_bf16 v44, v98, v22, v44
    v_dot2_f32_bf16 v45, v102, v22, v45
    v_dot2_f32_bf16 v46, v106, v22, v46
    v_dot2_f32_bf16 v47, v110, v22, v47
    v_dot2_f32_bf16 v44, v99, v23, v44
    v_dot2_f32_bf16 v45, v103, v23, v45
    v_dot2_f32_bf16 v46, v107, v23, v46
    v_dot2_f32_bf16 v47, v111, v23, v47
    s_waitcnt vmcnt(7)
    buffer_load_dwordx4 v[96:99], v128, s[32:35], s52 offen nt
    s_waitcnt vmcnt(6)
    buffer_load_dwordx4 v[100:103], v129, s[32:35], s52 offen nt
    buffer_load_dwordx4 a[144:147], v2, s[36:39], s58 offen
    s_add_u32 s58, s58, 32768
    v_dot2_f32_bf16 v48, v112, v20, 0
    v_dot2_f32_bf16 v49, v116, v20, 0
    v_dot2_f32_bf16 v50, v120, v20, 0
    v_dot2_f32_bf16 v51, v124, v20, 0
    v_dot2_f32_bf16 v48, v113, v21, v48
    v_dot2_f32_bf16 v49, v117, v21, v49
    v_dot2_f32_bf16 v50, v121, v21, v50
    v_dot2_f32_bf16 v51, v125, v21, v51
    v_dot2_f32_bf16 v48, v114, v22, v48
    v_dot2_f32_bf16 v49, v118, v22, v49
    v_dot2_f32_bf16 v50, v122, v22, v50
    v_dot2_f32_bf16 v51, v126, v22, v51
    v_dot2_f32_bf16 v48, v115, v23, v48
    v_dot2_f32_bf16 v49, v119, v23, v49
    v_dot2_f32_bf16 v50, v123, v23, v50
    v_dot2_f32_bf16 v51, v127, v23, v51
    s_waitcnt vmcnt(7)
    buffer_load_dwordx4 v[104:107], v130, s[32:35], s52 offen nt
    s_waitcnt vmcnt(6)
    buffer_load_dwordx4 v[108:111], v131, s[32:35], s52 offen nt
    buffer_load_dwordx4 a[148:151], v2, s[36:39], s58 offen
    s_add_u32 s58, s58, 32768
    v_add_f32_dpp v44, v44, v44 row_ror:8 row_mask:0xf bank_mask:0x3
    v_add_f32_dpp v48, v48, v48 row_ror:8 row_mask:0xf bank_mask:0x3
    v_add_f32_dpp v45, v45, v45 row_ror:8 row_mask:0xf bank_mask:0x3
    v_add_f32_dpp v49, v49, v49 row_ror:8 row_mask:0xf bank_mask:0x3
    v_add_f32_dpp v44, v46, v46 row_ror:8 row_mask:0xf bank_mask:0xc
    v_add_f32_dpp v48, v50, v50 row_ror:8 row_mask:0xf bank_mask:0xc
    v_add_f32_dpp v45, v47, v47 row_ror:8 row_mask:0xf bank_mask:0xc
    v_add_f32_dpp v49, v51, v51 row_ror:8 row_mask:0xf bank_mask:0xc
    v_add_f32_dpp v44, v44, v44 row_half_mirror row_mask:0xf bank_mask:0x5
    v_add_f32_dpp v48, v48, v48 row_half_mirror row_mask:0xf bank_mask:0x5
    s_nop 0
    v_add_f32_dpp v44, v45, v45 row_half_mirror row_mask:0xf bank_mask:0xa
    v_add_f32_dpp v48, v49, v49 row_half_mirror row_mask:0xf bank_mask:0xa
    s_nop 0
    v_add_f32_dpp v44, v44, v44 quad_perm:[1,0,3,2] row_mask:0xf bank_mask:0xf
    v_add_f32_dpp v48, v48, v48 quad_perm:[1,0,3,2] row_mask:0xf bank_mask:0xf
    s_nop 0
    v_add_f32_dpp v44, v44, v44 quad_perm:[2,3,0,1] row_mask:0xf bank_mask:0xf
    v_add_f32_dpp v48, v48, v48 quad_perm:[2,3,0,1] row_mask:0xf bank_mask:0xf
    s_waitcnt vmcnt(7)
    buffer_load_dwordx4 v[112:115], v132, s[32:35], s52 offen nt
    s_waitcnt vmcnt(6)
    buffer_load_dwordx4 v[116:119], v133, s[32:35], s52 offen nt
    buffer_load_dwordx4 a[152:155], v2, s[36:39], s58 offen
    s_add_u32 s58, s58, 32768
    v_cndmask_b32 v141, v141, v44, s[66:67]
    v_cndmask_b32 v141, v141, v48, s[68:69]
    s_waitcnt vmcnt(7)
    buffer_load_dwordx4 v[120:123], v134, s[32:35], s52 offen nt
    s_waitcnt vmcnt(6)
    buffer_load_dwordx4 v[124:127], v135, s[32:35], s52 offen nt
    buffer_load_dwordx4 a[156:159], v2, s[36:39], s58 offen
    s_add_u32 s51, s51, 0x20000
    s_add_u32 s52, s52, 0x20000
    v_dot2_f32_bf16 v44, v64, v20, 0
    v_dot2_f32_bf16 v45, v68, v20, 0
    v_dot2_f32_bf16 v46, v72, v20, 0
    v_dot2_f32_bf16 v47, v76, v20, 0
    v_dot2_f32_bf16 v44, v65, v21, v44
    v_dot2_f32_bf16 v45, v69, v21, v45
    v_dot2_f32_bf16 v46, v73, v21, v46
    v_dot2_f32_bf16 v47, v77, v21, v47
    v_dot2_f32_bf16 v44, v66, v22, v44
    v_dot2_f32_bf16 v45, v70, v22, v45
    v_dot2_f32_bf16 v46, v74, v22, v46
    v_dot2_f32_bf16 v47, v78, v22, v47
    v_dot2_f32_bf16 v44, v67, v23, v44
    v_dot2_f32_bf16 v45, v71, v23, v45
    v_dot2_f32_bf16 v46, v75, v23, v46
    v_dot2_f32_bf16 v47, v79, v23, v47
    s_waitcnt vmcnt(7)
    buffer_load_dwordx4 v[64:67], v128, s[32:35], s51 offen nt
    v_lshl_or_b32 v59, v59, 16, v59
    v_lshl_or_b32 v60, v60, 16, v60
    v_lshl_or_b32 v61, v61, 16, v61
    v_and_b32_dpp v28, v59, v16 row_newbcast:0 row_mask:0xf bank_mask:0xf
    v_and_b32_dpp v29, v59, v17 row_newbcast:0 row_mask:0xf bank_mask:0xf
    v_and_b32_dpp v30, v59, v18 row_newbcast:0 row_mask:0xf bank_mask:0xf
    v_and_b32_dpp v31, v59, v19 row_newbcast:0 row_mask:0xf bank_mask:0xf
    s_waitcnt vmcnt(6)
    buffer_load_dwordx4 v[68:71], v129, s[32:35], s51 offen nt
    v_and_b32_dpp v32, v59, v16 row_newbcast:1 row_mask:0xf bank_mask:0xf
    v_and_b32_dpp v33, v59, v17 row_newbcast:1 row_mask:0xf bank_mask:0xf
    v_and_b32_dpp v34, v59, v18 row_newbcast:1 row_mask:0xf bank_mask:0xf
    v_and_b32_dpp v35, v59, v19 row_newbcast:1 row_mask:0xf bank_mask:0xf
    v_mfma_f32_16x16x32_bf16 v[40:43], v[28:31], a[0:3], 0
    v_and_b32_dpp v28, v59, v16 row_newbcast:2 row_mask:0xf bank_mask:0xf
    v_and_b32_dpp v29, v59, v17 row_newbcast:2 row_mask:0xf bank_mask:0xf
    v_and_b32_dpp v30, v59, v18 row_newbcast:2 row_mask:0xf bank_mask:0xf
    v_and_b32_dpp v31, v59, v19 row_newbcast:2 row_mask:0xf bank_mask:0xf
    v_mfma_f32_16x16x32_bf16 v[40:43], v[32:35], a[4:7], v[40:43]
    v_and_b32_dpp v32, v59, v16 row_newbcast:3 row_mask:0xf bank_mask:0xf
    v_and_b32_dpp v33, v59, v17 row_newbcast:3 row_mask:0xf bank_mask:0xf
    v_and_b32_dpp v34, v59, v18 row_newbcast:3 row_mask:0xf bank_mask:0xf
    v_and_b32_dpp v35, v59, v19 row_newbcast:3 row_mask:0xf bank_mask:0xf
    v_mfma_f32_16x16x32_bf16 v[40:43], v[28:31], a[8:11], v[40:43]
    v_dot2_f32_bf16 v48, v80, v20, 0
    v_dot2_f32_bf16 v49, v84, v20, 0
    v_dot2_f32_bf16 v50, v88, v20, 0
    v_dot2_f32_bf16 v51, v92, v20, 0
    v_dot2_f32_bf16 v48, v81, v21, v48
    v_dot2_f32_bf16 v49, v85, v21, v49
    v_dot2_f32_bf16 v50, v89, v21, v50
    v_dot2_f32_bf16 v51, v93, v21, v51
    v_dot2_f32_bf16 v48, v82, v22, v48
    v_dot2_f32_bf16 v49, v86, v22, v49
    v_dot2_f32_bf16 v50, v90, v22, v50
    v_dot2_f32_bf16 v51, v94, v22, v51
    v_dot2_f32_bf16 v48, v83, v23, v48
    v_dot2_f32_bf16 v49, v87, v23, v49
    v_dot2_f32_bf16 v50, v91, v23, v50
    v_dot2_f32_bf16 v51, v95, v23, v51
    s_waitcnt vmcnt(6)
    buffer_load_dwordx4 v[72:75], v130, s[32:35], s51 offen nt
    v_and_b32_dpp v28, v59, v16 row_newbcast:4 row_mask:0xf bank_mask:0xf
    v_and_b32_dpp v29, v59, v17 row_newbcast:4 row_mask:0xf bank_mask:0xf
    v_and_b32_dpp v30, v59, v18 row_newbcast:4 row_mask:0xf bank_mask:0xf
    v_and_b32_dpp v31, v59, v19 row_newbcast:4 row_mask:0xf bank_mask:0xf
    v_mfma_f32_16x16x32_bf16 v[40:43], v[32:35], a[12:15], v[40:43]
    v_and_b32_dpp v32, v59, v16 row_newbcast:5 row_mask:0xf bank_mask:0xf
    v_and_b32_dpp v33, v59, v17 row_newbcast:5 row_mask:0xf bank_mask:0xf
    v_and_b32_dpp v34, v59, v18 row_newbcast:5 row_mask:0xf bank_mask:0xf
    v_and_b32_dpp v35, v59, v19 row_newbcast:5 row_mask:0xf bank_mask:0xf
    v_mfma_f32_16x16x32_bf16 v[40:43], v[28:31], a[16:19], v[40:43]
    v_and_b32_dpp v28, v59, v16 row_newbcast:6 row_mask:0xf bank_mask:0xf
    v_and_b32_dpp v29, v59, v17 row_newbcast:6 row_mask:0xf bank_mask:0xf
    v_and_b32_dpp v30, v59, v18 row_newbcast:6 row_mask:0xf bank_mask:0xf
    v_and_b32_dpp v31, v59, v19 row_newbcast:6 row_mask:0xf bank_mask:0xf
    v_mfma_f32_16x16x32_bf16 v[40:43], v[32:35], a[20:23], v[40:43]
    s_waitcnt vmcnt(5)
    buffer_load_dwordx4 v[76:79], v131, s[32:35], s51 offen nt
    v_and_b32_dpp v32, v59, v16 row_newbcast:7 row_mask:0xf bank_mask:0xf
    v_and_b32_dpp v33, v59, v17 row_newbcast:7 row_mask:0xf bank_mask:0xf
    v_and_b32_dpp v34, v59, v18 row_newbcast:7 row_mask:0xf bank_mask:0xf
    v_and_b32_dpp v35, v59, v19 row_newbcast:7 row_mask:0xf bank_mask:0xf
    v_mfma_f32_16x16x32_bf16 v[40:43], v[28:31], a[24:27], v[40:43]
    v_and_b32_dpp v28, v59, v16 row_newbcast:8 row_mask:0xf bank_mask:0xf
    v_and_b32_dpp v29, v59, v17 row_newbcast:8 row_mask:0xf bank_mask:0xf
    v_and_b32_dpp v30, v59, v18 row_newbcast:8 row_mask:0xf bank_mask:0xf
    v_and_b32_dpp v31, v59, v19 row_newbcast:8 row_mask:0xf bank_mask:0xf
    v_mfma_f32_16x16x32_bf16 v[40:43], v[32:35], a[28:31], v[40:43]
    v_and_b32_dpp v32, v59, v16 row_newbcast:9 row_mask:0xf bank_mask:0xf
    v_and_b32_dpp v33, v59, v17 row_newbcast:9 row_mask:0xf bank_mask:0xf
    v_and_b32_dpp v34, v59, v18 row_newbcast:9 row_mask:0xf bank_mask:0xf
    v_and_b32_dpp v35, v59, v19 row_newbcast:9 row_mask:0xf bank_mask:0xf
    v_mfma_f32_16x16x32_bf16 v[40:43], v[28:31], a[32:35], v[40:43]
    v_add_f32_dpp v44, v44, v44 row_ror:8 row_mask:0xf bank_mask:0x3
    v_add_f32_dpp v48, v48, v48 row_ror:8 row_mask:0xf bank_mask:0x3
    v_add_f32_dpp v45, v45, v45 row_ror:8 row_mask:0xf bank_mask:0x3
    v_add_f32_dpp v49, v49, v49 row_ror:8 row_mask:0xf bank_mask:0x3
    v_add_f32_dpp v44, v46, v46 row_ror:8 row_mask:0xf bank_mask:0xc
    v_add_f32_dpp v48, v50, v50 row_ror:8 row_mask:0xf bank_mask:0xc
    v_add_f32_dpp v45, v47, v47 row_ror:8 row_mask:0xf bank_mask:0xc
    v_add_f32_dpp v49, v51, v51 row_ror:8 row_mask:0xf bank_mask:0xc
    v_add_f32_dpp v44, v44, v44 row_half_mirror row_mask:0xf bank_mask:0x5
    v_add_f32_dpp v48, v48, v48 row_half_mirror row_mask:0xf bank_mask:0x5
    s_nop 0
    v_add_f32_dpp v44, v45, v45 row_half_mirror row_mask:0xf bank_mask:0xa
    v_add_f32_dpp v48, v49, v49 row_half_mirror row_mask:0xf bank_mask:0xa
    s_nop 0
    v_add_f32_dpp v44, v44, v44 quad_perm:[1,0,3,2] row_mask:0xf bank_mask:0xf
    v_add_f32_dpp v48, v48, v48 quad_perm:[1,0,3,2] row_mask:0xf bank_mask:0xf
    s_nop 0
    v_add_f32_dpp v44, v44, v44 quad_perm:[2,3,0,1] row_mask:0xf bank_mask:0xf
    v_add_f32_dpp v48, v48, v48 quad_perm:[2,3,0,1] row_mask:0xf bank_mask:0xf
    s_waitcnt vmcnt(5)
    buffer_load_dwordx4 v[80:83], v132, s[32:35], s51 offen nt
    v_and_b32_dpp v28, v59, v16 row_newbcast:10 row_mask:0xf bank_mask:0xf
    v_and_b32_dpp v29, v59, v17 row_newbcast:10 row_mask:0xf bank_mask:0xf
    v_and_b32_dpp v30, v59, v18 row_newbcast:10 row_mask:0xf bank_mask:0xf
    v_and_b32_dpp v31, v59, v19 row_newbcast:10 row_mask:0xf bank_mask:0xf
    v_mfma_f32_16x16x32_bf16 v[40:43], v[32:35], a[36:39], v[40:43]
    v_and_b32_dpp v32, v59, v16 row_newbcast:11 row_mask:0xf bank_mask:0xf
    v_and_b32_dpp v33, v59, v17 row_newbcast:11 row_mask:0xf bank_mask:0xf
    v_and_b32_dpp v34, v59, v18 row_newbcast:11 row_mask:0xf bank_mask:0xf
    v_and_b32_dpp v35, v59, v19 row_newbcast:11 row_mask:0xf bank_mask:0xf
    v_mfma_f32_16x16x32_bf16 v[40:43], v[28:31], a[40:43], v[40:43]
    v_and_b32_dpp v28, v59, v16 row_newbcast:12 row_mask:0xf bank_mask:0xf
    v_and_b32_dpp v29, v59, v17 row_newbcast:12 row_mask:0xf bank_mask:0xf
    v_and_b32_dpp v30, v59, v18 row_newbcast:12 row_mask:0xf bank_mask:0xf
    v_and_b32_dpp v31, v59, v19 row_newbcast:12 row_mask:0xf bank_mask:0xf
    v_mfma_f32_16x16x32_bf16 v[40:43], v[32:35], a[44:47], v[40:43]
    s_waitcnt vmcnt(4)
    buffer_load_dwordx4 v[84:87], v133, s[32:35], s51 offen nt
    v_and_b32_dpp v32, v59, v16 row_newbcast:13 row_mask:0xf bank_mask:0xf
    v_and_b32_dpp v33, v59, v17 row_newbcast:13 row_mask:0xf bank_mask:0xf
    v_and_b32_dpp v34, v59, v18 row_newbcast:13 row_mask:0xf bank_mask:0xf
    v_and_b32_dpp v35, v59, v19 row_newbcast:13 row_mask:0xf bank_mask:0xf
    v_mfma_f32_16x16x32_bf16 v[40:43], v[28:31], a[48:51], v[40:43]
    v_and_b32_dpp v28, v59, v16 row_newbcast:14 row_mask:0xf bank_mask:0xf
    v_and_b32_dpp v29, v59, v17 row_newbcast:14 row_mask:0xf bank_mask:0xf
    v_and_b32_dpp v30, v59, v18 row_newbcast:14 row_mask:0xf bank_mask:0xf
    v_and_b32_dpp v31, v59, v19 row_newbcast:14 row_mask:0xf bank_mask:0xf
    v_mfma_f32_16x16x32_bf16 v[40:43], v[32:35], a[52:55], v[40:43]
    v_and_b32_dpp v32, v59, v16 row_newbcast:15 row_mask:0xf bank_mask:0xf
    v_and_b32_dpp v33, v59, v17 row_newbcast:15 row_mask:0xf bank_mask:0xf
    v_and_b32_dpp v34, v59, v18 row_newbcast:15 row_mask:0xf bank_mask:0xf
    v_and_b32_dpp v35, v59, v19 row_newbcast:15 row_mask:0xf bank_mask:0xf
    v_mfma_f32_16x16x32_bf16 v[40:43], v[28:31], a[56:59], v[40:43]
    v_cndmask_b32 v142, v44, v48, s[64:65]
    s_waitcnt vmcnt(4)
    buffer_load_dwordx4 v[88:91], v134, s[32:35], s51 offen nt
    v_and_b32_dpp v28, v60, v16 row_newbcast:0 row_mask:0xf bank_mask:0xf
    v_and_b32_dpp v29, v60, v17 row_newbcast:0 row_mask:0xf bank_mask:0xf
    v_and_b32_dpp v30, v60, v18 row_newbcast:0 row_mask:0xf bank_mask:0xf
    v_and_b32_dpp v31, v60, v19 row_newbcast:0 row_mask:0xf bank_mask:0xf
    v_mfma_f32_16x16x32_bf16 v[40:43], v[32:35], a[60:63], v[40:43]
    v_and_b32_dpp v32, v60, v16 row_newbcast:1 row_mask:0xf bank_mask:0xf
    v_and_b32_dpp v33, v60, v17 row_newbcast:1 row_mask:0xf bank_mask:0xf
    v_and_b32_dpp v34, v60, v18 row_newbcast:1 row_mask:0xf bank_mask:0xf
    v_and_b32_dpp v35, v60, v19 row_newbcast:1 row_mask:0xf bank_mask:0xf
    v_mfma_f32_16x16x32_bf16 v[40:43], v[28:31], a[64:67], v[40:43]
    v_and_b32_dpp v28, v60, v16 row_newbcast:2 row_mask:0xf bank_mask:0xf
    v_and_b32_dpp v29, v60, v17 row_newbcast:2 row_mask:0xf bank_mask:0xf
    v_and_b32_dpp v30, v60, v18 row_newbcast:2 row_mask:0xf bank_mask:0xf
    v_and_b32_dpp v31, v60, v19 row_newbcast:2 row_mask:0xf bank_mask:0xf
    v_mfma_f32_16x16x32_bf16 v[40:43], v[32:35], a[68:71], v[40:43]
    s_waitcnt vmcnt(4)
    buffer_load_dwordx4 v[92:95], v135, s[32:35], s51 offen nt
    v_and_b32_dpp v32, v60, v16 row_newbcast:3 row_mask:0xf bank_mask:0xf
    v_and_b32_dpp v33, v60, v17 row_newbcast:3 row_mask:0xf bank_mask:0xf
    v_and_b32_dpp v34, v60, v18 row_newbcast:3 row_mask:0xf bank_mask:0xf
    v_and_b32_dpp v35, v60, v19 row_newbcast:3 row_mask:0xf bank_mask:0xf
    v_mfma_f32_16x16x32_bf16 v[40:43], v[28:31], a[72:75], v[40:43]
    v_and_b32_dpp v28, v60, v16 row_newbcast:4 row_mask:0xf bank_mask:0xf
    v_and_b32_dpp v29, v60, v17 row_newbcast:4 row_mask:0xf bank_mask:0xf
    v_and_b32_dpp v30, v60, v18 row_newbcast:4 row_mask:0xf bank_mask:0xf
    v_and_b32_dpp v31, v60, v19 row_newbcast:4 row_mask:0xf bank_mask:0xf
    v_mfma_f32_16x16x32_bf16 v[40:43], v[32:35], a[76:79], v[40:43]
    v_and_b32_dpp v32, v60, v16 row_newbcast:5 row_mask:0xf bank_mask:0xf
    v_and_b32_dpp v33, v60, v17 row_newbcast:5 row_mask:0xf bank_mask:0xf
    v_and_b32_dpp v34, v60, v18 row_newbcast:5 row_mask:0xf bank_mask:0xf
    v_and_b32_dpp v35, v60, v19 row_newbcast:5 row_mask:0xf bank_mask:0xf
    v_mfma_f32_16x16x32_bf16 v[40:43], v[28:31], a[80:83], v[40:43]
    v_dot2_f32_bf16 v44, v96, v20, 0
    v_dot2_f32_bf16 v45, v100, v20, 0
    v_dot2_f32_bf16 v46, v104, v20, 0
    v_dot2_f32_bf16 v47, v108, v20, 0
    v_dot2_f32_bf16 v44, v97, v21, v44
    v_dot2_f32_bf16 v45, v101, v21, v45
    v_dot2_f32_bf16 v46, v105, v21, v46
    v_dot2_f32_bf16 v47, v109, v21, v47
    v_dot2_f32_bf16 v44, v98, v22, v44
    v_dot2_f32_bf16 v45, v102, v22, v45
    v_dot2_f32_bf16 v46, v106, v22, v46
    v_dot2_f32_bf16 v47, v110, v22, v47
    v_dot2_f32_bf16 v44, v99, v23, v44
    v_dot2_f32_bf16 v45, v103, v23, v45
    v_dot2_f32_bf16 v46, v107, v23, v46
    v_dot2_f32_bf16 v47, v111, v23, v47
    s_waitcnt vmcnt(4)
    buffer_load_dwordx4 v[96:99], v128, s[32:35], s52 offen nt
    v_and_b32_dpp v28, v60, v16 row_newbcast:6 row_mask:0xf bank_mask:0xf
    v_and_b32_dpp v29, v60, v17 row_newbcast:6 row_mask:0xf bank_mask:0xf
    v_and_b32_dpp v30, v60, v18 row_newbcast:6 row_mask:0xf bank_mask:0xf
    v_and_b32_dpp v31, v60, v19 row_newbcast:6 row_mask:0xf bank_mask:0xf
    v_mfma_f32_16x16x32_bf16 v[40:43], v[32:35], a[84:87], v[40:43]
    v_and_b32_dpp v32, v60, v16 row_newbcast:7 row_mask:0xf bank_mask:0xf
    v_and_b32_dpp v33, v60, v17 row_newbcast:7 row_mask:0xf bank_mask:0xf
    v_and_b32_dpp v34, v60, v18 row_newbcast:7 row_mask:0xf bank_mask:0xf
    v_and_b32_dpp v35, v60, v19 row_newbcast:7 row_mask:0xf bank_mask:0xf
    v_mfma_f32_16x16x32_bf16 v[40:43], v[28:31], a[88:91], v[40:43]
    v_and_b32_dpp v28, v60, v16 row_newbcast:8 row_mask:0xf bank_mask:0xf
    v_and_b32_dpp v29, v60, v17 row_newbcast:8 row_mask:0xf bank_mask:0xf
    v_and_b32_dpp v30, v60, v18 row_newbcast:8 row_mask:0xf bank_mask:0xf
    v_and_b32_dpp v31, v60, v19 row_newbcast:8 row_mask:0xf bank_mask:0xf
    v_mfma_f32_16x16x32_bf16 v[40:43], v[32:35], a[92:95], v[40:43]
    s_waitcnt vmcnt(4)
    buffer_load_dwordx4 v[100:103], v129, s[32:35], s52 offen nt
    v_and_b32_dpp v32, v60, v16 row_newbcast:9 row_mask:0xf bank_mask:0xf
    v_and_b32_dpp v33, v60, v17 row_newbcast:9 row_mask:0xf bank_mask:0xf
    v_and_b32_dpp v34, v60, v18 row_newbcast:9 row_mask:0xf bank_mask:0xf
    v_and_b32_dpp v35, v60, v19 row_newbcast:9 row_mask:0xf bank_mask:0xf
    v_mfma_f32_16x16x32_bf16 v[40:43], v[28:31], a[96:99], v[40:43]
    v_and_b32_dpp v28, v60, v16 row_newbcast:10 row_mask:0xf bank_mask:0xf
    v_and_b32_dpp v29, v60, v17 row_newbcast:10 row_mask:0xf bank_mask:0xf
    v_and_b32_dpp v30, v60, v18 row_newbcast:10 row_mask:0xf bank_mask:0xf
    v_and_b32_dpp v31, v60, v19 row_newbcast:10 row_mask:0xf bank_mask:0xf
    v_mfma_f32_16x16x32_bf16 v[40:43], v[32:35], a[100:103], v[40:43]
    v_and_b32_dpp v32, v60, v16 row_newbcast:11 row_mask:0xf bank_mask:0xf
    v_and_b32_dpp v33, v60, v17 row_newbcast:11 row_mask:0xf bank_mask:0xf
    v_and_b32_dpp v34, v60, v18 row_newbcast:11 row_mask:0xf bank_mask:0xf
    v_and_b32_dpp v35, v60, v19 row_newbcast:11 row_mask:0xf bank_mask:0xf
    v_mfma_f32_16x16x32_bf16 v[40:43], v[28:31], a[104:107], v[40:43]
    v_dot2_f32_bf16 v48, v112, v20, 0
    v_dot2_f32_bf16 v49, v116, v20, 0
    v_dot2_f32_bf16 v50, v120, v20, 0
    v_dot2_f32_bf16 v51, v124, v20, 0
    v_dot2_f32_bf16 v48, v113, v21, v48
    v_dot2_f32_bf16 v49, v117, v21, v49
    v_dot2_f32_bf16 v50, v121, v21, v50
    v_dot2_f32_bf16 v51, v125, v21, v51
    v_dot2_f32_bf16 v48, v114, v22, v48
    v_dot2_f32_bf16 v49, v118, v22, v49
    v_dot2_f32_bf16 v50, v122, v22, v50
    v_dot2_f32_bf16 v51, v126, v22, v51
    v_dot2_f32_bf16 v48, v115, v23, v48
    v_dot2_f32_bf16 v49, v119, v23, v49
    v_dot2_f32_bf16 v50, v123, v23, v50
    v_dot2_f32_bf16 v51, v127, v23, v51
    s_waitcnt vmcnt(4)
    buffer_load_dwordx4 v[104:107], v130, s[32:35], s52 offen nt
    v_and_b32_dpp v28, v60, v16 row_newbcast:12 row_mask:0xf bank_mask:0xf
    v_and_b32_dpp v29, v60, v17 row_newbcast:12 row_mask:0xf bank_mask:0xf
    v_and_b32_dpp v30, v60, v18 row_newbcast:12 row_mask:0xf bank_mask:0xf
    v_and_b32_dpp v31, v60, v19 row_newbcast:12 row_mask:0xf bank_mask:0xf
    v_mfma_f32_16x16x32_bf16 v[40:43], v[32:35], a[108:111], v[40:43]
    v_and_b32_dpp v32, v60, v16 row_newbcast:13 row_mask:0xf bank_mask:0xf
    v_and_b32_dpp v33, v60, v17 row_newbcast:13 row_mask:0xf bank_mask:0xf
    v_and_b32_dpp v34, v60, v18 row_newbcast:13 row_mask:0xf bank_mask:0xf
    v_and_b32_dpp v35, v60, v19 row_newbcast:13 row_mask:0xf bank_mask:0xf
    v_mfma_f32_16x16x32_bf16 v[40:43], v[28:31], a[112:115], v[40:43]
    v_and_b32_dpp v28, v60, v16 row_newbcast:14 row_mask:0xf bank_mask:0xf
    v_and_b32_dpp v29, v60, v17 row_newbcast:14 row_mask:0xf bank_mask:0xf
    v_and_b32_dpp v30, v60, v18 row_newbcast:14 row_mask:0xf bank_mask:0xf
    v_and_b32_dpp v31, v60, v19 row_newbcast:14 row_mask:0xf bank_mask:0xf
    v_mfma_f32_16x16x32_bf16 v[40:43], v[32:35], a[116:119], v[40:43]
    s_waitcnt vmcnt(4)
    buffer_load_dwordx4 v[108:111], v131, s[32:35], s52 offen nt
    v_and_b32_dpp v32, v60, v16 row_newbcast:15 row_mask:0xf bank_mask:0xf
    v_and_b32_dpp v33, v60, v17 row_newbcast:15 row_mask:0xf bank_mask:0xf
    v_and_b32_dpp v34, v60, v18 row_newbcast:15 row_mask:0xf bank_mask:0xf
    v_and_b32_dpp v35, v60, v19 row_newbcast:15 row_mask:0xf bank_mask:0xf
    v_mfma_f32_16x16x32_bf16 v[40:43], v[28:31], a[120:123], v[40:43]
    v_and_b32_dpp v28, v61, v16 row_newbcast:0 row_mask:0xf bank_mask:0xf
    v_and_b32_dpp v29, v61, v17 row_newbcast:0 row_mask:0xf bank_mask:0xf
    v_and_b32_dpp v30, v61, v18 row_newbcast:0 row_mask:0xf bank_mask:0xf
    v_and_b32_dpp v31, v61, v19 row_newbcast:0 row_mask:0xf bank_mask:0xf
    v_mfma_f32_16x16x32_bf16 v[40:43], v[32:35], a[124:127], v[40:43]
    v_and_b32_dpp v32, v61, v16 row_newbcast:1 row_mask:0xf bank_mask:0xf
    v_and_b32_dpp v33, v61, v17 row_newbcast:1 row_mask:0xf bank_mask:0xf
    v_and_b32_dpp v34, v61, v18 row_newbcast:1 row_mask:0xf bank_mask:0xf
    v_and_b32_dpp v35, v61, v19 row_newbcast:1 row_mask:0xf bank_mask:0xf
    v_mfma_f32_16x16x32_bf16 v[40:43], v[28:31], a[128:131], v[40:43]
    v_add_f32_dpp v44, v44, v44 row_ror:8 row_mask:0xf bank_mask:0x3
    v_add_f32_dpp v48, v48, v48 row_ror:8 row_mask:0xf bank_mask:0x3
    v_add_f32_dpp v45, v45, v45 row_ror:8 row_mask:0xf bank_mask:0x3
    v_add_f32_dpp v49, v49, v49 row_ror:8 row_mask:0xf bank_mask:0x3
    v_add_f32_dpp v44, v46, v46 row_ror:8 row_mask:0xf bank_mask:0xc
    v_add_f32_dpp v48, v50, v50 row_ror:8 row_mask:0xf bank_mask:0xc
    v_add_f32_dpp v45, v47, v47 row_ror:8 row_mask:0xf bank_mask:0xc
    v_add_f32_dpp v49, v51, v51 row_ror:8 row_mask:0xf bank_mask:0xc
    v_add_f32_dpp v44, v44, v44 row_half_mirror row_mask:0xf bank_mask:0x5
    v_add_f32_dpp v48, v48, v48 row_half_mirror row_mask:0xf bank_mask:0x5
    s_nop 0
    v_add_f32_dpp v44, v45, v45 row_half_mirror row_mask:0xf bank_mask:0xa
    v_add_f32_dpp v48, v49, v49 row_half_mirror row_mask:0xf bank_mask:0xa
    s_nop 0
    v_add_f32_dpp v44, v44, v44 quad_perm:[1,0,3,2] row_mask:0xf bank_mask:0xf
    v_add_f32_dpp v48, v48, v48 quad_perm:[1,0,3,2] row_mask:0xf bank_mask:0xf
    s_nop 0
    v_add_f32_dpp v44, v44, v44 quad_perm:[2,3,0,1] row_mask:0xf bank_mask:0xf
    v_add_f32_dpp v48, v48, v48 quad_perm:[2,3,0,1] row_mask:0xf bank_mask:0xf
    s_waitcnt vmcnt(4)
    buffer_load_dwordx4 v[112:115], v132, s[32:35], s52 offen nt
    v_and_b32_dpp v28, v61, v16 row_newbcast:2 row_mask:0xf bank_mask:0xf
    v_and_b32_dpp v29, v61, v17 row_newbcast:2 row_mask:0xf bank_mask:0xf
    v_and_b32_dpp v30, v61, v18 row_newbcast:2 row_mask:0xf bank_mask:0xf
    v_and_b32_dpp v31, v61, v19 row_newbcast:2 row_mask:0xf bank_mask:0xf
    v_mfma_f32_16x16x32_bf16 v[40:43], v[32:35], a[132:135], v[40:43]
    v_and_b32_dpp v32, v61, v16 row_newbcast:3 row_mask:0xf bank_mask:0xf
    v_and_b32_dpp v33, v61, v17 row_newbcast:3 row_mask:0xf bank_mask:0xf
    v_and_b32_dpp v34, v61, v18 row_newbcast:3 row_mask:0xf bank_mask:0xf
    v_and_b32_dpp v35, v61, v19 row_newbcast:3 row_mask:0xf bank_mask:0xf
    v_mfma_f32_16x16x32_bf16 v[40:43], v[28:31], a[136:139], v[40:43]
    v_and_b32_dpp v28, v61, v16 row_newbcast:4 row_mask:0xf bank_mask:0xf
    v_and_b32_dpp v29, v61, v17 row_newbcast:4 row_mask:0xf bank_mask:0xf
    v_and_b32_dpp v30, v61, v18 row_newbcast:4 row_mask:0xf bank_mask:0xf
    v_and_b32_dpp v31, v61, v19 row_newbcast:4 row_mask:0xf bank_mask:0xf
    v_mfma_f32_16x16x32_bf16 v[40:43], v[32:35], a[140:143], v[40:43]
    s_waitcnt vmcnt(4)
    buffer_load_dwordx4 v[116:119], v133, s[32:35], s52 offen nt
    v_and_b32_dpp v32, v61, v16 row_newbcast:5 row_mask:0xf bank_mask:0xf
    v_and_b32_dpp v33, v61, v17 row_newbcast:5 row_mask:0xf bank_mask:0xf
    v_and_b32_dpp v34, v61, v18 row_newbcast:5 row_mask:0xf bank_mask:0xf
    v_and_b32_dpp v35, v61, v19 row_newbcast:5 row_mask:0xf bank_mask:0xf
    v_mfma_f32_16x16x32_bf16 v[40:43], v[28:31], a[144:147], v[40:43]
    v_and_b32_dpp v28, v61, v16 row_newbcast:6 row_mask:0xf bank_mask:0xf
    v_and_b32_dpp v29, v61, v17 row_newbcast:6 row_mask:0xf bank_mask:0xf
    v_and_b32_dpp v30, v61, v18 row_newbcast:6 row_mask:0xf bank_mask:0xf
    v_and_b32_dpp v31, v61, v19 row_newbcast:6 row_mask:0xf bank_mask:0xf
    v_mfma_f32_16x16x32_bf16 v[40:43], v[32:35], a[148:151], v[40:43]
    v_and_b32_dpp v32, v61, v16 row_newbcast:7 row_mask:0xf bank_mask:0xf
    v_and_b32_dpp v33, v61, v17 row_newbcast:7 row_mask:0xf bank_mask:0xf
    v_and_b32_dpp v34, v61, v18 row_newbcast:7 row_mask:0xf bank_mask:0xf
    v_and_b32_dpp v35, v61, v19 row_newbcast:7 row_mask:0xf bank_mask:0xf
    v_mfma_f32_16x16x32_bf16 v[40:43], v[28:31], a[152:155], v[40:43]
    v_cndmask_b32 v142, v142, v44, s[66:67]
    v_cndmask_b32 v142, v142, v48, s[68:69]
    s_waitcnt vmcnt(4)
    buffer_load_dwordx4 v[120:123], v134, s[32:35], s52 offen nt
    v_mfma_f32_16x16x32_bf16 v[40:43], v[32:35], a[156:159], v[40:43]
    s_waitcnt vmcnt(4)
    buffer_load_dwordx4 v[124:127], v135, s[32:35], s52 offen nt
    s_mul_i32 s54, s3, 512
    v_add_u32 v62, s54, v11
    s_mov_b32 exec_hi, 0
    s_nop 2
    ds_write_b128 v62, v[40:43] offset:4608
    s_mov_b32 exec_hi, -1
    s_mov_b64 s[32:33], s[8:9]
    s_mov_b32 s51, s53
    s_add_u32 s52, s53, 0x8000
    v_dot2_f32_bf16 v44, v64, v20, 0
    v_dot2_f32_bf16 v45, v68, v20, 0
    v_dot2_f32_bf16 v46, v72, v20, 0
    v_dot2_f32_bf16 v47, v76, v20, 0
    v_dot2_f32_bf16 v44, v65, v21, v44
    v_dot2_f32_bf16 v45, v69, v21, v45
    v_dot2_f32_bf16 v46, v73, v21, v46
    v_dot2_f32_bf16 v47, v77, v21, v47
    v_dot2_f32_bf16 v44, v66, v22, v44
    v_dot2_f32_bf16 v45, v70, v22, v45
    v_dot2_f32_bf16 v46, v74, v22, v46
    v_dot2_f32_bf16 v47, v78, v22, v47
    v_dot2_f32_bf16 v44, v67, v23, v44
    v_dot2_f32_bf16 v45, v71, v23, v45
    v_dot2_f32_bf16 v46, v75, v23, v46
    v_dot2_f32_bf16 v47, v79, v23, v47
    v_dot2_f32_bf16 v48, v80, v20, 0
    v_dot2_f32_bf16 v49, v84, v20, 0
    v_dot2_f32_bf16 v50, v88, v20, 0
    v_dot2_f32_bf16 v51, v92, v20, 0
    v_dot2_f32_bf16 v48, v81, v21, v48
    v_dot2_f32_bf16 v49, v85, v21, v49
    v_dot2_f32_bf16 v50, v89, v21, v50
    v_dot2_f32_bf16 v51, v93, v21, v51
    v_dot2_f32_bf16 v48, v82, v22, v48
    v_dot2_f32_bf16 v49, v86, v22, v49
    v_dot2_f32_bf16 v50, v90, v22, v50
    v_dot2_f32_bf16 v51, v94, v22, v51
    v_dot2_f32_bf16 v48, v83, v23, v48
    v_dot2_f32_bf16 v49, v87, v23, v49
    v_dot2_f32_bf16 v50, v91, v23, v50
    v_dot2_f32_bf16 v51, v95, v23, v51
    s_mov_b64 s[36:37], s[12:13]
    s_mov_b32 s58, s60
    buffer_load_dwordx4 a[0:3], v3, s[36:39], s58 offen offset:0
    v_add_f32_dpp v44, v44, v44 row_ror:8 row_mask:0xf bank_mask:0x3
    v_add_f32_dpp v48, v48, v48 row_ror:8 row_mask:0xf bank_mask:0x3
    v_add_f32_dpp v45, v45, v45 row_ror:8 row_mask:0xf bank_mask:0x3
    v_add_f32_dpp v49, v49, v49 row_ror:8 row_mask:0xf bank_mask:0x3
    v_add_f32_dpp v44, v46, v46 row_ror:8 row_mask:0xf bank_mask:0xc
    v_add_f32_dpp v48, v50, v50 row_ror:8 row_mask:0xf bank_mask:0xc
    v_add_f32_dpp v45, v47, v47 row_ror:8 row_mask:0xf bank_mask:0xc
    v_add_f32_dpp v49, v51, v51 row_ror:8 row_mask:0xf bank_mask:0xc
    v_add_f32_dpp v44, v44, v44 row_half_mirror row_mask:0xf bank_mask:0x5
    v_add_f32_dpp v48, v48, v48 row_half_mirror row_mask:0xf bank_mask:0x5
    s_nop 0
    v_add_f32_dpp v44, v45, v45 row_half_mirror row_mask:0xf bank_mask:0xa
    v_add_f32_dpp v48, v49, v49 row_half_mirror row_mask:0xf bank_mask:0xa
    s_nop 0
    v_add_f32_dpp v44, v44, v44 quad_perm:[1,0,3,2] row_mask:0xf bank_mask:0xf
    v_add_f32_dpp v48, v48, v48 quad_perm:[1,0,3,2] row_mask:0xf bank_mask:0xf
    s_nop 0
    v_add_f32_dpp v44, v44, v44 quad_perm:[2,3,0,1] row_mask:0xf bank_mask:0xf
    v_add_f32_dpp v48, v48, v48 quad_perm:[2,3,0,1] row_mask:0xf bank_mask:0xf
    v_cndmask_b32 v143, v44, v48, s[64:65]
    s_waitcnt vmcnt(5)
    v_dot2_f32_bf16 v44, v96, v20, 0
    v_dot2_f32_bf16 v45, v100, v20, 0
    v_dot2_f32_bf16 v46, v104, v20, 0
    v_dot2_f32_bf16 v47, v108, v20, 0
    v_dot2_f32_bf16 v44, v97, v21, v44
    v_dot2_f32_bf16 v45, v101, v21, v45
    v_dot2_f32_bf16 v46, v105, v21, v46
    v_dot2_f32_bf16 v47, v109, v21, v47
    v_dot2_f32_bf16 v44, v98, v22, v44
    v_dot2_f32_bf16 v45, v102, v22, v45
    v_dot2_f32_bf16 v46, v106, v22, v46
    v_dot2_f32_bf16 v47, v110, v22, v47
    v_dot2_f32_bf16 v44, v99, v23, v44
    v_dot2_f32_bf16 v45, v103, v23, v45
    v_dot2_f32_bf16 v46, v107, v23, v46
    v_dot2_f32_bf16 v47, v111, v23, v47
    s_waitcnt vmcnt(1)
    v_dot2_f32_bf16 v48, v112, v20, 0
    v_dot2_f32_bf16 v49, v116, v20, 0
    v_dot2_f32_bf16 v50, v120, v20, 0
    v_dot2_f32_bf16 v51, v124, v20, 0
    v_dot2_f32_bf16 v48, v113, v21, v48
    v_dot2_f32_bf16 v49, v117, v21, v49
    v_dot2_f32_bf16 v50, v121, v21, v50
    v_dot2_f32_bf16 v51, v125, v21, v51
    v_dot2_f32_bf16 v48, v114, v22, v48
    v_dot2_f32_bf16 v49, v118, v22, v49
    v_dot2_f32_bf16 v50, v122, v22, v50
    v_dot2_f32_bf16 v51, v126, v22, v51
    v_dot2_f32_bf16 v48, v115, v23, v48
    v_dot2_f32_bf16 v49, v119, v23, v49
    v_dot2_f32_bf16 v50, v123, v23, v50
    v_dot2_f32_bf16 v51, v127, v23, v51
    buffer_load_dwordx4 a[8:11], v3, s[36:39], s58 offen offset:256
    v_add_f32_dpp v44, v44, v44 row_ror:8 row_mask:0xf bank_mask:0x3
    v_add_f32_dpp v48, v48, v48 row_ror:8 row_mask:0xf bank_mask:0x3
    v_add_f32_dpp v45, v45, v45 row_ror:8 row_mask:0xf bank_mask:0x3
    v_add_f32_dpp v49, v49, v49 row_ror:8 row_mask:0xf bank_mask:0x3
    v_add_f32_dpp v44, v46, v46 row_ror:8 row_mask:0xf bank_mask:0xc
    v_add_f32_dpp v48, v50, v50 row_ror:8 row_mask:0xf bank_mask:0xc
    v_add_f32_dpp v45, v47, v47 row_ror:8 row_mask:0xf bank_mask:0xc
    v_add_f32_dpp v49, v51, v51 row_ror:8 row_mask:0xf bank_mask:0xc
    v_add_f32_dpp v44, v44, v44 row_half_mirror row_mask:0xf bank_mask:0x5
    v_add_f32_dpp v48, v48, v48 row_half_mirror row_mask:0xf bank_mask:0x5
    s_nop 0
    v_add_f32_dpp v44, v45, v45 row_half_mirror row_mask:0xf bank_mask:0xa
    v_add_f32_dpp v48, v49, v49 row_half_mirror row_mask:0xf bank_mask:0xa
    s_nop 0
    v_add_f32_dpp v44, v44, v44 quad_perm:[1,0,3,2] row_mask:0xf bank_mask:0xf
    v_add_f32_dpp v48, v48, v48 quad_perm:[1,0,3,2] row_mask:0xf bank_mask:0xf
    s_nop 0
    v_add_f32_dpp v44, v44, v44 quad_perm:[2,3,0,1] row_mask:0xf bank_mask:0xf
    v_add_f32_dpp v48, v48, v48 quad_perm:[2,3,0,1] row_mask:0xf bank_mask:0xf
    v_cndmask_b32 v143, v143, v44, s[66:67]
    v_cndmask_b32 v143, v143, v48, s[68:69]
    v_cvt_pk_bf16_f32 v136, v136, v136
    v_cvt_pk_bf16_f32 v137, v137, v137
    v_cvt_pk_bf16_f32 v138, v138, v138
    v_cvt_pk_bf16_f32 v139, v139, v139
    v_cvt_pk_bf16_f32 v140, v140, v140
    v_cvt_pk_bf16_f32 v141, v141, v141
    v_cvt_pk_bf16_f32 v142, v142, v142
    v_cvt_pk_bf16_f32 v143, v143, v143
    v_and_b32 v136, 0xffff0000, v136
    v_and_b32 v137, 0xffff0000, v137
    v_and_b32 v138, 0xffff0000, v138
    v_and_b32 v139, 0xffff0000, v139
    v_and_b32 v140, 0xffff0000, v140
    v_and_b32 v141, 0xffff0000, v141
    v_and_b32 v142, 0xffff0000, v142
    v_and_b32 v143, 0xffff0000, v143
    v_mul_f32 v136, 0x3db504f3, v136
    v_mul_f32 v137, 0x3db504f3, v137
    v_mul_f32 v138, 0x3db504f3, v138
    v_mul_f32 v139, 0x3db504f3, v139
    v_mul_f32 v140, 0x3db504f3, v140
    v_mul_f32 v141, 0x3db504f3, v141
    v_mul_f32 v142, 0x3db504f3, v142
    v_mul_f32 v143, 0x3db504f3, v143
    v_cvt_pk_bf16_f32 v136, v136, v136
    v_cvt_pk_bf16_f32 v137, v137, v137
    v_cvt_pk_bf16_f32 v138, v138, v138
    v_cvt_pk_bf16_f32 v139, v139, v139
    v_cvt_pk_bf16_f32 v140, v140, v140
    v_cvt_pk_bf16_f32 v141, v141, v141
    v_cvt_pk_bf16_f32 v142, v142, v142
    v_cvt_pk_bf16_f32 v143, v143, v143
    v_and_b32 v136, 0xffff0000, v136
    v_and_b32 v137, 0xffff0000, v137
    v_and_b32 v138, 0xffff0000, v138
    v_and_b32 v139, 0xffff0000, v139
    v_and_b32 v140, 0xffff0000, v140
    v_and_b32 v141, 0xffff0000, v141
    v_and_b32 v142, 0xffff0000, v142
    v_and_b32 v143, 0xffff0000, v143
    v_max3_f32 v54, v136, v137, v138
    v_max3_f32 v55, v139, v140, v141
    v_max3_f32 v54, v54, v142, v143
    v_max_f32 v54, v54, v55
    s_nop 1
    v_max_f32_dpp v54, v54, v54 row_ror:8 row_mask:0xf bank_mask:0xf
    s_nop 1
    v_max_f32_dpp v54, v54, v54 row_ror:4 row_mask:0xf bank_mask:0xf
    s_nop 1
    v_max_f32_dpp v54, v54, v54 row_ror:2 row_mask:0xf bank_mask:0xf
    s_nop 1
    v_max_f32_dpp v54, v54, v54 row_ror:1 row_mask:0xf bank_mask:0xf
    s_nop 1
    v_max_f32_dpp v54, v54, v54 row_bcast:15 row_mask:0xa bank_mask:0xf
    s_nop 1
    v_max_f32_dpp v54, v54, v54 row_bcast:31 row_mask:0xc bank_mask:0xf
    s_nop 0
    v_readlane_b32 s56, v54, 63
    buffer_load_dwordx4 a[16:19], v3, s[36:39], s58 offen offset:512
    s_nop 0
    v_subrev_f32 v136, s56, v136
    v_subrev_f32 v137, s56, v137
    v_subrev_f32 v138, s56, v138
    v_subrev_f32 v139, s56, v139
    v_subrev_f32 v140, s56, v140
    v_subrev_f32 v141, s56, v141
    v_subrev_f32 v142, s56, v142
    v_subrev_f32 v143, s56, v143
    v_mul_f32 v136, 0x3fb8aa3b, v136
    v_mul_f32 v137, 0x3fb8aa3b, v137
    v_mul_f32 v138, 0x3fb8aa3b, v138
    v_mul_f32 v139, 0x3fb8aa3b, v139
    v_mul_f32 v140, 0x3fb8aa3b, v140
    v_mul_f32 v141, 0x3fb8aa3b, v141
    v_mul_f32 v142, 0x3fb8aa3b, v142
    v_mul_f32 v143, 0x3fb8aa3b, v143
    v_exp_f32 v136, v136
    v_exp_f32 v137, v137
    v_exp_f32 v138, v138
    v_exp_f32 v139, v139
    v_exp_f32 v140, v140
    v_exp_f32 v141, v141
    v_exp_f32 v142, v142
    v_exp_f32 v143, v143
    buffer_load_dwordx4 v[112:115], v132, s[32:35], s52 offen nt
    v_mov_b32 v52, s56
    v_add_f32 v53, v136, v137
    v_add_f32 v54, v138, v139
    v_add_f32 v55, v140, v141
    v_add_f32 v62, v142, v143
    v_add_f32 v53, v53, v54
    v_add_f32 v55, v55, v62
    v_add_f32 v53, v53, v55
    s_nop 1
    v_add_f32_dpp v53, v53, v53 row_ror:8 row_mask:0xf bank_mask:0xf
    s_nop 1
    v_add_f32_dpp v53, v53, v53 row_ror:4 row_mask:0xf bank_mask:0xf
    s_nop 1
    v_add_f32_dpp v53, v53, v53 row_ror:2 row_mask:0xf bank_mask:0xf
    s_nop 1
    v_add_f32_dpp v53, v53, v53 row_ror:1 row_mask:0xf bank_mask:0xf
    s_nop 1
    v_add_f32_dpp v53, v53, v53 row_bcast:15 row_mask:0xa bank_mask:0xf
    s_nop 1
    v_add_f32_dpp v53, v53, v53 row_bcast:31 row_mask:0xc bank_mask:0xf
    s_lshl_b32 s54, s3, 3
    v_mov_b32 v62, s54
    s_mov_b32 exec_lo, 0
    s_mov_b32 exec_hi, 0x80000000
    ds_write_b64 v62, v[52:53] offset:4352
    s_mov_b64 exec, -1
    buffer_load_dwordx4 v[116:119], v133, s[32:35], s52 offen nt
    s_waitcnt lgkmcnt(0)
    s_barrier
    ds_read_b64 v[44:45], v13 offset:4352
    s_waitcnt lgkmcnt(0)
    v_max_f32_dpp v224, v44, v44 quad_perm:[1,0,3,2] row_mask:0xf bank_mask:0xf
    s_nop 1
    v_max_f32_dpp v224, v224, v224 quad_perm:[2,3,0,1] row_mask:0xf bank_mask:0xf
    v_sub_f32 v44, v44, v224
    v_sub_f32 v52, v52, v224
    v_mul_f32 v44, 0x3fb8aa3b, v44
    v_mul_f32 v52, 0x3fb8aa3b, v52
    v_exp_f32 v44, v44
    v_exp_f32 v52, v52
    v_mul_f32 v225, v45, v44
    s_nop 1
    v_add_f32_dpp v225, v225, v225 quad_perm:[1,0,3,2] row_mask:0xf bank_mask:0xf
    s_nop 1
    v_add_f32_dpp v225, v225, v225 quad_perm:[2,3,0,1] row_mask:0xf bank_mask:0xf
    v_rcp_f32 v55, v225
    s_nop 0
    v_mul_f32 v55, v55, v52
    buffer_load_dwordx4 v[120:123], v134, s[32:35], s52 offen nt
    v_mul_f32 v136, v136, v55
    v_mul_f32 v137, v137, v55
    v_mul_f32 v138, v138, v55
    v_mul_f32 v139, v139, v55
    v_mul_f32 v140, v140, v55
    v_mul_f32 v141, v141, v55
    v_mul_f32 v142, v142, v55
    v_mul_f32 v143, v143, v55
    v_cvt_pk_bf16_f32 v136, v136, v136
    v_cvt_pk_bf16_f32 v137, v137, v137
    v_cvt_pk_bf16_f32 v138, v138, v138
    v_cvt_pk_bf16_f32 v139, v139, v139
    v_cvt_pk_bf16_f32 v140, v140, v140
    v_cvt_pk_bf16_f32 v141, v141, v141
    v_cvt_pk_bf16_f32 v142, v142, v142
    v_cvt_pk_bf16_f32 v143, v143, v143
    v_lshlrev_b32 v62, 5, v10
    ds_read_b128 v[144:147], v62 offset:4608
    ds_read_b128 v[148:151], v62 offset:4624
    ds_read_b128 v[152:155], v62 offset:5120
    ds_read_b128 v[156:159], v62 offset:5136
    ds_read_b128 v[160:163], v62 offset:5632
    ds_read_b128 v[164:167], v62 offset:5648
    ds_read_b128 v[168:171], v62 offset:6144
    ds_read_b128 v[172:175], v62 offset:6160
    s_waitcnt lgkmcnt(0)
    v_add_f32 v144, v144, v152
    v_add_f32 v145, v145, v153
    v_add_f32 v146, v146, v154
    v_add_f32 v147, v147, v155
    v_add_f32 v148, v148, v156
    v_add_f32 v149, v149, v157
    v_add_f32 v150, v150, v158
    v_add_f32 v151, v151, v159
    s_waitcnt lgkmcnt(0)
    v_add_f32 v144, v144, v160
    v_add_f32 v145, v145, v161
    v_add_f32 v146, v146, v162
    v_add_f32 v147, v147, v163
    v_add_f32 v148, v148, v164
    v_add_f32 v149, v149, v165
    v_add_f32 v150, v150, v166
    v_add_f32 v151, v151, v167
    s_waitcnt lgkmcnt(0)
    v_add_f32 v144, v144, v168
    v_add_f32 v145, v145, v169
    v_add_f32 v146, v146, v170
    v_add_f32 v147, v147, v171
    v_add_f32 v148, v148, v172
    v_add_f32 v149, v149, v173
    v_add_f32 v150, v150, v174
    v_add_f32 v151, v151, v175
    v_cvt_pk_bf16_f32 v24, v144, v145
    v_cvt_pk_bf16_f32 v25, v146, v147
    v_cvt_pk_bf16_f32 v26, v148, v149
    v_cvt_pk_bf16_f32 v27, v150, v151
    v_readfirstlane_b32 s100, v224
    v_readfirstlane_b32 s101, v225
    s_bitcmp1_b32 s70, 0
    s_cselect_b32 s54, 1, 0
    s_and_b32 s100, s100, -2
    s_or_b32 s100, s100, s54
    s_bitcmp1_b32 s70, 1
    s_cselect_b32 s54, 1, 0
    s_and_b32 s101, s101, -2
    s_or_b32 s101, s101, s54
    s_cmp_lg_u32 s3, 0
    s_cbranch_scc1 L_t1
    s_atomic_swap_x2 s[100:101], s[96:97], 0x10
L_t1:
    buffer_load_dwordx4 v[124:127], v135, s[32:35], s52 offen nt
    buffer_load_dwordx4 a[24:27], v3, s[36:39], s58 offen offset:768
    s_add_u32 s51, s51, 0x20000
    s_add_u32 s52, s52, 0x20000
    s_cmp_lg_u32 s3, 0
    s_cbranch_scc1 L_t2
    s_atomic_xor s98, s[96:97], 0x0
L_t2:
    s_mov_b32 s55, 1310720
    buffer_load_dword v236, v230, s[40:43], s55 offen sc1
    v_and_b32_dpp v28, v136, v16 row_newbcast:0 row_mask:0xf bank_mask:0xf
    v_and_b32_dpp v29, v136, v17 row_newbcast:0 row_mask:0xf bank_mask:0xf
    v_and_b32_dpp v30, v136, v18 row_newbcast:0 row_mask:0xf bank_mask:0xf
    v_and_b32_dpp v31, v136, v19 row_newbcast:0 row_mask:0xf bank_mask:0xf
    v_and_b32_dpp v32, v136, v16 row_newbcast:4 row_mask:0xf bank_mask:0xf
    v_and_b32_dpp v33, v136, v17 row_newbcast:4 row_mask:0xf bank_mask:0xf
    v_and_b32_dpp v34, v136, v18 row_newbcast:4 row_mask:0xf bank_mask:0xf
    v_and_b32_dpp v35, v136, v19 row_newbcast:4 row_mask:0xf bank_mask:0xf
    v_mfma_f32_16x16x32_bf16 v[36:39], v[28:31], a[160:163], 0
    buffer_load_dwordx4 v[64:67], v128, s[32:35], s51 offen nt
    v_and_b32_dpp v28, v136, v16 row_newbcast:8 row_mask:0xf bank_mask:0xf
    v_and_b32_dpp v29, v136, v17 row_newbcast:8 row_mask:0xf bank_mask:0xf
    v_and_b32_dpp v30, v136, v18 row_newbcast:8 row_mask:0xf bank_mask:0xf
    v_and_b32_dpp v31, v136, v19 row_newbcast:8 row_mask:0xf bank_mask:0xf
    v_mfma_f32_16x16x32_bf16 v[36:39], v[32:35], a[164:167], v[36:39]
    s_waitcnt vmcnt(6)
    buffer_load_dwordx4 v[68:71], v129, s[32:35], s51 offen nt
    v_and_b32_dpp v32, v136, v16 row_newbcast:12 row_mask:0xf bank_mask:0xf
    v_and_b32_dpp v33, v136, v17 row_newbcast:12 row_mask:0xf bank_mask:0xf
    v_and_b32_dpp v34, v136, v18 row_newbcast:12 row_mask:0xf bank_mask:0xf
    v_and_b32_dpp v35, v136, v19 row_newbcast:12 row_mask:0xf bank_mask:0xf
    v_mfma_f32_16x16x32_bf16 v[36:39], v[28:31], a[168:171], v[36:39]
    s_waitcnt vmcnt(6)
    buffer_load_dwordx4 v[72:75], v130, s[32:35], s51 offen nt
    v_and_b32_dpp v28, v136, v16 row_newbcast:1 row_mask:0xf bank_mask:0xf
    v_and_b32_dpp v29, v136, v17 row_newbcast:1 row_mask:0xf bank_mask:0xf
    v_and_b32_dpp v30, v136, v18 row_newbcast:1 row_mask:0xf bank_mask:0xf
    v_and_b32_dpp v31, v136, v19 row_newbcast:1 row_mask:0xf bank_mask:0xf
    v_mfma_f32_16x16x32_bf16 v[36:39], v[32:35], a[172:175], v[36:39]
    s_waitcnt vmcnt(6)
    buffer_load_dwordx4 v[76:79], v131, s[32:35], s51 offen nt
    buffer_load_dwordx4 a[32:35], v3, s[36:39], s58 offen offset:1024
    s_cmp_eq_u32 s71, 7
    s_cselect_b32 s63, 0xffff7400, s73
    s_add_u32 s58, s58, s63
    v_and_b32_dpp v32, v136, v16 row_newbcast:5 row_mask:0xf bank_mask:0xf
    v_and_b32_dpp v33, v136, v17 row_newbcast:5 row_mask:0xf bank_mask:0xf
    v_and_b32_dpp v34, v136, v18 row_newbcast:5 row_mask:0xf bank_mask:0xf
    v_and_b32_dpp v35, v136, v19 row_newbcast:5 row_mask:0xf bank_mask:0xf
    v_mfma_f32_16x16x32_bf16 v[36:39], v[28:31], a[176:179], v[36:39]
    s_waitcnt vmcnt(7)
    buffer_load_dwordx4 v[80:83], v132, s[32:35], s51 offen nt
    v_and_b32_dpp v28, v136, v16 row_newbcast:9 row_mask:0xf bank_mask:0xf
    v_and_b32_dpp v29, v136, v17 row_newbcast:9 row_mask:0xf bank_mask:0xf
    v_and_b32_dpp v30, v136, v18 row_newbcast:9 row_mask:0xf bank_mask:0xf
    v_and_b32_dpp v31, v136, v19 row_newbcast:9 row_mask:0xf bank_mask:0xf
    v_mfma_f32_16x16x32_bf16 v[36:39], v[32:35], a[180:183], v[36:39]
    s_waitcnt vmcnt(5)
    buffer_load_dwordx4 v[84:87], v133, s[32:35], s51 offen nt
    v_and_b32_dpp v32, v136, v16 row_newbcast:13 row_mask:0xf bank_mask:0xf
    v_and_b32_dpp v33, v136, v17 row_newbcast:13 row_mask:0xf bank_mask:0xf
    v_and_b32_dpp v34, v136, v18 row_newbcast:13 row_mask:0xf bank_mask:0xf
    v_and_b32_dpp v35, v136, v19 row_newbcast:13 row_mask:0xf bank_mask:0xf
    v_mfma_f32_16x16x32_bf16 v[36:39], v[28:31], a[184:187], v[36:39]
    s_waitcnt vmcnt(5)
    buffer_load_dwordx4 v[88:91], v134, s[32:35], s51 offen nt
    v_and_b32_dpp v28, v136, v16 row_newbcast:2 row_mask:0xf bank_mask:0xf
    v_and_b32_dpp v29, v136, v17 row_newbcast:2 row_mask:0xf bank_mask:0xf
    v_and_b32_dpp v30, v136, v18 row_newbcast:2 row_mask:0xf bank_mask:0xf
    v_and_b32_dpp v31, v136, v19 row_newbcast:2 row_mask:0xf bank_mask:0xf
    v_mfma_f32_16x16x32_bf16 v[36:39], v[32:35], a[188:191], v[36:39]
    s_waitcnt vmcnt(5)
    buffer_load_dwordx4 v[92:95], v135, s[32:35], s51 offen nt
    buffer_load_dwordx4 a[40:43], v3, s[36:39], s58 offen offset:0
    v_and_b32_dpp v32, v136, v16 row_newbcast:6 row_mask:0xf bank_mask:0xf
    v_and_b32_dpp v33, v136, v17 row_newbcast:6 row_mask:0xf bank_mask:0xf
    v_and_b32_dpp v34, v136, v18 row_newbcast:6 row_mask:0xf bank_mask:0xf
    v_and_b32_dpp v35, v136, v19 row_newbcast:6 row_mask:0xf bank_mask:0xf
    v_mfma_f32_16x16x32_bf16 v[36:39], v[28:31], a[192:195], v[36:39]
    s_waitcnt vmcnt(6)
    buffer_load_dwordx4 v[96:99], v128, s[32:35], s52 offen nt
    v_and_b32_dpp v28, v136, v16 row_newbcast:10 row_mask:0xf bank_mask:0xf
    v_and_b32_dpp v29, v136, v17 row_newbcast:10 row_mask:0xf bank_mask:0xf
    v_and_b32_dpp v30, v136, v18 row_newbcast:10 row_mask:0xf bank_mask:0xf
    v_and_b32_dpp v31, v136, v19 row_newbcast:10 row_mask:0xf bank_mask:0xf
    v_mfma_f32_16x16x32_bf16 v[36:39], v[32:35], a[196:199], v[36:39]
    s_waitcnt vmcnt(5)
    buffer_load_dwordx4 v[100:103], v129, s[32:35], s52 offen nt
    v_xor_b32 v236, v236, v232
    v_and_b32 v236, 1, v236
    v_cmp_eq_u32 s[54:55], 1, v236
    s_nop 0
    s_and_b32 s54, s54, -2
    s_bcnt1_i32_b32 s54, s54
    s_mul_i32 s54, s54, 109
    s_sub_i32 s54, s54, 294
    s_ashr_i32 s54, s54, 6
    v_mov_b32 v231, s54
    v_mov_b32 v236, 4400
    s_cmp_lg_u32 s3, 0
    s_cbranch_scc1 L_t3
    ds_write_b32 v236, v231
L_t3:
    v_and_b32_dpp v32, v136, v16 row_newbcast:14 row_mask:0xf bank_mask:0xf
    v_and_b32_dpp v33, v136, v17 row_newbcast:14 row_mask:0xf bank_mask:0xf
    v_and_b32_dpp v34, v136, v18 row_newbcast:14 row_mask:0xf bank_mask:0xf
    v_and_b32_dpp v35, v136, v19 row_newbcast:14 row_mask:0xf bank_mask:0xf
    v_mfma_f32_16x16x32_bf16 v[36:39], v[28:31], a[200:203], v[36:39]
    s_waitcnt vmcnt(5)
    buffer_load_dwordx4 v[104:107], v130, s[32:35], s52 offen nt
    v_and_b32_dpp v28, v136, v16 row_newbcast:3 row_mask:0xf bank_mask:0xf
    v_and_b32_dpp v29, v136, v17 row_newbcast:3 row_mask:0xf bank_mask:0xf
    v_and_b32_dpp v30, v136, v18 row_newbcast:3 row_mask:0xf bank_mask:0xf
    v_and_b32_dpp v31, v136, v19 row_newbcast:3 row_mask:0xf bank_mask:0xf
    v_mfma_f32_16x16x32_bf16 v[36:39], v[32:35], a[204:207], v[36:39]
    s_waitcnt vmcnt(5)
    buffer_load_dwordx4 v[108:111], v131, s[32:35], s52 offen nt
    buffer_load_dwordx4 a[48:51], v3, s[36:39], s58 offen offset:256
    v_and_b32_dpp v32, v136, v16 row_newbcast:7 row_mask:0xf bank_mask:0xf
    v_and_b32_dpp v33, v136, v17 row_newbcast:7 row_mask:0xf bank_mask:0xf
    v_and_b32_dpp v34, v136, v18 row_newbcast:7 row_mask:0xf bank_mask:0xf
    v_and_b32_dpp v35, v136, v19 row_newbcast:7 row_mask:0xf bank_mask:0xf
    v_mfma_f32_16x16x32_bf16 v[36:39], v[28:31], v[112:115], v[36:39]
    s_waitcnt vmcnt(6)
    buffer_load_dwordx4 v[112:115], v132, s[32:35], s52 offen nt
    v_and_b32_dpp v28, v136, v16 row_newbcast:11 row_mask:0xf bank_mask:0xf
    v_and_b32_dpp v29, v136, v17 row_newbcast:11 row_mask:0xf bank_mask:0xf
    v_and_b32_dpp v30, v136, v18 row_newbcast:11 row_mask:0xf bank_mask:0xf
    v_and_b32_dpp v31, v136, v19 row_newbcast:11 row_mask:0xf bank_mask:0xf
    v_mfma_f32_16x16x32_bf16 v[36:39], v[32:35], v[116:119], v[36:39]
    s_waitcnt vmcnt(5)
    buffer_load_dwordx4 v[116:119], v133, s[32:35], s52 offen nt
    v_and_b32_dpp v32, v136, v16 row_newbcast:15 row_mask:0xf bank_mask:0xf
    v_and_b32_dpp v33, v136, v17 row_newbcast:15 row_mask:0xf bank_mask:0xf
    v_and_b32_dpp v34, v136, v18 row_newbcast:15 row_mask:0xf bank_mask:0xf
    v_and_b32_dpp v35, v136, v19 row_newbcast:15 row_mask:0xf bank_mask:0xf
    v_mfma_f32_16x16x32_bf16 v[36:39], v[28:31], v[120:123], v[36:39]
    s_waitcnt vmcnt(5)
    buffer_load_dwordx4 v[120:123], v134, s[32:35], s52 offen nt
    v_mfma_f32_16x16x32_bf16 v[36:39], v[32:35], v[124:127], v[36:39]
    s_waitcnt vmcnt(5)
    buffer_load_dwordx4 v[124:127], v135, s[32:35], s52 offen nt
    buffer_load_dwordx4 a[56:59], v3, s[36:39], s58 offen offset:512
    s_add_u32 s51, s51, 0x20000
    s_add_u32 s52, s52, 0x20000
    v_mov_b32 v236, 4400
    ds_read_b32 v231, v236
    s_waitcnt lgkmcnt(0)
    v_readfirstlane_b32 s75, v231
    s_nop 0
    s_cmp_gt_i32 s75, 0
    s_cselect_b64 vcc, -1, 0
    s_sub_i32 s75, s75, 1
    v_and_b32_dpp v28, v137, v16 row_newbcast:0 row_mask:0xf bank_mask:0xf
    v_and_b32_dpp v29, v137, v17 row_newbcast:0 row_mask:0xf bank_mask:0xf
    v_and_b32_dpp v30, v137, v18 row_newbcast:0 row_mask:0xf bank_mask:0xf
    v_and_b32_dpp v31, v137, v19 row_newbcast:0 row_mask:0xf bank_mask:0xf
    v_and_b32_dpp v32, v137, v16 row_newbcast:4 row_mask:0xf bank_mask:0xf
    v_and_b32_dpp v33, v137, v17 row_newbcast:4 row_mask:0xf bank_mask:0xf
    v_and_b32_dpp v34, v137, v18 row_newbcast:4 row_mask:0xf bank_mask:0xf
    v_and_b32_dpp v35, v137, v19 row_newbcast:4 row_mask:0xf bank_mask:0xf
    v_mfma_f32_16x16x32_bf16 v[36:39], v[28:31], v[64:67], v[36:39]
    s_cbranch_vccnz L_t4
    s_waitcnt vmcnt(6)
L_t4:
    buffer_load_dwordx4 v[64:67], v128, s[32:35], s51 offen nt
    v_and_b32_dpp v28, v137, v16 row_newbcast:8 row_mask:0xf bank_mask:0xf
    v_and_b32_dpp v29, v137, v17 row_newbcast:8 row_mask:0xf bank_mask:0xf
    v_and_b32_dpp v30, v137, v18 row_newbcast:8 row_mask:0xf bank_mask:0xf
    v_and_b32_dpp v31, v137, v19 row_newbcast:8 row_mask:0xf bank_mask:0xf
    v_mfma_f32_16x16x32_bf16 v[36:39], v[32:35], v[68:71], v[36:39]
    s_waitcnt vmcnt(7)
    s_cbranch_vccnz L_t5
    s_waitcnt vmcnt(5)
L_t5:
    buffer_load_dwordx4 v[68:71], v129, s[32:35], s51 offen nt
    v_and_b32_dpp v32, v137, v16 row_newbcast:12 row_mask:0xf bank_mask:0xf
    v_and_b32_dpp v33, v137, v17 row_newbcast:12 row_mask:0xf bank_mask:0xf
    v_and_b32_dpp v34, v137, v18 row_newbcast:12 row_mask:0xf bank_mask:0xf
    v_and_b32_dpp v35, v137, v19 row_newbcast:12 row_mask:0xf bank_mask:0xf
    v_mfma_f32_16x16x32_bf16 v[36:39], v[28:31], v[72:75], v[36:39]
    s_waitcnt vmcnt(6)
    s_cbranch_vccnz L_t6
    s_waitcnt vmcnt(5)
L_t6:
    buffer_load_dwordx4 v[72:75], v130, s[32:35], s51 offen nt
    v_and_b32_dpp v28, v137, v16 row_newbcast:1 row_mask:0xf bank_mask:0xf
    v_and_b32_dpp v29, v137, v17 row_newbcast:1 row_mask:0xf bank_mask:0xf
    v_and_b32_dpp v30, v137, v18 row_newbcast:1 row_mask:0xf bank_mask:0xf
    v_and_b32_dpp v31, v137, v19 row_newbcast:1 row_mask:0xf bank_mask:0xf
    v_mfma_f32_16x16x32_bf16 v[36:39], v[32:35], v[76:79], v[36:39]
    s_waitcnt vmcnt(6)
    s_cbranch_vccnz L_t7
    s_waitcnt vmcnt(5)
L_t7:
    buffer_load_dwordx4 v[76:79], v131, s[32:35], s51 offen nt
    buffer_load_dwordx4 a[64:67], v3, s[36:39], s58 offen offset:768
    v_and_b32_dpp v32, v137, v16 row_newbcast:5 row_mask:0xf bank_mask:0xf
    v_and_b32_dpp v33, v137, v17 row_newbcast:5 row_mask:0xf bank_mask:0xf
    v_and_b32_dpp v34, v137, v18 row_newbcast:5 row_mask:0xf bank_mask:0xf
    v_and_b32_dpp v35, v137, v19 row_newbcast:5 row_mask:0xf bank_mask:0xf
    v_mfma_f32_16x16x32_bf16 v[36:39], v[28:31], v[80:83], v[36:39]
    s_waitcnt vmcnt(7)
    s_cbranch_vccnz L_t8
    s_waitcnt vmcnt(6)
L_t8:
    buffer_load_dwordx4 v[80:83], v132, s[32:35], s51 offen nt
    v_and_b32_dpp v28, v137, v16 row_newbcast:9 row_mask:0xf bank_mask:0xf
    v_and_b32_dpp v29, v137, v17 row_newbcast:9 row_mask:0xf bank_mask:0xf
    v_and_b32_dpp v30, v137, v18 row_newbcast:9 row_mask:0xf bank_mask:0xf
    v_and_b32_dpp v31, v137, v19 row_newbcast:9 row_mask:0xf bank_mask:0xf
    v_mfma_f32_16x16x32_bf16 v[36:39], v[32:35], v[84:87], v[36:39]
    s_waitcnt vmcnt(7)
    s_cbranch_vccnz L_t9
    s_waitcnt vmcnt(5)
L_t9:
    buffer_load_dwordx4 v[84:87], v133, s[32:35], s51 offen nt
    v_and_b32_dpp v32, v137, v16 row_newbcast:13 row_mask:0xf bank_mask:0xf
    v_and_b32_dpp v33, v137, v17 row_newbcast:13 row_mask:0xf bank_mask:0xf
    v_and_b32_dpp v34, v137, v18 row_newbcast:13 row_mask:0xf bank_mask:0xf
    v_and_b32_dpp v35, v137, v19 row_newbcast:13 row_mask:0xf bank_mask:0xf
    v_mfma_f32_16x16x32_bf16 v[36:39], v[28:31], v[88:91], v[36:39]
    s_waitcnt vmcnt(6)
    s_cbranch_vccnz L_t10
    s_waitcnt vmcnt(5)
L_t10:
    buffer_load_dwordx4 v[88:91], v134, s[32:35], s51 offen nt
    buffer_load_dwordx4 a[72:75], v3, s[36:39], s58 offen offset:1024
    s_cmp_eq_u32 s71, 6
    s_cselect_b32 s63, 0xffff7400, s73
    s_add_u32 s58, s58, s63
    v_and_b32_dpp v28, v137, v16 row_newbcast:2 row_mask:0xf bank_mask:0xf
    v_and_b32_dpp v29, v137, v17 row_newbcast:2 row_mask:0xf bank_mask:0xf
    v_and_b32_dpp v30, v137, v18 row_newbcast:2 row_mask:0xf bank_mask:0xf
    v_and_b32_dpp v31, v137, v19 row_newbcast:2 row_mask:0xf bank_mask:0xf
    v_mfma_f32_16x16x32_bf16 v[36:39], v[32:35], v[92:95], v[36:39]
    s_waitcnt vmcnt(7)
    s_cbranch_vccnz L_t11
    s_waitcnt vmcnt(6)
L_t11:
    buffer_load_dwordx4 v[92:95], v135, s[32:35], s51 offen nt
    v_and_b32_dpp v32, v137, v16 row_newbcast:6 row_mask:0xf bank_mask:0xf
    v_and_b32_dpp v33, v137, v17 row_newbcast:6 row_mask:0xf bank_mask:0xf
    v_and_b32_dpp v34, v137, v18 row_newbcast:6 row_mask:0xf bank_mask:0xf
    v_and_b32_dpp v35, v137, v19 row_newbcast:6 row_mask:0xf bank_mask:0xf
    v_mfma_f32_16x16x32_bf16 v[36:39], v[28:31], v[96:99], v[36:39]
    s_waitcnt vmcnt(7)
    s_cbranch_vccnz L_t12
    s_waitcnt vmcnt(6)
L_t12:
    buffer_load_dwordx4 v[96:99], v128, s[32:35], s52 offen nt
    v_and_b32_dpp v28, v137, v16 row_newbcast:10 row_mask:0xf bank_mask:0xf
    v_and_b32_dpp v29, v137, v17 row_newbcast:10 row_mask:0xf bank_mask:0xf
    v_and_b32_dpp v30, v137, v18 row_newbcast:10 row_mask:0xf bank_mask:0xf
    v_and_b32_dpp v31, v137, v19 row_newbcast:10 row_mask:0xf bank_mask:0xf
    v_mfma_f32_16x16x32_bf16 v[36:39], v[32:35], v[100:103], v[36:39]
    s_waitcnt vmcnt(7)
    s_cbranch_vccnz L_t13
    s_waitcnt vmcnt(5)
L_t13:
    buffer_load_dwordx4 v[100:103], v129, s[32:35], s52 offen nt
    buffer_load_dwordx4 a[80:83], v3, s[36:39], s58 offen offset:0
    v_and_b32_dpp v32, v137, v16 row_newbcast:14 row_mask:0xf bank_mask:0xf
    v_and_b32_dpp v33, v137, v17 row_newbcast:14 row_mask:0xf bank_mask:0xf
    v_and_b32_dpp v34, v137, v18 row_newbcast:14 row_mask:0xf bank_mask:0xf
    v_and_b32_dpp v35, v137, v19 row_newbcast:14 row_mask:0xf bank_mask:0xf
    v_mfma_f32_16x16x32_bf16 v[36:39], v[28:31], v[104:107], v[36:39]
    s_waitcnt vmcnt(7)
    s_cbranch_vccnz L_t14
    s_waitcnt vmcnt(6)
L_t14:
    buffer_load_dwordx4 v[104:107], v130, s[32:35], s52 offen nt
    v_and_b32_dpp v28, v137, v16 row_newbcast:3 row_mask:0xf bank_mask:0xf
    v_and_b32_dpp v29, v137, v17 row_newbcast:3 row_mask:0xf bank_mask:0xf
    v_and_b32_dpp v30, v137, v18 row_newbcast:3 row_mask:0xf bank_mask:0xf
    v_and_b32_dpp v31, v137, v19 row_newbcast:3 row_mask:0xf bank_mask:0xf
    v_mfma_f32_16x16x32_bf16 v[36:39], v[32:35], v[108:111], v[36:39]
    s_waitcnt vmcnt(7)
    s_cbranch_vccnz L_t15
    s_waitcnt vmcnt(6)
L_t15:
    buffer_load_dwordx4 v[108:111], v131, s[32:35], s52 offen nt
    v_and_b32_dpp v32, v137, v16 row_newbcast:7 row_mask:0xf bank_mask:0xf
    v_and_b32_dpp v33, v137, v17 row_newbcast:7 row_mask:0xf bank_mask:0xf
    v_and_b32_dpp v34, v137, v18 row_newbcast:7 row_mask:0xf bank_mask:0xf
    v_and_b32_dpp v35, v137, v19 row_newbcast:7 row_mask:0xf bank_mask:0xf
    v_mfma_f32_16x16x32_bf16 v[36:39], v[28:31], v[112:115], v[36:39]
    s_waitcnt vmcnt(7)
    s_cbranch_vccnz L_t16
    s_waitcnt vmcnt(5)
L_t16:
    buffer_load_dwordx4 v[112:115], v132, s[32:35], s52 offen nt
    buffer_load_dwordx4 a[88:91], v3, s[36:39], s58 offen offset:256
    v_and_b32_dpp v28, v137, v16 row_newbcast:11 row_mask:0xf bank_mask:0xf
    v_and_b32_dpp v29, v137, v17 row_newbcast:11 row_mask:0xf bank_mask:0xf
    v_and_b32_dpp v30, v137, v18 row_newbcast:11 row_mask:0xf bank_mask:0xf
    v_and_b32_dpp v31, v137, v19 row_newbcast:11 row_mask:0xf bank_mask:0xf
    v_mfma_f32_16x16x32_bf16 v[36:39], v[32:35], v[116:119], v[36:39]
    s_waitcnt vmcnt(7)
    s_cbranch_vccnz L_t17
    s_waitcnt vmcnt(6)
L_t17:
    buffer_load_dwordx4 v[116:119], v133, s[32:35], s52 offen nt
    v_and_b32_dpp v32, v137, v16 row_newbcast:15 row_mask:0xf bank_mask:0xf
    v_and_b32_dpp v33, v137, v17 row_newbcast:15 row_mask:0xf bank_mask:0xf
    v_and_b32_dpp v34, v137, v18 row_newbcast:15 row_mask:0xf bank_mask:0xf
    v_and_b32_dpp v35, v137, v19 row_newbcast:15 row_mask:0xf bank_mask:0xf
    v_mfma_f32_16x16x32_bf16 v[36:39], v[28:31], v[120:123], v[36:39]
    s_waitcnt vmcnt(7)
    s_cbranch_vccnz L_t18
    s_waitcnt vmcnt(6)
L_t18:
    buffer_load_dwordx4 v[120:123], v134, s[32:35], s52 offen nt
    v_mfma_f32_16x16x32_bf16 v[36:39], v[32:35], v[124:127], v[36:39]
    s_waitcnt vmcnt(7)
    s_cbranch_vccnz L_t19
    s_waitcnt vmcnt(5)
L_t19:
    buffer_load_dwordx4 v[124:127], v135, s[32:35], s52 offen nt
    buffer_load_dwordx4 a[96:99], v3, s[36:39], s58 offen offset:512
    s_add_u32 s51, s51, 0x20000
    s_add_u32 s52, s52, 0x20000
    buffer_load_dwordx2 v[196:197], v15, s[40:43], s99 offen offset:16 sc1
    s_cmp_gt_i32 s75, 0
    s_cselect_b64 vcc, -1, 0
    s_sub_i32 s75, s75, 1
    v_and_b32_dpp v28, v138, v16 row_newbcast:0 row_mask:0xf bank_mask:0xf
    v_and_b32_dpp v29, v138, v17 row_newbcast:0 row_mask:0xf bank_mask:0xf
    v_and_b32_dpp v30, v138, v18 row_newbcast:0 row_mask:0xf bank_mask:0xf
    v_and_b32_dpp v31, v138, v19 row_newbcast:0 row_mask:0xf bank_mask:0xf
    v_and_b32_dpp v32, v138, v16 row_newbcast:4 row_mask:0xf bank_mask:0xf
    v_and_b32_dpp v33, v138, v17 row_newbcast:4 row_mask:0xf bank_mask:0xf
    v_and_b32_dpp v34, v138, v18 row_newbcast:4 row_mask:0xf bank_mask:0xf
    v_and_b32_dpp v35, v138, v19 row_newbcast:4 row_mask:0xf bank_mask:0xf
    v_mfma_f32_16x16x32_bf16 v[36:39], v[28:31], v[64:67], v[36:39]
    s_waitcnt vmcnt(8)
    s_cbranch_vccnz L_t20
    s_waitcnt vmcnt(7)
L_t20:
    buffer_load_dwordx4 v[64:67], v128, s[32:35], s51 offen nt
    v_and_b32_dpp v28, v138, v16 row_newbcast:8 row_mask:0xf bank_mask:0xf
    v_and_b32_dpp v29, v138, v17 row_newbcast:8 row_mask:0xf bank_mask:0xf
    v_and_b32_dpp v30, v138, v18 row_newbcast:8 row_mask:0xf bank_mask:0xf
    v_and_b32_dpp v31, v138, v19 row_newbcast:8 row_mask:0xf bank_mask:0xf
    v_mfma_f32_16x16x32_bf16 v[36:39], v[32:35], v[68:71], v[36:39]
    s_waitcnt vmcnt(8)
    s_cbranch_vccnz L_t21
    s_waitcnt vmcnt(7)
L_t21:
    buffer_load_dwordx4 v[68:71], v129, s[32:35], s51 offen nt
    v_and_b32_dpp v32, v138, v16 row_newbcast:12 row_mask:0xf bank_mask:0xf
    v_and_b32_dpp v33, v138, v17 row_newbcast:12 row_mask:0xf bank_mask:0xf
    v_and_b32_dpp v34, v138, v18 row_newbcast:12 row_mask:0xf bank_mask:0xf
    v_and_b32_dpp v35, v138, v19 row_newbcast:12 row_mask:0xf bank_mask:0xf
    v_mfma_f32_16x16x32_bf16 v[36:39], v[28:31], v[72:75], v[36:39]
    s_waitcnt vmcnt(8)
    s_cbranch_vccnz L_t22
    s_waitcnt vmcnt(6)
L_t22:
    buffer_load_dwordx4 v[72:75], v130, s[32:35], s51 offen nt
    v_and_b32_dpp v28, v138, v16 row_newbcast:1 row_mask:0xf bank_mask:0xf
    v_and_b32_dpp v29, v138, v17 row_newbcast:1 row_mask:0xf bank_mask:0xf
    v_and_b32_dpp v30, v138, v18 row_newbcast:1 row_mask:0xf bank_mask:0xf
    v_and_b32_dpp v31, v138, v19 row_newbcast:1 row_mask:0xf bank_mask:0xf
    v_mfma_f32_16x16x32_bf16 v[36:39], v[32:35], v[76:79], v[36:39]
    s_waitcnt vmcnt(7)
    s_cbranch_vccnz L_t23
    s_waitcnt vmcnt(6)
L_t23:
    buffer_load_dwordx4 v[76:79], v131, s[32:35], s51 offen nt
    buffer_load_dwordx4 a[104:107], v3, s[36:39], s58 offen offset:768
    v_and_b32_dpp v32, v138, v16 row_newbcast:5 row_mask:0xf bank_mask:0xf
    v_and_b32_dpp v33, v138, v17 row_newbcast:5 row_mask:0xf bank_mask:0xf
    v_and_b32_dpp v34, v138, v18 row_newbcast:5 row_mask:0xf bank_mask:0xf
    v_and_b32_dpp v35, v138, v19 row_newbcast:5 row_mask:0xf bank_mask:0xf
    v_mfma_f32_16x16x32_bf16 v[36:39], v[28:31], v[80:83], v[36:39]
    s_waitcnt vmcnt(8)
    s_cbranch_vccnz L_t24
    s_waitcnt vmcnt(7)
L_t24:
    buffer_load_dwordx4 v[80:83], v132, s[32:35], s51 offen nt
    v_and_b32_dpp v28, v138, v16 row_newbcast:9 row_mask:0xf bank_mask:0xf
    v_and_b32_dpp v29, v138, v17 row_newbcast:9 row_mask:0xf bank_mask:0xf
    v_and_b32_dpp v30, v138, v18 row_newbcast:9 row_mask:0xf bank_mask:0xf
    v_and_b32_dpp v31, v138, v19 row_newbcast:9 row_mask:0xf bank_mask:0xf
    v_mfma_f32_16x16x32_bf16 v[36:39], v[32:35], v[84:87], v[36:39]
    s_waitcnt vmcnt(8)
    s_cbranch_vccnz L_t25
    s_waitcnt vmcnt(5)
L_t25:
    buffer_load_dwordx4 v[84:87], v133, s[32:35], s51 offen nt
    v_and_b32_dpp v32, v138, v16 row_newbcast:13 row_mask:0xf bank_mask:0xf
    v_and_b32_dpp v33, v138, v17 row_newbcast:13 row_mask:0xf bank_mask:0xf
    v_and_b32_dpp v34, v138, v18 row_newbcast:13 row_mask:0xf bank_mask:0xf
    v_and_b32_dpp v35, v138, v19 row_newbcast:13 row_mask:0xf bank_mask:0xf
    v_mfma_f32_16x16x32_bf16 v[36:39], v[28:31], v[88:91], v[36:39]
    s_waitcnt vmcnt(6)
    s_cbranch_vccnz L_t26
    s_waitcnt vmcnt(5)
L_t26:
    buffer_load_dwordx4 v[88:91], v134, s[32:35], s51 offen nt
    v_and_b32_dpp v28, v138, v16 row_newbcast:2 row_mask:0xf bank_mask:0xf
    v_and_b32_dpp v29, v138, v17 row_newbcast:2 row_mask:0xf bank_mask:0xf
    v_and_b32_dpp v30, v138, v18 row_newbcast:2 row_mask:0xf bank_mask:0xf
    v_and_b32_dpp v31, v138, v19 row_newbcast:2 row_mask:0xf bank_mask:0xf
    v_mfma_f32_16x16x32_bf16 v[36:39], v[32:35], v[92:95], v[36:39]
    s_waitcnt vmcnt(6)
    s_cbranch_vccnz L_t27
    s_waitcnt vmcnt(5)
L_t27:
    buffer_load_dwordx4 v[92:95], v135, s[32:35], s51 offen nt
    buffer_load_dwordx4 a[112:115], v3, s[36:39], s58 offen offset:1024
    s_cmp_eq_u32 s71, 5
    s_cselect_b32 s63, 0xffff7400, s73
    s_add_u32 s58, s58, s63
    v_and_b32_dpp v32, v138, v16 row_newbcast:6 row_mask:0xf bank_mask:0xf
    v_and_b32_dpp v33, v138, v17 row_newbcast:6 row_mask:0xf bank_mask:0xf
    v_and_b32_dpp v34, v138, v18 row_newbcast:6 row_mask:0xf bank_mask:0xf
    v_and_b32_dpp v35, v138, v19 row_newbcast:6 row_mask:0xf bank_mask:0xf
    v_mfma_f32_16x16x32_bf16 v[36:39], v[28:31], v[96:99], v[36:39]
    s_waitcnt vmcnt(7)
    s_cbranch_vccnz L_t28
    s_waitcnt vmcnt(6)
L_t28:
    buffer_load_dwordx4 v[96:99], v128, s[32:35], s52 offen nt
    v_and_b32_dpp v28, v138, v16 row_newbcast:10 row_mask:0xf bank_mask:0xf
    v_and_b32_dpp v29, v138, v17 row_newbcast:10 row_mask:0xf bank_mask:0xf
    v_and_b32_dpp v30, v138, v18 row_newbcast:10 row_mask:0xf bank_mask:0xf
    v_and_b32_dpp v31, v138, v19 row_newbcast:10 row_mask:0xf bank_mask:0xf
    v_mfma_f32_16x16x32_bf16 v[36:39], v[32:35], v[100:103], v[36:39]
    s_waitcnt vmcnt(7)
    s_cbranch_vccnz L_t29
    s_waitcnt vmcnt(5)
L_t29:
    buffer_load_dwordx4 v[100:103], v129, s[32:35], s52 offen nt
    v_and_b32_dpp v32, v138, v16 row_newbcast:14 row_mask:0xf bank_mask:0xf
    v_and_b32_dpp v33, v138, v17 row_newbcast:14 row_mask:0xf bank_mask:0xf
    v_and_b32_dpp v34, v138, v18 row_newbcast:14 row_mask:0xf bank_mask:0xf
    v_and_b32_dpp v35, v138, v19 row_newbcast:14 row_mask:0xf bank_mask:0xf
    v_mfma_f32_16x16x32_bf16 v[36:39], v[28:31], v[104:107], v[36:39]
    s_waitcnt vmcnt(6)
    s_cbranch_vccnz L_t30
    s_waitcnt vmcnt(5)
L_t30:
    buffer_load_dwordx4 v[104:107], v130, s[32:35], s52 offen nt
    v_and_b32_dpp v28, v138, v16 row_newbcast:3 row_mask:0xf bank_mask:0xf
    v_and_b32_dpp v29, v138, v17 row_newbcast:3 row_mask:0xf bank_mask:0xf
    v_and_b32_dpp v30, v138, v18 row_newbcast:3 row_mask:0xf bank_mask:0xf
    v_and_b32_dpp v31, v138, v19 row_newbcast:3 row_mask:0xf bank_mask:0xf
    v_mfma_f32_16x16x32_bf16 v[36:39], v[32:35], v[108:111], v[36:39]
    s_waitcnt vmcnt(6)
    s_cbranch_vccnz L_t31
    s_waitcnt vmcnt(5)
L_t31:
    buffer_load_dwordx4 v[108:111], v131, s[32:35], s52 offen nt
    buffer_load_dwordx4 a[120:123], v3, s[36:39], s58 offen offset:0
    v_and_b32_dpp v32, v138, v16 row_newbcast:7 row_mask:0xf bank_mask:0xf
    v_and_b32_dpp v33, v138, v17 row_newbcast:7 row_mask:0xf bank_mask:0xf
    v_and_b32_dpp v34, v138, v18 row_newbcast:7 row_mask:0xf bank_mask:0xf
    v_and_b32_dpp v35, v138, v19 row_newbcast:7 row_mask:0xf bank_mask:0xf
    v_mfma_f32_16x16x32_bf16 v[36:39], v[28:31], v[112:115], v[36:39]
    s_waitcnt vmcnt(7)
    s_cbranch_vccnz L_t32
    s_waitcnt vmcnt(6)
L_t32:
    buffer_load_dwordx4 v[112:115], v132, s[32:35], s52 offen nt
    s_mov_b32 s57, 0
L_ps0:
    v_xor_b32 v54, v196, v200
    v_xor_b32 v55, v197, v201
    v_and_b32 v54, v54, v55
    s_nop 0
    v_readfirstlane_b32 s54, v54
    s_nop 0
    s_bitcmp1_b32 s54, 0
    s_cbranch_scc1 L_pd0
    s_add_u32 s57, s57, 1
    s_cmp_ge_u32 s57, 0x400
    s_cbranch_scc1 L_pd0
    buffer_load_dwordx2 v[196:197], v15, s[40:43], s99 offen offset:16 sc1
    s_waitcnt vmcnt(0)
    s_branch L_ps0
L_pd0:
    v_and_b32 v196, -2, v196
    v_and_b32 v197, -2, v197
    v_max_f32 v54, v224, v196
    v_sub_f32 v55, v224, v54
    v_sub_f32 v54, v196, v54
    v_mul_f32 v55, 0x3fb8aa3b, v55
    v_mul_f32 v54, 0x3fb8aa3b, v54
    v_exp_f32 v55, v55
    v_exp_f32 v54, v54
    v_mul_f32 v55, v55, v225
    v_fma_f32 v54, v54, v197, v55
    v_rcp_f32 v54, v54
    s_nop 0
    v_mul_f32 v198, v55, v54
    v_and_b32_dpp v28, v138, v16 row_newbcast:11 row_mask:0xf bank_mask:0xf
    v_and_b32_dpp v29, v138, v17 row_newbcast:11 row_mask:0xf bank_mask:0xf
    v_and_b32_dpp v30, v138, v18 row_newbcast:11 row_mask:0xf bank_mask:0xf
    v_and_b32_dpp v31, v138, v19 row_newbcast:11 row_mask:0xf bank_mask:0xf
    v_mfma_f32_16x16x32_bf16 v[36:39], v[32:35], v[116:119], v[36:39]
    s_waitcnt vmcnt(7)
    s_cbranch_vccnz L_t33
    s_waitcnt vmcnt(5)
L_t33:
    buffer_load_dwordx4 v[116:119], v133, s[32:35], s52 offen nt
    v_and_b32_dpp v32, v138, v16 row_newbcast:15 row_mask:0xf bank_mask:0xf
    v_and_b32_dpp v33, v138, v17 row_newbcast:15 row_mask:0xf bank_mask:0xf
    v_and_b32_dpp v34, v138, v18 row_newbcast:15 row_mask:0xf bank_mask:0xf
    v_and_b32_dpp v35, v138, v19 row_newbcast:15 row_mask:0xf bank_mask:0xf
    v_mfma_f32_16x16x32_bf16 v[36:39], v[28:31], v[120:123], v[36:39]
    s_waitcnt vmcnt(6)
    s_cbranch_vccnz L_t34
    s_waitcnt vmcnt(5)
L_t34:
    buffer_load_dwordx4 v[120:123], v134, s[32:35], s52 offen nt
    v_mfma_f32_16x16x32_bf16 v[36:39], v[32:35], v[124:127], v[36:39]
    s_waitcnt vmcnt(6)
    s_cbranch_vccnz L_t35
    s_waitcnt vmcnt(5)
L_t35:
    buffer_load_dwordx4 v[124:127], v135, s[32:35], s52 offen nt
    buffer_load_dwordx4 a[128:131], v3, s[36:39], s58 offen offset:256
    s_add_u32 s51, s51, 0x20000
    s_add_u32 s52, s52, 0x20000
    s_cmp_gt_i32 s75, 0
    s_cselect_b64 vcc, -1, 0
    s_sub_i32 s75, s75, 1
    v_and_b32_dpp v28, v139, v16 row_newbcast:0 row_mask:0xf bank_mask:0xf
    v_and_b32_dpp v29, v139, v17 row_newbcast:0 row_mask:0xf bank_mask:0xf
    v_and_b32_dpp v30, v139, v18 row_newbcast:0 row_mask:0xf bank_mask:0xf
    v_and_b32_dpp v31, v139, v19 row_newbcast:0 row_mask:0xf bank_mask:0xf
    v_and_b32_dpp v32, v139, v16 row_newbcast:4 row_mask:0xf bank_mask:0xf
    v_and_b32_dpp v33, v139, v17 row_newbcast:4 row_mask:0xf bank_mask:0xf
    v_and_b32_dpp v34, v139, v18 row_newbcast:4 row_mask:0xf bank_mask:0xf
    v_and_b32_dpp v35, v139, v19 row_newbcast:4 row_mask:0xf bank_mask:0xf
    v_mfma_f32_16x16x32_bf16 v[36:39], v[28:31], v[64:67], v[36:39]
    s_waitcnt vmcnt(7)
    s_cbranch_vccnz L_t36
    s_waitcnt vmcnt(6)
L_t36:
    buffer_load_dwordx4 v[64:67], v128, s[32:35], s51 offen nt
    v_and_b32_dpp v28, v139, v16 row_newbcast:8 row_mask:0xf bank_mask:0xf
    v_and_b32_dpp v29, v139, v17 row_newbcast:8 row_mask:0xf bank_mask:0xf
    v_and_b32_dpp v30, v139, v18 row_newbcast:8 row_mask:0xf bank_mask:0xf
    v_and_b32_dpp v31, v139, v19 row_newbcast:8 row_mask:0xf bank_mask:0xf
    v_mfma_f32_16x16x32_bf16 v[36:39], v[32:35], v[68:71], v[36:39]
    s_waitcnt vmcnt(7)
    s_cbranch_vccnz L_t37
    s_waitcnt vmcnt(5)
L_t37:
    buffer_load_dwordx4 v[68:71], v129, s[32:35], s51 offen nt
    v_and_b32_dpp v32, v139, v16 row_newbcast:12 row_mask:0xf bank_mask:0xf
    v_and_b32_dpp v33, v139, v17 row_newbcast:12 row_mask:0xf bank_mask:0xf
    v_and_b32_dpp v34, v139, v18 row_newbcast:12 row_mask:0xf bank_mask:0xf
    v_and_b32_dpp v35, v139, v19 row_newbcast:12 row_mask:0xf bank_mask:0xf
    v_mfma_f32_16x16x32_bf16 v[36:39], v[28:31], v[72:75], v[36:39]
    s_waitcnt vmcnt(6)
    s_cbranch_vccnz L_t38
    s_waitcnt vmcnt(5)
L_t38:
    buffer_load_dwordx4 v[72:75], v130, s[32:35], s51 offen nt
    v_and_b32_dpp v28, v139, v16 row_newbcast:1 row_mask:0xf bank_mask:0xf
    v_and_b32_dpp v29, v139, v17 row_newbcast:1 row_mask:0xf bank_mask:0xf
    v_and_b32_dpp v30, v139, v18 row_newbcast:1 row_mask:0xf bank_mask:0xf
    v_and_b32_dpp v31, v139, v19 row_newbcast:1 row_mask:0xf bank_mask:0xf
    v_mfma_f32_16x16x32_bf16 v[36:39], v[32:35], v[76:79], v[36:39]
    s_waitcnt vmcnt(6)
    s_cbranch_vccnz L_t39
    s_waitcnt vmcnt(5)
L_t39:
    buffer_load_dwordx4 v[76:79], v131, s[32:35], s51 offen nt
    buffer_load_dwordx4 a[136:139], v3, s[36:39], s58 offen offset:512
    v_and_b32_dpp v32, v139, v16 row_newbcast:5 row_mask:0xf bank_mask:0xf
    v_and_b32_dpp v33, v139, v17 row_newbcast:5 row_mask:0xf bank_mask:0xf
    v_and_b32_dpp v34, v139, v18 row_newbcast:5 row_mask:0xf bank_mask:0xf
    v_and_b32_dpp v35, v139, v19 row_newbcast:5 row_mask:0xf bank_mask:0xf
    v_mfma_f32_16x16x32_bf16 v[36:39], v[28:31], v[80:83], v[36:39]
    s_waitcnt vmcnt(7)
    s_cbranch_vccnz L_t40
    s_waitcnt vmcnt(6)
L_t40:
    buffer_load_dwordx4 v[80:83], v132, s[32:35], s51 offen nt
    v_and_b32_dpp v28, v139, v16 row_newbcast:9 row_mask:0xf bank_mask:0xf
    v_and_b32_dpp v29, v139, v17 row_newbcast:9 row_mask:0xf bank_mask:0xf
    v_and_b32_dpp v30, v139, v18 row_newbcast:9 row_mask:0xf bank_mask:0xf
    v_and_b32_dpp v31, v139, v19 row_newbcast:9 row_mask:0xf bank_mask:0xf
    v_mfma_f32_16x16x32_bf16 v[36:39], v[32:35], v[84:87], v[36:39]
    s_waitcnt vmcnt(7)
    s_cbranch_vccnz L_t41
    s_waitcnt vmcnt(5)
L_t41:
    buffer_load_dwordx4 v[84:87], v133, s[32:35], s51 offen nt
    v_and_b32_dpp v32, v139, v16 row_newbcast:13 row_mask:0xf bank_mask:0xf
    v_and_b32_dpp v33, v139, v17 row_newbcast:13 row_mask:0xf bank_mask:0xf
    v_and_b32_dpp v34, v139, v18 row_newbcast:13 row_mask:0xf bank_mask:0xf
    v_and_b32_dpp v35, v139, v19 row_newbcast:13 row_mask:0xf bank_mask:0xf
    v_mfma_f32_16x16x32_bf16 v[36:39], v[28:31], v[88:91], v[36:39]
    s_waitcnt vmcnt(6)
    s_cbranch_vccnz L_t42
    s_waitcnt vmcnt(5)
L_t42:
    buffer_load_dwordx4 v[88:91], v134, s[32:35], s51 offen nt
    buffer_load_dwordx4 a[144:147], v3, s[36:39], s58 offen offset:768
    v_and_b32_dpp v28, v139, v16 row_newbcast:2 row_mask:0xf bank_mask:0xf
    v_and_b32_dpp v29, v139, v17 row_newbcast:2 row_mask:0xf bank_mask:0xf
    v_and_b32_dpp v30, v139, v18 row_newbcast:2 row_mask:0xf bank_mask:0xf
    v_and_b32_dpp v31, v139, v19 row_newbcast:2 row_mask:0xf bank_mask:0xf
    v_mfma_f32_16x16x32_bf16 v[36:39], v[32:35], v[92:95], v[36:39]
    s_waitcnt vmcnt(7)
    s_cbranch_vccnz L_t43
    s_waitcnt vmcnt(6)
L_t43:
    buffer_load_dwordx4 v[92:95], v135, s[32:35], s51 offen nt
    v_and_b32_dpp v32, v139, v16 row_newbcast:6 row_mask:0xf bank_mask:0xf
    v_and_b32_dpp v33, v139, v17 row_newbcast:6 row_mask:0xf bank_mask:0xf
    v_and_b32_dpp v34, v139, v18 row_newbcast:6 row_mask:0xf bank_mask:0xf
    v_and_b32_dpp v35, v139, v19 row_newbcast:6 row_mask:0xf bank_mask:0xf
    v_mfma_f32_16x16x32_bf16 v[36:39], v[28:31], v[96:99], v[36:39]
    s_waitcnt vmcnt(7)
    s_cbranch_vccnz L_t44
    s_waitcnt vmcnt(6)
L_t44:
    buffer_load_dwordx4 v[96:99], v128, s[32:35], s52 offen nt
    v_and_b32_dpp v28, v139, v16 row_newbcast:10 row_mask:0xf bank_mask:0xf
    v_and_b32_dpp v29, v139, v17 row_newbcast:10 row_mask:0xf bank_mask:0xf
    v_and_b32_dpp v30, v139, v18 row_newbcast:10 row_mask:0xf bank_mask:0xf
    v_and_b32_dpp v31, v139, v19 row_newbcast:10 row_mask:0xf bank_mask:0xf
    v_mfma_f32_16x16x32_bf16 v[36:39], v[32:35], v[100:103], v[36:39]
    s_waitcnt vmcnt(7)
    s_cbranch_vccnz L_t45
    s_waitcnt vmcnt(5)
L_t45:
    buffer_load_dwordx4 v[100:103], v129, s[32:35], s52 offen nt
    buffer_load_dwordx4 a[152:155], v3, s[36:39], s58 offen offset:1024
    s_cmp_eq_u32 s71, 4
    s_cselect_b32 s63, 0xffff7400, s73
    s_add_u32 s58, s58, s63
    v_and_b32_dpp v32, v139, v16 row_newbcast:14 row_mask:0xf bank_mask:0xf
    v_and_b32_dpp v33, v139, v17 row_newbcast:14 row_mask:0xf bank_mask:0xf
    v_and_b32_dpp v34, v139, v18 row_newbcast:14 row_mask:0xf bank_mask:0xf
    v_and_b32_dpp v35, v139, v19 row_newbcast:14 row_mask:0xf bank_mask:0xf
    v_mfma_f32_16x16x32_bf16 v[36:39], v[28:31], v[104:107], v[36:39]
    s_waitcnt vmcnt(7)
    s_cbranch_vccnz L_t46
    s_waitcnt vmcnt(6)
L_t46:
    buffer_load_dwordx4 v[104:107], v130, s[32:35], s52 offen nt
    v_and_b32_dpp v28, v139, v16 row_newbcast:3 row_mask:0xf bank_mask:0xf
    v_and_b32_dpp v29, v139, v17 row_newbcast:3 row_mask:0xf bank_mask:0xf
    v_and_b32_dpp v30, v139, v18 row_newbcast:3 row_mask:0xf bank_mask:0xf
    v_and_b32_dpp v31, v139, v19 row_newbcast:3 row_mask:0xf bank_mask:0xf
    v_mfma_f32_16x16x32_bf16 v[36:39], v[32:35], v[108:111], v[36:39]
    s_waitcnt vmcnt(7)
    s_cbranch_vccnz L_t47
    s_waitcnt vmcnt(6)
L_t47:
    buffer_load_dwordx4 v[108:111], v131, s[32:35], s52 offen nt
    v_and_b32_dpp v32, v139, v16 row_newbcast:7 row_mask:0xf bank_mask:0xf
    v_and_b32_dpp v33, v139, v17 row_newbcast:7 row_mask:0xf bank_mask:0xf
    v_and_b32_dpp v34, v139, v18 row_newbcast:7 row_mask:0xf bank_mask:0xf
    v_and_b32_dpp v35, v139, v19 row_newbcast:7 row_mask:0xf bank_mask:0xf
    v_mfma_f32_16x16x32_bf16 v[36:39], v[28:31], v[112:115], v[36:39]
    s_waitcnt vmcnt(7)
    s_cbranch_vccnz L_t48
    s_waitcnt vmcnt(5)
L_t48:
    buffer_load_dwordx4 v[112:115], v132, s[32:35], s52 offen nt
    buffer_load_dwordx4 a[4:7], v3, s[36:39], s58 offen offset:0
    v_and_b32_dpp v28, v139, v16 row_newbcast:11 row_mask:0xf bank_mask:0xf
    v_and_b32_dpp v29, v139, v17 row_newbcast:11 row_mask:0xf bank_mask:0xf
    v_and_b32_dpp v30, v139, v18 row_newbcast:11 row_mask:0xf bank_mask:0xf
    v_and_b32_dpp v31, v139, v19 row_newbcast:11 row_mask:0xf bank_mask:0xf
    v_mfma_f32_16x16x32_bf16 v[36:39], v[32:35], v[116:119], v[36:39]
    s_waitcnt vmcnt(7)
    s_cbranch_vccnz L_t49
    s_waitcnt vmcnt(6)
L_t49:
    buffer_load_dwordx4 v[116:119], v133, s[32:35], s52 offen nt
    v_and_b32_dpp v32, v139, v16 row_newbcast:15 row_mask:0xf bank_mask:0xf
    v_and_b32_dpp v33, v139, v17 row_newbcast:15 row_mask:0xf bank_mask:0xf
    v_and_b32_dpp v34, v139, v18 row_newbcast:15 row_mask:0xf bank_mask:0xf
    v_and_b32_dpp v35, v139, v19 row_newbcast:15 row_mask:0xf bank_mask:0xf
    v_mfma_f32_16x16x32_bf16 v[36:39], v[28:31], v[120:123], v[36:39]
    s_waitcnt vmcnt(7)
    s_cbranch_vccnz L_t50
    s_waitcnt vmcnt(6)
L_t50:
    buffer_load_dwordx4 v[120:123], v134, s[32:35], s52 offen nt
    v_mfma_f32_16x16x32_bf16 v[36:39], v[32:35], v[124:127], v[36:39]
    s_waitcnt vmcnt(7)
    s_cbranch_vccnz L_t51
    s_waitcnt vmcnt(5)
L_t51:
    buffer_load_dwordx4 v[124:127], v135, s[32:35], s52 offen nt
    buffer_load_dwordx4 a[12:15], v3, s[36:39], s58 offen offset:256
    s_add_u32 s51, s51, 0x20000
    s_add_u32 s52, s52, 0x20000
    s_cmp_gt_i32 s75, 0
    s_cselect_b64 vcc, -1, 0
    s_sub_i32 s75, s75, 1
    v_and_b32_dpp v28, v140, v16 row_newbcast:0 row_mask:0xf bank_mask:0xf
    v_and_b32_dpp v29, v140, v17 row_newbcast:0 row_mask:0xf bank_mask:0xf
    v_and_b32_dpp v30, v140, v18 row_newbcast:0 row_mask:0xf bank_mask:0xf
    v_and_b32_dpp v31, v140, v19 row_newbcast:0 row_mask:0xf bank_mask:0xf
    v_and_b32_dpp v32, v140, v16 row_newbcast:4 row_mask:0xf bank_mask:0xf
    v_and_b32_dpp v33, v140, v17 row_newbcast:4 row_mask:0xf bank_mask:0xf
    v_and_b32_dpp v34, v140, v18 row_newbcast:4 row_mask:0xf bank_mask:0xf
    v_and_b32_dpp v35, v140, v19 row_newbcast:4 row_mask:0xf bank_mask:0xf
    v_mfma_f32_16x16x32_bf16 v[36:39], v[28:31], v[64:67], v[36:39]
    s_waitcnt vmcnt(7)
    s_cbranch_vccnz L_t52
    s_waitcnt vmcnt(6)
L_t52:
    buffer_load_dwordx4 v[64:67], v128, s[32:35], s51 offen nt
    v_and_b32_dpp v28, v140, v16 row_newbcast:8 row_mask:0xf bank_mask:0xf
    v_and_b32_dpp v29, v140, v17 row_newbcast:8 row_mask:0xf bank_mask:0xf
    v_and_b32_dpp v30, v140, v18 row_newbcast:8 row_mask:0xf bank_mask:0xf
    v_and_b32_dpp v31, v140, v19 row_newbcast:8 row_mask:0xf bank_mask:0xf
    v_mfma_f32_16x16x32_bf16 v[36:39], v[32:35], v[68:71], v[36:39]
    s_waitcnt vmcnt(7)
    s_cbranch_vccnz L_t53
    s_waitcnt vmcnt(6)
L_t53:
    buffer_load_dwordx4 v[68:71], v129, s[32:35], s51 offen nt
    v_and_b32_dpp v32, v140, v16 row_newbcast:12 row_mask:0xf bank_mask:0xf
    v_and_b32_dpp v33, v140, v17 row_newbcast:12 row_mask:0xf bank_mask:0xf
    v_and_b32_dpp v34, v140, v18 row_newbcast:12 row_mask:0xf bank_mask:0xf
    v_and_b32_dpp v35, v140, v19 row_newbcast:12 row_mask:0xf bank_mask:0xf
    v_mfma_f32_16x16x32_bf16 v[36:39], v[28:31], v[72:75], v[36:39]
    s_waitcnt vmcnt(7)
    s_cbranch_vccnz L_t54
    s_waitcnt vmcnt(5)
L_t54:
    buffer_load_dwordx4 v[72:75], v130, s[32:35], s51 offen nt
    v_and_b32_dpp v28, v140, v16 row_newbcast:1 row_mask:0xf bank_mask:0xf
    v_and_b32_dpp v29, v140, v17 row_newbcast:1 row_mask:0xf bank_mask:0xf
    v_and_b32_dpp v30, v140, v18 row_newbcast:1 row_mask:0xf bank_mask:0xf
    v_and_b32_dpp v31, v140, v19 row_newbcast:1 row_mask:0xf bank_mask:0xf
    v_mfma_f32_16x16x32_bf16 v[36:39], v[32:35], v[76:79], v[36:39]
    s_waitcnt vmcnt(6)
    s_cbranch_vccnz L_t55
    s_waitcnt vmcnt(5)
L_t55:
    buffer_load_dwordx4 v[76:79], v131, s[32:35], s51 offen nt
    buffer_load_dwordx4 a[20:23], v3, s[36:39], s58 offen offset:512
    v_and_b32_dpp v32, v140, v16 row_newbcast:5 row_mask:0xf bank_mask:0xf
    v_and_b32_dpp v33, v140, v17 row_newbcast:5 row_mask:0xf bank_mask:0xf
    v_and_b32_dpp v34, v140, v18 row_newbcast:5 row_mask:0xf bank_mask:0xf
    v_and_b32_dpp v35, v140, v19 row_newbcast:5 row_mask:0xf bank_mask:0xf
    v_mfma_f32_16x16x32_bf16 v[36:39], v[28:31], v[80:83], v[36:39]
    s_waitcnt vmcnt(7)
    s_cbranch_vccnz L_t56
    s_waitcnt vmcnt(6)
L_t56:
    buffer_load_dwordx4 v[80:83], v132, s[32:35], s51 offen nt
    v_and_b32_dpp v28, v140, v16 row_newbcast:9 row_mask:0xf bank_mask:0xf
    v_and_b32_dpp v29, v140, v17 row_newbcast:9 row_mask:0xf bank_mask:0xf
    v_and_b32_dpp v30, v140, v18 row_newbcast:9 row_mask:0xf bank_mask:0xf
    v_and_b32_dpp v31, v140, v19 row_newbcast:9 row_mask:0xf bank_mask:0xf
    v_mfma_f32_16x16x32_bf16 v[36:39], v[32:35], v[84:87], v[36:39]
    s_waitcnt vmcnt(7)
    s_cbranch_vccnz L_t57
    s_waitcnt vmcnt(5)
L_t57:
    buffer_load_dwordx4 v[84:87], v133, s[32:35], s51 offen nt
    v_and_b32_dpp v32, v140, v16 row_newbcast:13 row_mask:0xf bank_mask:0xf
    v_and_b32_dpp v33, v140, v17 row_newbcast:13 row_mask:0xf bank_mask:0xf
    v_and_b32_dpp v34, v140, v18 row_newbcast:13 row_mask:0xf bank_mask:0xf
    v_and_b32_dpp v35, v140, v19 row_newbcast:13 row_mask:0xf bank_mask:0xf
    v_mfma_f32_16x16x32_bf16 v[36:39], v[28:31], v[88:91], v[36:39]
    s_waitcnt vmcnt(6)
    s_cbranch_vccnz L_t58
    s_waitcnt vmcnt(5)
L_t58:
    buffer_load_dwordx4 v[88:91], v134, s[32:35], s51 offen nt
    v_and_b32_dpp v28, v140, v16 row_newbcast:2 row_mask:0xf bank_mask:0xf
    v_and_b32_dpp v29, v140, v17 row_newbcast:2 row_mask:0xf bank_mask:0xf
    v_and_b32_dpp v30, v140, v18 row_newbcast:2 row_mask:0xf bank_mask:0xf
    v_and_b32_dpp v31, v140, v19 row_newbcast:2 row_mask:0xf bank_mask:0xf
    v_mfma_f32_16x16x32_bf16 v[36:39], v[32:35], v[92:95], v[36:39]
    s_waitcnt vmcnt(6)
    s_cbranch_vccnz L_t59
    s_waitcnt vmcnt(5)
L_t59:
    buffer_load_dwordx4 v[92:95], v135, s[32:35], s51 offen nt
    buffer_load_dwordx4 a[28:31], v3, s[36:39], s58 offen offset:768
    v_and_b32_dpp v32, v140, v16 row_newbcast:6 row_mask:0xf bank_mask:0xf
    v_and_b32_dpp v33, v140, v17 row_newbcast:6 row_mask:0xf bank_mask:0xf
    v_and_b32_dpp v34, v140, v18 row_newbcast:6 row_mask:0xf bank_mask:0xf
    v_and_b32_dpp v35, v140, v19 row_newbcast:6 row_mask:0xf bank_mask:0xf
    v_mfma_f32_16x16x32_bf16 v[36:39], v[28:31], v[96:99], v[36:39]
    s_waitcnt vmcnt(7)
    s_cbranch_vccnz L_t60
    s_waitcnt vmcnt(6)
L_t60:
    buffer_load_dwordx4 v[96:99], v128, s[32:35], s52 offen nt
    v_and_b32_dpp v28, v140, v16 row_newbcast:10 row_mask:0xf bank_mask:0xf
    v_and_b32_dpp v29, v140, v17 row_newbcast:10 row_mask:0xf bank_mask:0xf
    v_and_b32_dpp v30, v140, v18 row_newbcast:10 row_mask:0xf bank_mask:0xf
    v_and_b32_dpp v31, v140, v19 row_newbcast:10 row_mask:0xf bank_mask:0xf
    v_mfma_f32_16x16x32_bf16 v[36:39], v[32:35], v[100:103], v[36:39]
    s_waitcnt vmcnt(7)
    s_cbranch_vccnz L_t61
    s_waitcnt vmcnt(5)
L_t61:
    buffer_load_dwordx4 v[100:103], v129, s[32:35], s52 offen nt
    v_and_b32_dpp v32, v140, v16 row_newbcast:14 row_mask:0xf bank_mask:0xf
    v_and_b32_dpp v33, v140, v17 row_newbcast:14 row_mask:0xf bank_mask:0xf
    v_and_b32_dpp v34, v140, v18 row_newbcast:14 row_mask:0xf bank_mask:0xf
    v_and_b32_dpp v35, v140, v19 row_newbcast:14 row_mask:0xf bank_mask:0xf
    v_mfma_f32_16x16x32_bf16 v[36:39], v[28:31], v[104:107], v[36:39]
    s_waitcnt vmcnt(6)
    s_cbranch_vccnz L_t62
    s_waitcnt vmcnt(5)
L_t62:
    buffer_load_dwordx4 v[104:107], v130, s[32:35], s52 offen nt
    v_and_b32_dpp v28, v140, v16 row_newbcast:3 row_mask:0xf bank_mask:0xf
    v_and_b32_dpp v29, v140, v17 row_newbcast:3 row_mask:0xf bank_mask:0xf
    v_and_b32_dpp v30, v140, v18 row_newbcast:3 row_mask:0xf bank_mask:0xf
    v_and_b32_dpp v31, v140, v19 row_newbcast:3 row_mask:0xf bank_mask:0xf
    v_mfma_f32_16x16x32_bf16 v[36:39], v[32:35], v[108:111], v[36:39]
    s_waitcnt vmcnt(6)
    s_cbranch_vccnz L_t63
    s_waitcnt vmcnt(5)
L_t63:
    buffer_load_dwordx4 v[108:111], v131, s[32:35], s52 offen nt
    buffer_load_dwordx4 a[36:39], v3, s[36:39], s58 offen offset:1024
    s_cmp_eq_u32 s71, 3
    s_cselect_b32 s63, 0xffff7400, s73
    s_add_u32 s58, s58, s63
    v_and_b32_dpp v32, v140, v16 row_newbcast:7 row_mask:0xf bank_mask:0xf
    v_and_b32_dpp v33, v140, v17 row_newbcast:7 row_mask:0xf bank_mask:0xf
    v_and_b32_dpp v34, v140, v18 row_newbcast:7 row_mask:0xf bank_mask:0xf
    v_and_b32_dpp v35, v140, v19 row_newbcast:7 row_mask:0xf bank_mask:0xf
    v_mfma_f32_16x16x32_bf16 v[36:39], v[28:31], v[112:115], v[36:39]
    s_waitcnt vmcnt(7)
    s_cbranch_vccnz L_t64
    s_waitcnt vmcnt(6)
L_t64:
    buffer_load_dwordx4 v[112:115], v132, s[32:35], s52 offen nt
    v_and_b32_dpp v28, v140, v16 row_newbcast:11 row_mask:0xf bank_mask:0xf
    v_and_b32_dpp v29, v140, v17 row_newbcast:11 row_mask:0xf bank_mask:0xf
    v_and_b32_dpp v30, v140, v18 row_newbcast:11 row_mask:0xf bank_mask:0xf
    v_and_b32_dpp v31, v140, v19 row_newbcast:11 row_mask:0xf bank_mask:0xf
    v_mfma_f32_16x16x32_bf16 v[36:39], v[32:35], v[116:119], v[36:39]
    s_waitcnt vmcnt(7)
    s_cbranch_vccnz L_t65
    s_waitcnt vmcnt(5)
L_t65:
    buffer_load_dwordx4 v[116:119], v133, s[32:35], s52 offen nt
    v_and_b32_dpp v32, v140, v16 row_newbcast:15 row_mask:0xf bank_mask:0xf
    v_and_b32_dpp v33, v140, v17 row_newbcast:15 row_mask:0xf bank_mask:0xf
    v_and_b32_dpp v34, v140, v18 row_newbcast:15 row_mask:0xf bank_mask:0xf
    v_and_b32_dpp v35, v140, v19 row_newbcast:15 row_mask:0xf bank_mask:0xf
    v_mfma_f32_16x16x32_bf16 v[36:39], v[28:31], v[120:123], v[36:39]
    s_waitcnt vmcnt(6)
    s_cbranch_vccnz L_t66
    s_waitcnt vmcnt(5)
L_t66:
    buffer_load_dwordx4 v[120:123], v134, s[32:35], s52 offen nt
    v_mfma_f32_16x16x32_bf16 v[36:39], v[32:35], v[124:127], v[36:39]
    s_waitcnt vmcnt(6)
    s_cbranch_vccnz L_t67
    s_waitcnt vmcnt(5)
L_t67:
    buffer_load_dwordx4 v[124:127], v135, s[32:35], s52 offen nt
    buffer_load_dwordx4 a[44:47], v3, s[36:39], s58 offen offset:0
    s_add_u32 s51, s51, 0x20000
    s_add_u32 s52, s52, 0x20000
    s_cmp_gt_i32 s75, 0
    s_cselect_b64 vcc, -1, 0
    s_sub_i32 s75, s75, 1
    v_and_b32_dpp v28, v141, v16 row_newbcast:0 row_mask:0xf bank_mask:0xf
    v_and_b32_dpp v29, v141, v17 row_newbcast:0 row_mask:0xf bank_mask:0xf
    v_and_b32_dpp v30, v141, v18 row_newbcast:0 row_mask:0xf bank_mask:0xf
    v_and_b32_dpp v31, v141, v19 row_newbcast:0 row_mask:0xf bank_mask:0xf
    v_and_b32_dpp v32, v141, v16 row_newbcast:4 row_mask:0xf bank_mask:0xf
    v_and_b32_dpp v33, v141, v17 row_newbcast:4 row_mask:0xf bank_mask:0xf
    v_and_b32_dpp v34, v141, v18 row_newbcast:4 row_mask:0xf bank_mask:0xf
    v_and_b32_dpp v35, v141, v19 row_newbcast:4 row_mask:0xf bank_mask:0xf
    v_mfma_f32_16x16x32_bf16 v[36:39], v[28:31], v[64:67], v[36:39]
    s_waitcnt vmcnt(7)
    s_cbranch_vccnz L_t68
    s_waitcnt vmcnt(6)
L_t68:
    buffer_load_dwordx4 v[64:67], v128, s[32:35], s51 offen nt
    v_and_b32_dpp v28, v141, v16 row_newbcast:8 row_mask:0xf bank_mask:0xf
    v_and_b32_dpp v29, v141, v17 row_newbcast:8 row_mask:0xf bank_mask:0xf
    v_and_b32_dpp v30, v141, v18 row_newbcast:8 row_mask:0xf bank_mask:0xf
    v_and_b32_dpp v31, v141, v19 row_newbcast:8 row_mask:0xf bank_mask:0xf
    v_mfma_f32_16x16x32_bf16 v[36:39], v[32:35], v[68:71], v[36:39]
    s_waitcnt vmcnt(7)
    s_cbranch_vccnz L_t69
    s_waitcnt vmcnt(5)
L_t69:
    buffer_load_dwordx4 v[68:71], v129, s[32:35], s51 offen nt
    v_and_b32_dpp v32, v141, v16 row_newbcast:12 row_mask:0xf bank_mask:0xf
    v_and_b32_dpp v33, v141, v17 row_newbcast:12 row_mask:0xf bank_mask:0xf
    v_and_b32_dpp v34, v141, v18 row_newbcast:12 row_mask:0xf bank_mask:0xf
    v_and_b32_dpp v35, v141, v19 row_newbcast:12 row_mask:0xf bank_mask:0xf
    v_mfma_f32_16x16x32_bf16 v[36:39], v[28:31], v[72:75], v[36:39]
    s_waitcnt vmcnt(6)
    s_cbranch_vccnz L_t70
    s_waitcnt vmcnt(5)
L_t70:
    buffer_load_dwordx4 v[72:75], v130, s[32:35], s51 offen nt
    v_and_b32_dpp v28, v141, v16 row_newbcast:1 row_mask:0xf bank_mask:0xf
    v_and_b32_dpp v29, v141, v17 row_newbcast:1 row_mask:0xf bank_mask:0xf
    v_and_b32_dpp v30, v141, v18 row_newbcast:1 row_mask:0xf bank_mask:0xf
    v_and_b32_dpp v31, v141, v19 row_newbcast:1 row_mask:0xf bank_mask:0xf
    v_mfma_f32_16x16x32_bf16 v[36:39], v[32:35], v[76:79], v[36:39]
    s_waitcnt vmcnt(6)
    s_cbranch_vccnz L_t71
    s_waitcnt vmcnt(5)
L_t71:
    buffer_load_dwordx4 v[76:79], v131, s[32:35], s51 offen nt
    buffer_load_dwordx4 a[52:55], v3, s[36:39], s58 offen offset:256
    v_and_b32_dpp v32, v141, v16 row_newbcast:5 row_mask:0xf bank_mask:0xf
    v_and_b32_dpp v33, v141, v17 row_newbcast:5 row_mask:0xf bank_mask:0xf
    v_and_b32_dpp v34, v141, v18 row_newbcast:5 row_mask:0xf bank_mask:0xf
    v_and_b32_dpp v35, v141, v19 row_newbcast:5 row_mask:0xf bank_mask:0xf
    v_mfma_f32_16x16x32_bf16 v[36:39], v[28:31], v[80:83], v[36:39]
    s_waitcnt vmcnt(7)
    s_cbranch_vccnz L_t72
    s_waitcnt vmcnt(6)
L_t72:
    buffer_load_dwordx4 v[80:83], v132, s[32:35], s51 offen nt
    v_and_b32_dpp v28, v141, v16 row_newbcast:9 row_mask:0xf bank_mask:0xf
    v_and_b32_dpp v29, v141, v17 row_newbcast:9 row_mask:0xf bank_mask:0xf
    v_and_b32_dpp v30, v141, v18 row_newbcast:9 row_mask:0xf bank_mask:0xf
    v_and_b32_dpp v31, v141, v19 row_newbcast:9 row_mask:0xf bank_mask:0xf
    v_mfma_f32_16x16x32_bf16 v[36:39], v[32:35], v[84:87], v[36:39]
    s_waitcnt vmcnt(7)
    s_cbranch_vccnz L_t73
    s_waitcnt vmcnt(5)
L_t73:
    buffer_load_dwordx4 v[84:87], v133, s[32:35], s51 offen nt
    v_and_b32_dpp v32, v141, v16 row_newbcast:13 row_mask:0xf bank_mask:0xf
    v_and_b32_dpp v33, v141, v17 row_newbcast:13 row_mask:0xf bank_mask:0xf
    v_and_b32_dpp v34, v141, v18 row_newbcast:13 row_mask:0xf bank_mask:0xf
    v_and_b32_dpp v35, v141, v19 row_newbcast:13 row_mask:0xf bank_mask:0xf
    v_mfma_f32_16x16x32_bf16 v[36:39], v[28:31], v[88:91], v[36:39]
    s_waitcnt vmcnt(6)
    s_cbranch_vccnz L_t74
    s_waitcnt vmcnt(5)
L_t74:
    buffer_load_dwordx4 v[88:91], v134, s[32:35], s51 offen nt
    buffer_load_dwordx4 a[60:63], v3, s[36:39], s58 offen offset:512
    v_and_b32_dpp v28, v141, v16 row_newbcast:2 row_mask:0xf bank_mask:0xf
    v_and_b32_dpp v29, v141, v17 row_newbcast:2 row_mask:0xf bank_mask:0xf
    v_and_b32_dpp v30, v141, v18 row_newbcast:2 row_mask:0xf bank_mask:0xf
    v_and_b32_dpp v31, v141, v19 row_newbcast:2 row_mask:0xf bank_mask:0xf
    v_mfma_f32_16x16x32_bf16 v[36:39], v[32:35], v[92:95], v[36:39]
    s_waitcnt vmcnt(7)
    s_cbranch_vccnz L_t75
    s_waitcnt vmcnt(6)
L_t75:
    buffer_load_dwordx4 v[92:95], v135, s[32:35], s51 offen nt
    v_and_b32_dpp v32, v141, v16 row_newbcast:6 row_mask:0xf bank_mask:0xf
    v_and_b32_dpp v33, v141, v17 row_newbcast:6 row_mask:0xf bank_mask:0xf
    v_and_b32_dpp v34, v141, v18 row_newbcast:6 row_mask:0xf bank_mask:0xf
    v_and_b32_dpp v35, v141, v19 row_newbcast:6 row_mask:0xf bank_mask:0xf
    v_mfma_f32_16x16x32_bf16 v[36:39], v[28:31], v[96:99], v[36:39]
    s_waitcnt vmcnt(7)
    s_cbranch_vccnz L_t76
    s_waitcnt vmcnt(6)
L_t76:
    buffer_load_dwordx4 v[96:99], v128, s[32:35], s52 offen nt
    v_and_b32_dpp v28, v141, v16 row_newbcast:10 row_mask:0xf bank_mask:0xf
    v_and_b32_dpp v29, v141, v17 row_newbcast:10 row_mask:0xf bank_mask:0xf
    v_and_b32_dpp v30, v141, v18 row_newbcast:10 row_mask:0xf bank_mask:0xf
    v_and_b32_dpp v31, v141, v19 row_newbcast:10 row_mask:0xf bank_mask:0xf
    v_mfma_f32_16x16x32_bf16 v[36:39], v[32:35], v[100:103], v[36:39]
    s_waitcnt vmcnt(7)
    s_cbranch_vccnz L_t77
    s_waitcnt vmcnt(5)
L_t77:
    buffer_load_dwordx4 v[100:103], v129, s[32:35], s52 offen nt
    buffer_load_dwordx4 a[68:71], v3, s[36:39], s58 offen offset:768
    v_and_b32_dpp v32, v141, v16 row_newbcast:14 row_mask:0xf bank_mask:0xf
    v_and_b32_dpp v33, v141, v17 row_newbcast:14 row_mask:0xf bank_mask:0xf
    v_and_b32_dpp v34, v141, v18 row_newbcast:14 row_mask:0xf bank_mask:0xf
    v_and_b32_dpp v35, v141, v19 row_newbcast:14 row_mask:0xf bank_mask:0xf
    v_mfma_f32_16x16x32_bf16 v[36:39], v[28:31], v[104:107], v[36:39]
    s_waitcnt vmcnt(7)
    s_cbranch_vccnz L_t78
    s_waitcnt vmcnt(6)
L_t78:
    buffer_load_dwordx4 v[104:107], v130, s[32:35], s52 offen nt
    v_and_b32_dpp v28, v141, v16 row_newbcast:3 row_mask:0xf bank_mask:0xf
    v_and_b32_dpp v29, v141, v17 row_newbcast:3 row_mask:0xf bank_mask:0xf
    v_and_b32_dpp v30, v141, v18 row_newbcast:3 row_mask:0xf bank_mask:0xf
    v_and_b32_dpp v31, v141, v19 row_newbcast:3 row_mask:0xf bank_mask:0xf
    v_mfma_f32_16x16x32_bf16 v[36:39], v[32:35], v[108:111], v[36:39]
    s_waitcnt vmcnt(7)
    s_cbranch_vccnz L_t79
    s_waitcnt vmcnt(6)
L_t79:
    buffer_load_dwordx4 v[108:111], v131, s[32:35], s52 offen nt
    v_and_b32_dpp v32, v141, v16 row_newbcast:7 row_mask:0xf bank_mask:0xf
    v_and_b32_dpp v33, v141, v17 row_newbcast:7 row_mask:0xf bank_mask:0xf
    v_and_b32_dpp v34, v141, v18 row_newbcast:7 row_mask:0xf bank_mask:0xf
    v_and_b32_dpp v35, v141, v19 row_newbcast:7 row_mask:0xf bank_mask:0xf
    v_mfma_f32_16x16x32_bf16 v[36:39], v[28:31], v[112:115], v[36:39]
    s_waitcnt vmcnt(7)
    s_cbranch_vccnz L_t80
    s_waitcnt vmcnt(5)
L_t80:
    buffer_load_dwordx4 v[112:115], v132, s[32:35], s52 offen nt
    buffer_load_dwordx4 a[76:79], v3, s[36:39], s58 offen offset:1024
    s_cmp_eq_u32 s71, 2
    s_cselect_b32 s63, 0xffff7400, s73
    s_add_u32 s58, s58, s63
    v_and_b32_dpp v28, v141, v16 row_newbcast:11 row_mask:0xf bank_mask:0xf
    v_and_b32_dpp v29, v141, v17 row_newbcast:11 row_mask:0xf bank_mask:0xf
    v_and_b32_dpp v30, v141, v18 row_newbcast:11 row_mask:0xf bank_mask:0xf
    v_and_b32_dpp v31, v141, v19 row_newbcast:11 row_mask:0xf bank_mask:0xf
    v_mfma_f32_16x16x32_bf16 v[36:39], v[32:35], v[116:119], v[36:39]
    s_waitcnt vmcnt(7)
    s_cbranch_vccnz L_t81
    s_waitcnt vmcnt(6)
L_t81:
    buffer_load_dwordx4 v[116:119], v133, s[32:35], s52 offen nt
    v_and_b32_dpp v32, v141, v16 row_newbcast:15 row_mask:0xf bank_mask:0xf
    v_and_b32_dpp v33, v141, v17 row_newbcast:15 row_mask:0xf bank_mask:0xf
    v_and_b32_dpp v34, v141, v18 row_newbcast:15 row_mask:0xf bank_mask:0xf
    v_and_b32_dpp v35, v141, v19 row_newbcast:15 row_mask:0xf bank_mask:0xf
    v_mfma_f32_16x16x32_bf16 v[36:39], v[28:31], v[120:123], v[36:39]
    s_waitcnt vmcnt(7)
    s_cbranch_vccnz L_t82
    s_waitcnt vmcnt(6)
L_t82:
    buffer_load_dwordx4 v[120:123], v134, s[32:35], s52 offen nt
    v_mfma_f32_16x16x32_bf16 v[36:39], v[32:35], v[124:127], v[36:39]
    s_waitcnt vmcnt(7)
    s_cbranch_vccnz L_t83
    s_waitcnt vmcnt(5)
L_t83:
    buffer_load_dwordx4 v[124:127], v135, s[32:35], s52 offen nt
    buffer_load_dwordx4 a[84:87], v3, s[36:39], s58 offen offset:0
    s_add_u32 s51, s51, 0x20000
    s_add_u32 s52, s52, 0x20000
    s_cmp_gt_i32 s75, 0
    s_cselect_b64 vcc, -1, 0
    s_sub_i32 s75, s75, 1
    v_and_b32_dpp v28, v142, v16 row_newbcast:0 row_mask:0xf bank_mask:0xf
    v_and_b32_dpp v29, v142, v17 row_newbcast:0 row_mask:0xf bank_mask:0xf
    v_and_b32_dpp v30, v142, v18 row_newbcast:0 row_mask:0xf bank_mask:0xf
    v_and_b32_dpp v31, v142, v19 row_newbcast:0 row_mask:0xf bank_mask:0xf
    v_and_b32_dpp v32, v142, v16 row_newbcast:4 row_mask:0xf bank_mask:0xf
    v_and_b32_dpp v33, v142, v17 row_newbcast:4 row_mask:0xf bank_mask:0xf
    v_and_b32_dpp v34, v142, v18 row_newbcast:4 row_mask:0xf bank_mask:0xf
    v_and_b32_dpp v35, v142, v19 row_newbcast:4 row_mask:0xf bank_mask:0xf
    v_mfma_f32_16x16x32_bf16 v[36:39], v[28:31], v[64:67], v[36:39]
    s_waitcnt vmcnt(7)
    s_cbranch_vccnz L_t84
    s_waitcnt vmcnt(6)
L_t84:
    buffer_load_dwordx4 v[64:67], v128, s[32:35], s51 offen nt
    v_and_b32_dpp v28, v142, v16 row_newbcast:8 row_mask:0xf bank_mask:0xf
    v_and_b32_dpp v29, v142, v17 row_newbcast:8 row_mask:0xf bank_mask:0xf
    v_and_b32_dpp v30, v142, v18 row_newbcast:8 row_mask:0xf bank_mask:0xf
    v_and_b32_dpp v31, v142, v19 row_newbcast:8 row_mask:0xf bank_mask:0xf
    v_mfma_f32_16x16x32_bf16 v[36:39], v[32:35], v[68:71], v[36:39]
    s_waitcnt vmcnt(7)
    s_cbranch_vccnz L_t85
    s_waitcnt vmcnt(6)
L_t85:
    buffer_load_dwordx4 v[68:71], v129, s[32:35], s51 offen nt
    v_and_b32_dpp v32, v142, v16 row_newbcast:12 row_mask:0xf bank_mask:0xf
    v_and_b32_dpp v33, v142, v17 row_newbcast:12 row_mask:0xf bank_mask:0xf
    v_and_b32_dpp v34, v142, v18 row_newbcast:12 row_mask:0xf bank_mask:0xf
    v_and_b32_dpp v35, v142, v19 row_newbcast:12 row_mask:0xf bank_mask:0xf
    v_mfma_f32_16x16x32_bf16 v[36:39], v[28:31], v[72:75], v[36:39]
    s_waitcnt vmcnt(7)
    s_cbranch_vccnz L_t86
    s_waitcnt vmcnt(5)
L_t86:
    buffer_load_dwordx4 v[72:75], v130, s[32:35], s51 offen nt
    v_and_b32_dpp v28, v142, v16 row_newbcast:1 row_mask:0xf bank_mask:0xf
    v_and_b32_dpp v29, v142, v17 row_newbcast:1 row_mask:0xf bank_mask:0xf
    v_and_b32_dpp v30, v142, v18 row_newbcast:1 row_mask:0xf bank_mask:0xf
    v_and_b32_dpp v31, v142, v19 row_newbcast:1 row_mask:0xf bank_mask:0xf
    v_mfma_f32_16x16x32_bf16 v[36:39], v[32:35], v[76:79], v[36:39]
    s_waitcnt vmcnt(6)
    s_cbranch_vccnz L_t87
    s_waitcnt vmcnt(5)
L_t87:
    buffer_load_dwordx4 v[76:79], v131, s[32:35], s51 offen nt
    buffer_load_dwordx4 a[92:95], v3, s[36:39], s58 offen offset:256
    v_and_b32_dpp v32, v142, v16 row_newbcast:5 row_mask:0xf bank_mask:0xf
    v_and_b32_dpp v33, v142, v17 row_newbcast:5 row_mask:0xf bank_mask:0xf
    v_and_b32_dpp v34, v142, v18 row_newbcast:5 row_mask:0xf bank_mask:0xf
    v_and_b32_dpp v35, v142, v19 row_newbcast:5 row_mask:0xf bank_mask:0xf
    v_mfma_f32_16x16x32_bf16 v[36:39], v[28:31], v[80:83], v[36:39]
    s_waitcnt vmcnt(7)
    s_cbranch_vccnz L_t88
    s_waitcnt vmcnt(6)
L_t88:
    buffer_load_dwordx4 v[80:83], v132, s[32:35], s51 offen nt
    v_and_b32_dpp v28, v142, v16 row_newbcast:9 row_mask:0xf bank_mask:0xf
    v_and_b32_dpp v29, v142, v17 row_newbcast:9 row_mask:0xf bank_mask:0xf
    v_and_b32_dpp v30, v142, v18 row_newbcast:9 row_mask:0xf bank_mask:0xf
    v_and_b32_dpp v31, v142, v19 row_newbcast:9 row_mask:0xf bank_mask:0xf
    v_mfma_f32_16x16x32_bf16 v[36:39], v[32:35], v[84:87], v[36:39]
    s_waitcnt vmcnt(7)
    s_cbranch_vccnz L_t89
    s_waitcnt vmcnt(5)
L_t89:
    buffer_load_dwordx4 v[84:87], v133, s[32:35], s51 offen nt
    v_and_b32_dpp v32, v142, v16 row_newbcast:13 row_mask:0xf bank_mask:0xf
    v_and_b32_dpp v33, v142, v17 row_newbcast:13 row_mask:0xf bank_mask:0xf
    v_and_b32_dpp v34, v142, v18 row_newbcast:13 row_mask:0xf bank_mask:0xf
    v_and_b32_dpp v35, v142, v19 row_newbcast:13 row_mask:0xf bank_mask:0xf
    v_mfma_f32_16x16x32_bf16 v[36:39], v[28:31], v[88:91], v[36:39]
    s_waitcnt vmcnt(6)
    s_cbranch_vccnz L_t90
    s_waitcnt vmcnt(5)
L_t90:
    buffer_load_dwordx4 v[88:91], v134, s[32:35], s51 offen nt
    v_and_b32_dpp v28, v142, v16 row_newbcast:2 row_mask:0xf bank_mask:0xf
    v_and_b32_dpp v29, v142, v17 row_newbcast:2 row_mask:0xf bank_mask:0xf
    v_and_b32_dpp v30, v142, v18 row_newbcast:2 row_mask:0xf bank_mask:0xf
    v_and_b32_dpp v31, v142, v19 row_newbcast:2 row_mask:0xf bank_mask:0xf
    v_mfma_f32_16x16x32_bf16 v[36:39], v[32:35], v[92:95], v[36:39]
    s_waitcnt vmcnt(6)
    s_cbranch_vccnz L_t91
    s_waitcnt vmcnt(5)
L_t91:
    buffer_load_dwordx4 v[92:95], v135, s[32:35], s51 offen nt
    buffer_load_dwordx4 a[100:103], v3, s[36:39], s58 offen offset:512
    v_and_b32_dpp v32, v142, v16 row_newbcast:6 row_mask:0xf bank_mask:0xf
    v_and_b32_dpp v33, v142, v17 row_newbcast:6 row_mask:0xf bank_mask:0xf
    v_and_b32_dpp v34, v142, v18 row_newbcast:6 row_mask:0xf bank_mask:0xf
    v_and_b32_dpp v35, v142, v19 row_newbcast:6 row_mask:0xf bank_mask:0xf
    v_mfma_f32_16x16x32_bf16 v[36:39], v[28:31], v[96:99], v[36:39]
    s_waitcnt vmcnt(7)
    s_cbranch_vccnz L_t92
    s_waitcnt vmcnt(6)
L_t92:
    buffer_load_dwordx4 v[96:99], v128, s[32:35], s52 offen nt
    v_and_b32_dpp v28, v142, v16 row_newbcast:10 row_mask:0xf bank_mask:0xf
    v_and_b32_dpp v29, v142, v17 row_newbcast:10 row_mask:0xf bank_mask:0xf
    v_and_b32_dpp v30, v142, v18 row_newbcast:10 row_mask:0xf bank_mask:0xf
    v_and_b32_dpp v31, v142, v19 row_newbcast:10 row_mask:0xf bank_mask:0xf
    v_mfma_f32_16x16x32_bf16 v[36:39], v[32:35], v[100:103], v[36:39]
    s_waitcnt vmcnt(7)
    s_cbranch_vccnz L_t93
    s_waitcnt vmcnt(5)
L_t93:
    buffer_load_dwordx4 v[100:103], v129, s[32:35], s52 offen nt
    v_and_b32_dpp v32, v142, v16 row_newbcast:14 row_mask:0xf bank_mask:0xf
    v_and_b32_dpp v33, v142, v17 row_newbcast:14 row_mask:0xf bank_mask:0xf
    v_and_b32_dpp v34, v142, v18 row_newbcast:14 row_mask:0xf bank_mask:0xf
    v_and_b32_dpp v35, v142, v19 row_newbcast:14 row_mask:0xf bank_mask:0xf
    v_mfma_f32_16x16x32_bf16 v[36:39], v[28:31], v[104:107], v[36:39]
    s_waitcnt vmcnt(6)
    s_cbranch_vccnz L_t94
    s_waitcnt vmcnt(5)
L_t94:
    buffer_load_dwordx4 v[104:107], v130, s[32:35], s52 offen nt
    v_and_b32_dpp v28, v142, v16 row_newbcast:3 row_mask:0xf bank_mask:0xf
    v_and_b32_dpp v29, v142, v17 row_newbcast:3 row_mask:0xf bank_mask:0xf
    v_and_b32_dpp v30, v142, v18 row_newbcast:3 row_mask:0xf bank_mask:0xf
    v_and_b32_dpp v31, v142, v19 row_newbcast:3 row_mask:0xf bank_mask:0xf
    v_mfma_f32_16x16x32_bf16 v[36:39], v[32:35], v[108:111], v[36:39]
    s_waitcnt vmcnt(6)
    s_cbranch_vccnz L_t95
    s_waitcnt vmcnt(5)
L_t95:
    buffer_load_dwordx4 v[108:111], v131, s[32:35], s52 offen nt
    buffer_load_dwordx4 a[108:111], v3, s[36:39], s58 offen offset:768
    v_and_b32_dpp v32, v142, v16 row_newbcast:7 row_mask:0xf bank_mask:0xf
    v_and_b32_dpp v33, v142, v17 row_newbcast:7 row_mask:0xf bank_mask:0xf
    v_and_b32_dpp v34, v142, v18 row_newbcast:7 row_mask:0xf bank_mask:0xf
    v_and_b32_dpp v35, v142, v19 row_newbcast:7 row_mask:0xf bank_mask:0xf
    v_mfma_f32_16x16x32_bf16 v[36:39], v[28:31], v[112:115], v[36:39]
    s_waitcnt vmcnt(7)
    s_cbranch_vccnz L_t96
    s_waitcnt vmcnt(6)
L_t96:
    buffer_load_dwordx4 v[112:115], v132, s[32:35], s52 offen nt
    v_and_b32_dpp v28, v142, v16 row_newbcast:11 row_mask:0xf bank_mask:0xf
    v_and_b32_dpp v29, v142, v17 row_newbcast:11 row_mask:0xf bank_mask:0xf
    v_and_b32_dpp v30, v142, v18 row_newbcast:11 row_mask:0xf bank_mask:0xf
    v_and_b32_dpp v31, v142, v19 row_newbcast:11 row_mask:0xf bank_mask:0xf
    v_mfma_f32_16x16x32_bf16 v[36:39], v[32:35], v[116:119], v[36:39]
    s_waitcnt vmcnt(7)
    s_cbranch_vccnz L_t97
    s_waitcnt vmcnt(5)
L_t97:
    buffer_load_dwordx4 v[116:119], v133, s[32:35], s52 offen nt
    v_and_b32_dpp v32, v142, v16 row_newbcast:15 row_mask:0xf bank_mask:0xf
    v_and_b32_dpp v33, v142, v17 row_newbcast:15 row_mask:0xf bank_mask:0xf
    v_and_b32_dpp v34, v142, v18 row_newbcast:15 row_mask:0xf bank_mask:0xf
    v_and_b32_dpp v35, v142, v19 row_newbcast:15 row_mask:0xf bank_mask:0xf
    v_mfma_f32_16x16x32_bf16 v[36:39], v[28:31], v[120:123], v[36:39]
    s_waitcnt vmcnt(6)
    s_cbranch_vccnz L_t98
    s_waitcnt vmcnt(5)
L_t98:
    buffer_load_dwordx4 v[120:123], v134, s[32:35], s52 offen nt
    v_mfma_f32_16x16x32_bf16 v[36:39], v[32:35], v[124:127], v[36:39]
    s_waitcnt vmcnt(6)
    s_cbranch_vccnz L_t99
    s_waitcnt vmcnt(5)
L_t99:
    buffer_load_dwordx4 v[124:127], v135, s[32:35], s52 offen nt
    buffer_load_dwordx4 a[116:119], v3, s[36:39], s58 offen offset:1024
    s_cmp_eq_u32 s71, 1
    s_cselect_b32 s63, 0xffff7400, s73
    s_add_u32 s58, s58, s63
    s_mov_b64 s[32:33], s[16:17]
    s_mov_b32 s51, s53
    s_add_u32 s52, s53, 0x8000
    s_cmp_gt_i32 s75, 0
    s_cselect_b64 vcc, -1, 0
    s_sub_i32 s75, s75, 1
    v_and_b32_dpp v28, v143, v16 row_newbcast:0 row_mask:0xf bank_mask:0xf
    v_and_b32_dpp v29, v143, v17 row_newbcast:0 row_mask:0xf bank_mask:0xf
    v_and_b32_dpp v30, v143, v18 row_newbcast:0 row_mask:0xf bank_mask:0xf
    v_and_b32_dpp v31, v143, v19 row_newbcast:0 row_mask:0xf bank_mask:0xf
    v_and_b32_dpp v32, v143, v16 row_newbcast:4 row_mask:0xf bank_mask:0xf
    v_and_b32_dpp v33, v143, v17 row_newbcast:4 row_mask:0xf bank_mask:0xf
    v_and_b32_dpp v34, v143, v18 row_newbcast:4 row_mask:0xf bank_mask:0xf
    v_and_b32_dpp v35, v143, v19 row_newbcast:4 row_mask:0xf bank_mask:0xf
    v_mfma_f32_16x16x32_bf16 v[36:39], v[28:31], v[64:67], v[36:39]
    s_waitcnt vmcnt(7)
    s_cbranch_vccnz L_t100
    s_waitcnt vmcnt(6)
L_t100:
    buffer_load_dwordx4 v[64:67], v128, s[32:35], s51 offen nt
    v_and_b32_dpp v28, v143, v16 row_newbcast:8 row_mask:0xf bank_mask:0xf
    v_and_b32_dpp v29, v143, v17 row_newbcast:8 row_mask:0xf bank_mask:0xf
    v_and_b32_dpp v30, v143, v18 row_newbcast:8 row_mask:0xf bank_mask:0xf
    v_and_b32_dpp v31, v143, v19 row_newbcast:8 row_mask:0xf bank_mask:0xf
    v_mfma_f32_16x16x32_bf16 v[36:39], v[32:35], v[68:71], v[36:39]
    s_waitcnt vmcnt(7)
    s_cbranch_vccnz L_t101
    s_waitcnt vmcnt(5)
L_t101:
    buffer_load_dwordx4 v[68:71], v129, s[32:35], s51 offen nt
    v_and_b32_dpp v32, v143, v16 row_newbcast:12 row_mask:0xf bank_mask:0xf
    v_and_b32_dpp v33, v143, v17 row_newbcast:12 row_mask:0xf bank_mask:0xf
    v_and_b32_dpp v34, v143, v18 row_newbcast:12 row_mask:0xf bank_mask:0xf
    v_and_b32_dpp v35, v143, v19 row_newbcast:12 row_mask:0xf bank_mask:0xf
    v_mfma_f32_16x16x32_bf16 v[36:39], v[28:31], v[72:75], v[36:39]
    s_waitcnt vmcnt(6)
    s_cbranch_vccnz L_t102
    s_waitcnt vmcnt(5)
L_t102:
    buffer_load_dwordx4 v[72:75], v130, s[32:35], s51 offen nt
    v_and_b32_dpp v28, v143, v16 row_newbcast:1 row_mask:0xf bank_mask:0xf
    v_and_b32_dpp v29, v143, v17 row_newbcast:1 row_mask:0xf bank_mask:0xf
    v_and_b32_dpp v30, v143, v18 row_newbcast:1 row_mask:0xf bank_mask:0xf
    v_and_b32_dpp v31, v143, v19 row_newbcast:1 row_mask:0xf bank_mask:0xf
    v_mfma_f32_16x16x32_bf16 v[36:39], v[32:35], v[76:79], v[36:39]
    s_waitcnt vmcnt(6)
    s_cbranch_vccnz L_t103
    s_waitcnt vmcnt(5)
L_t103:
    buffer_load_dwordx4 v[76:79], v131, s[32:35], s51 offen nt
    buffer_load_dwordx4 a[124:127], v3, s[36:39], s58 offen offset:0
    v_and_b32_dpp v32, v143, v16 row_newbcast:5 row_mask:0xf bank_mask:0xf
    v_and_b32_dpp v33, v143, v17 row_newbcast:5 row_mask:0xf bank_mask:0xf
    v_and_b32_dpp v34, v143, v18 row_newbcast:5 row_mask:0xf bank_mask:0xf
    v_and_b32_dpp v35, v143, v19 row_newbcast:5 row_mask:0xf bank_mask:0xf
    v_mfma_f32_16x16x32_bf16 v[36:39], v[28:31], v[80:83], v[36:39]
    s_waitcnt vmcnt(7)
    s_cbranch_vccnz L_t104
    s_waitcnt vmcnt(6)
L_t104:
    buffer_load_dwordx4 v[80:83], v132, s[32:35], s51 offen nt
    v_and_b32_dpp v28, v143, v16 row_newbcast:9 row_mask:0xf bank_mask:0xf
    v_and_b32_dpp v29, v143, v17 row_newbcast:9 row_mask:0xf bank_mask:0xf
    v_and_b32_dpp v30, v143, v18 row_newbcast:9 row_mask:0xf bank_mask:0xf
    v_and_b32_dpp v31, v143, v19 row_newbcast:9 row_mask:0xf bank_mask:0xf
    v_mfma_f32_16x16x32_bf16 v[36:39], v[32:35], v[84:87], v[36:39]
    s_waitcnt vmcnt(7)
    s_cbranch_vccnz L_t105
    s_waitcnt vmcnt(5)
L_t105:
    buffer_load_dwordx4 v[84:87], v133, s[32:35], s51 offen nt
    v_and_b32_dpp v32, v143, v16 row_newbcast:13 row_mask:0xf bank_mask:0xf
    v_and_b32_dpp v33, v143, v17 row_newbcast:13 row_mask:0xf bank_mask:0xf
    v_and_b32_dpp v34, v143, v18 row_newbcast:13 row_mask:0xf bank_mask:0xf
    v_and_b32_dpp v35, v143, v19 row_newbcast:13 row_mask:0xf bank_mask:0xf
    v_mfma_f32_16x16x32_bf16 v[36:39], v[28:31], v[88:91], v[36:39]
    s_waitcnt vmcnt(6)
    s_cbranch_vccnz L_t106
    s_waitcnt vmcnt(5)
L_t106:
    buffer_load_dwordx4 v[88:91], v134, s[32:35], s51 offen nt
    buffer_load_dwordx4 a[132:135], v3, s[36:39], s58 offen offset:256
    v_and_b32_dpp v28, v143, v16 row_newbcast:2 row_mask:0xf bank_mask:0xf
    v_and_b32_dpp v29, v143, v17 row_newbcast:2 row_mask:0xf bank_mask:0xf
    v_and_b32_dpp v30, v143, v18 row_newbcast:2 row_mask:0xf bank_mask:0xf
    v_and_b32_dpp v31, v143, v19 row_newbcast:2 row_mask:0xf bank_mask:0xf
    v_mfma_f32_16x16x32_bf16 v[36:39], v[32:35], v[92:95], v[36:39]
    s_waitcnt vmcnt(7)
    s_cbranch_vccnz L_t107
    s_waitcnt vmcnt(6)
L_t107:
    buffer_load_dwordx4 v[92:95], v135, s[32:35], s51 offen nt
    v_and_b32_dpp v32, v143, v16 row_newbcast:6 row_mask:0xf bank_mask:0xf
    v_and_b32_dpp v33, v143, v17 row_newbcast:6 row_mask:0xf bank_mask:0xf
    v_and_b32_dpp v34, v143, v18 row_newbcast:6 row_mask:0xf bank_mask:0xf
    v_and_b32_dpp v35, v143, v19 row_newbcast:6 row_mask:0xf bank_mask:0xf
    v_mfma_f32_16x16x32_bf16 v[36:39], v[28:31], v[96:99], v[36:39]
    s_waitcnt vmcnt(7)
    s_cbranch_vccnz L_t108
    s_waitcnt vmcnt(6)
L_t108:
    buffer_load_dwordx4 v[96:99], v128, s[32:35], s52 offen nt
    v_and_b32_dpp v28, v143, v16 row_newbcast:10 row_mask:0xf bank_mask:0xf
    v_and_b32_dpp v29, v143, v17 row_newbcast:10 row_mask:0xf bank_mask:0xf
    v_and_b32_dpp v30, v143, v18 row_newbcast:10 row_mask:0xf bank_mask:0xf
    v_and_b32_dpp v31, v143, v19 row_newbcast:10 row_mask:0xf bank_mask:0xf
    v_mfma_f32_16x16x32_bf16 v[36:39], v[32:35], v[100:103], v[36:39]
    s_waitcnt vmcnt(7)
    s_cbranch_vccnz L_t109
    s_waitcnt vmcnt(5)
L_t109:
    buffer_load_dwordx4 v[100:103], v129, s[32:35], s52 offen nt
    buffer_load_dwordx4 a[140:143], v3, s[36:39], s58 offen offset:512
    v_and_b32_dpp v32, v143, v16 row_newbcast:14 row_mask:0xf bank_mask:0xf
    v_and_b32_dpp v33, v143, v17 row_newbcast:14 row_mask:0xf bank_mask:0xf
    v_and_b32_dpp v34, v143, v18 row_newbcast:14 row_mask:0xf bank_mask:0xf
    v_and_b32_dpp v35, v143, v19 row_newbcast:14 row_mask:0xf bank_mask:0xf
    v_mfma_f32_16x16x32_bf16 v[36:39], v[28:31], v[104:107], v[36:39]
    s_waitcnt vmcnt(7)
    s_cbranch_vccnz L_t110
    s_waitcnt vmcnt(6)
L_t110:
    buffer_load_dwordx4 v[104:107], v130, s[32:35], s52 offen nt
    v_and_b32_dpp v28, v143, v16 row_newbcast:3 row_mask:0xf bank_mask:0xf
    v_and_b32_dpp v29, v143, v17 row_newbcast:3 row_mask:0xf bank_mask:0xf
    v_and_b32_dpp v30, v143, v18 row_newbcast:3 row_mask:0xf bank_mask:0xf
    v_and_b32_dpp v31, v143, v19 row_newbcast:3 row_mask:0xf bank_mask:0xf
    v_mfma_f32_16x16x32_bf16 v[36:39], v[32:35], v[108:111], v[36:39]
    s_waitcnt vmcnt(7)
    s_cbranch_vccnz L_t111
    s_waitcnt vmcnt(6)
L_t111:
    buffer_load_dwordx4 v[108:111], v131, s[32:35], s52 offen nt
    v_and_b32_dpp v32, v143, v16 row_newbcast:7 row_mask:0xf bank_mask:0xf
    v_and_b32_dpp v33, v143, v17 row_newbcast:7 row_mask:0xf bank_mask:0xf
    v_and_b32_dpp v34, v143, v18 row_newbcast:7 row_mask:0xf bank_mask:0xf
    v_and_b32_dpp v35, v143, v19 row_newbcast:7 row_mask:0xf bank_mask:0xf
    v_mfma_f32_16x16x32_bf16 v[36:39], v[28:31], v[112:115], v[36:39]
    s_waitcnt vmcnt(7)
    s_cbranch_vccnz L_t112
    s_waitcnt vmcnt(5)
L_t112:
    buffer_load_dwordx4 v[112:115], v132, s[32:35], s52 offen nt
    buffer_load_dwordx4 a[148:151], v3, s[36:39], s58 offen offset:768
    v_and_b32_dpp v28, v143, v16 row_newbcast:11 row_mask:0xf bank_mask:0xf
    v_and_b32_dpp v29, v143, v17 row_newbcast:11 row_mask:0xf bank_mask:0xf
    v_and_b32_dpp v30, v143, v18 row_newbcast:11 row_mask:0xf bank_mask:0xf
    v_and_b32_dpp v31, v143, v19 row_newbcast:11 row_mask:0xf bank_mask:0xf
    v_mfma_f32_16x16x32_bf16 v[36:39], v[32:35], v[116:119], v[36:39]
    s_waitcnt vmcnt(7)
    s_cbranch_vccnz L_t113
    s_waitcnt vmcnt(6)
L_t113:
    buffer_load_dwordx4 v[116:119], v133, s[32:35], s52 offen nt
    v_and_b32_dpp v32, v143, v16 row_newbcast:15 row_mask:0xf bank_mask:0xf
    v_and_b32_dpp v33, v143, v17 row_newbcast:15 row_mask:0xf bank_mask:0xf
    v_and_b32_dpp v34, v143, v18 row_newbcast:15 row_mask:0xf bank_mask:0xf
    v_and_b32_dpp v35, v143, v19 row_newbcast:15 row_mask:0xf bank_mask:0xf
    v_mfma_f32_16x16x32_bf16 v[36:39], v[28:31], v[120:123], v[36:39]
    s_waitcnt vmcnt(7)
    s_cbranch_vccnz L_t114
    s_waitcnt vmcnt(6)
L_t114:
    buffer_load_dwordx4 v[120:123], v134, s[32:35], s52 offen nt
    v_mfma_f32_16x16x32_bf16 v[36:39], v[32:35], v[124:127], v[36:39]
    s_waitcnt vmcnt(7)
    s_cbranch_vccnz L_t115
    s_waitcnt vmcnt(5)
L_t115:
    buffer_load_dwordx4 v[124:127], v135, s[32:35], s52 offen nt
    buffer_load_dwordx4 a[156:159], v3, s[36:39], s58 offen offset:1024
    s_add_u32 s51, s51, 0x20000
    s_add_u32 s52, s52, 0x20000
    s_cmp_gt_i32 s75, 0
    s_cselect_b64 vcc, -1, 0
    s_sub_i32 s75, s75, 1
    v_dot2_f32_bf16 v44, v64, v24, 0
    v_dot2_f32_bf16 v45, v68, v24, 0
    v_dot2_f32_bf16 v46, v72, v24, 0
    v_dot2_f32_bf16 v47, v76, v24, 0
    v_dot2_f32_bf16 v44, v65, v25, v44
    v_dot2_f32_bf16 v45, v69, v25, v45
    v_dot2_f32_bf16 v46, v73, v25, v46
    v_dot2_f32_bf16 v47, v77, v25, v47
    v_dot2_f32_bf16 v44, v66, v26, v44
    v_dot2_f32_bf16 v45, v70, v26, v45
    v_dot2_f32_bf16 v46, v74, v26, v46
    v_dot2_f32_bf16 v47, v78, v26, v47
    v_dot2_f32_bf16 v44, v67, v27, v44
    v_dot2_f32_bf16 v45, v71, v27, v45
    v_dot2_f32_bf16 v46, v75, v27, v46
    v_dot2_f32_bf16 v47, v79, v27, v47
    s_waitcnt vmcnt(7)
    s_cbranch_vccnz L_t116
    s_waitcnt vmcnt(6)
L_t116:
    buffer_load_dwordx4 v[64:67], v128, s[32:35], s51 offen nt
    s_waitcnt vmcnt(7)
    s_cbranch_vccnz L_t117
    s_waitcnt vmcnt(6)
L_t117:
    buffer_load_dwordx4 v[68:71], v129, s[32:35], s51 offen nt
    v_dot2_f32_bf16 v48, v80, v24, 0
    v_dot2_f32_bf16 v49, v84, v24, 0
    v_dot2_f32_bf16 v50, v88, v24, 0
    v_dot2_f32_bf16 v51, v92, v24, 0
    v_dot2_f32_bf16 v48, v81, v25, v48
    v_dot2_f32_bf16 v49, v85, v25, v49
    v_dot2_f32_bf16 v50, v89, v25, v50
    v_dot2_f32_bf16 v51, v93, v25, v51
    v_dot2_f32_bf16 v48, v82, v26, v48
    v_dot2_f32_bf16 v49, v86, v26, v49
    v_dot2_f32_bf16 v50, v90, v26, v50
    v_dot2_f32_bf16 v51, v94, v26, v51
    v_dot2_f32_bf16 v48, v83, v27, v48
    v_dot2_f32_bf16 v49, v87, v27, v49
    v_dot2_f32_bf16 v50, v91, v27, v50
    v_dot2_f32_bf16 v51, v95, v27, v51
    s_waitcnt vmcnt(7)
    s_cbranch_vccnz L_t118
    s_waitcnt vmcnt(5)
L_t118:
    buffer_load_dwordx4 v[72:75], v130, s[32:35], s51 offen nt
    s_waitcnt vmcnt(6)
    s_cbranch_vccnz L_t119
    s_waitcnt vmcnt(5)
L_t119:
    buffer_load_dwordx4 v[76:79], v131, s[32:35], s51 offen nt
    s_mul_i32 s54, s3, 576
    v_add_u32 v62, s54, v11
    s_mov_b32 exec_hi, 0
    ds_write_b128 v62, v[36:39] offset:2048
    s_mov_b32 exec_hi, -1
    v_mov_b32 v176, 0
    v_mov_b32 v177, 0
    v_mov_b32 v178, 0
    v_mov_b32 v179, 0
    v_mov_b32 v180, 0
    v_mov_b32 v181, 0
    v_mov_b32 v182, 0
    v_mov_b32 v183, 0
    v_mov_b32 v184, 0
    v_mov_b32 v185, 0
    v_mov_b32 v186, 0
    v_mov_b32 v187, 0
    v_mov_b32 v188, 0
    v_mov_b32 v189, 0
    v_mov_b32 v190, 0
    v_mov_b32 v191, 0
    v_mov_b32 v192, 0
    v_mov_b32 v193, 0
    v_mov_b32 v194, 0
    v_mov_b32 v195, 0
    v_add_f32_dpp v44, v44, v44 row_ror:8 row_mask:0xf bank_mask:0x3
    v_add_f32_dpp v48, v48, v48 row_ror:8 row_mask:0xf bank_mask:0x3
    v_add_f32_dpp v45, v45, v45 row_ror:8 row_mask:0xf bank_mask:0x3
    v_add_f32_dpp v49, v49, v49 row_ror:8 row_mask:0xf bank_mask:0x3
    v_add_f32_dpp v44, v46, v46 row_ror:8 row_mask:0xf bank_mask:0xc
    v_add_f32_dpp v48, v50, v50 row_ror:8 row_mask:0xf bank_mask:0xc
    v_add_f32_dpp v45, v47, v47 row_ror:8 row_mask:0xf bank_mask:0xc
    v_add_f32_dpp v49, v51, v51 row_ror:8 row_mask:0xf bank_mask:0xc
    v_add_f32_dpp v44, v44, v44 row_half_mirror row_mask:0xf bank_mask:0x5
    v_add_f32_dpp v48, v48, v48 row_half_mirror row_mask:0xf bank_mask:0x5
    s_nop 0
    v_add_f32_dpp v44, v45, v45 row_half_mirror row_mask:0xf bank_mask:0xa
    v_add_f32_dpp v48, v49, v49 row_half_mirror row_mask:0xf bank_mask:0xa
    s_nop 0
    v_add_f32_dpp v44, v44, v44 quad_perm:[1,0,3,2] row_mask:0xf bank_mask:0xf
    v_add_f32_dpp v48, v48, v48 quad_perm:[1,0,3,2] row_mask:0xf bank_mask:0xf
    s_nop 0
    v_add_f32_dpp v44, v44, v44 quad_perm:[2,3,0,1] row_mask:0xf bank_mask:0xf
    v_add_f32_dpp v48, v48, v48 quad_perm:[2,3,0,1] row_mask:0xf bank_mask:0xf
    s_waitcnt vmcnt(6)
    s_cbranch_vccnz L_t120
    s_waitcnt vmcnt(5)
L_t120:
    buffer_load_dwordx4 v[80:83], v132, s[32:35], s51 offen nt
    s_waitcnt vmcnt(6)
    s_cbranch_vccnz L_t121
    s_waitcnt vmcnt(4)
L_t121:
    buffer_load_dwordx4 v[84:87], v133, s[32:35], s51 offen nt
    v_cndmask_b32 v136, v44, v48, s[64:65]
    s_waitcnt vmcnt(5)
    s_cbranch_vccnz L_t122
    s_waitcnt vmcnt(4)
L_t122:
    buffer_load_dwordx4 v[88:91], v134, s[32:35], s51 offen nt
    s_waitcnt vmcnt(5)
    s_cbranch_vccnz L_t123
    s_waitcnt vmcnt(4)
L_t123:
    buffer_load_dwordx4 v[92:95], v135, s[32:35], s51 offen nt
    s_waitcnt lgkmcnt(0)
    s_barrier
    ds_read_b64 v[228:229], v12 offset:2048
    s_waitcnt lgkmcnt(0)
    v_add_f32_dpp v228, v228, v228 quad_perm:[1,0,3,2] row_mask:0xf bank_mask:0xf
    v_add_f32_dpp v229, v229, v229 quad_perm:[1,0,3,2] row_mask:0xf bank_mask:0xf
    s_nop 0
    v_add_f32_dpp v228, v228, v228 quad_perm:[2,3,0,1] row_mask:0xf bank_mask:0xf
    v_add_f32_dpp v229, v229, v229 quad_perm:[2,3,0,1] row_mask:0xf bank_mask:0xf
    v_mul_f32 v228, v228, v198
    v_mul_f32 v229, v229, v198
    v_cvt_pk_bf16_f32 v228, v228, v228
    v_cvt_pk_bf16_f32 v229, v229, v229
    s_nop 0
    v_and_b32_dpp v28, v228, v208 row_newbcast:0 row_mask:0xf bank_mask:0xf
    v_and_b32_dpp v29, v228, v209 row_newbcast:0 row_mask:0xf bank_mask:0xf
    v_and_b32_dpp v30, v229, v208 row_newbcast:0 row_mask:0xf bank_mask:0xf
    v_and_b32_dpp v31, v229, v209 row_newbcast:0 row_mask:0xf bank_mask:0xf
    v_dot2_f32_bf16 v44, v96, v24, 0
    v_dot2_f32_bf16 v45, v100, v24, 0
    v_dot2_f32_bf16 v46, v104, v24, 0
    v_dot2_f32_bf16 v47, v108, v24, 0
    v_dot2_f32_bf16 v44, v97, v25, v44
    v_dot2_f32_bf16 v45, v101, v25, v45
    v_dot2_f32_bf16 v46, v105, v25, v46
    v_dot2_f32_bf16 v47, v109, v25, v47
    v_dot2_f32_bf16 v44, v98, v26, v44
    v_dot2_f32_bf16 v45, v102, v26, v45
    v_dot2_f32_bf16 v46, v106, v26, v46
    v_dot2_f32_bf16 v47, v110, v26, v47
    v_dot2_f32_bf16 v44, v99, v27, v44
    v_dot2_f32_bf16 v45, v103, v27, v45
    v_dot2_f32_bf16 v46, v107, v27, v46
    v_dot2_f32_bf16 v47, v111, v27, v47
    s_waitcnt vmcnt(5)
    s_cbranch_vccnz L_t124
    s_waitcnt vmcnt(4)
L_t124:
    buffer_load_dwordx4 v[96:99], v128, s[32:35], s52 offen nt
    s_waitcnt vmcnt(5)
    s_cbranch_vccnz L_t125
    s_waitcnt vmcnt(4)
L_t125:
    buffer_load_dwordx4 v[100:103], v129, s[32:35], s52 offen nt
    v_dot2_f32_bf16 v48, v112, v24, 0
    v_dot2_f32_bf16 v49, v116, v24, 0
    v_dot2_f32_bf16 v50, v120, v24, 0
    v_dot2_f32_bf16 v51, v124, v24, 0
    v_dot2_f32_bf16 v48, v113, v25, v48
    v_dot2_f32_bf16 v49, v117, v25, v49
    v_dot2_f32_bf16 v50, v121, v25, v50
    v_dot2_f32_bf16 v51, v125, v25, v51
    v_dot2_f32_bf16 v48, v114, v26, v48
    v_dot2_f32_bf16 v49, v118, v26, v49
    v_dot2_f32_bf16 v50, v122, v26, v50
    v_dot2_f32_bf16 v51, v126, v26, v51
    v_dot2_f32_bf16 v48, v115, v27, v48
    v_dot2_f32_bf16 v49, v119, v27, v49
    v_dot2_f32_bf16 v50, v123, v27, v50
    v_dot2_f32_bf16 v51, v127, v27, v51
    s_waitcnt vmcnt(5)
    s_cbranch_vccnz L_t126
    s_waitcnt vmcnt(4)
L_t126:
    buffer_load_dwordx4 v[104:107], v130, s[32:35], s52 offen nt
    s_waitcnt vmcnt(5)
    s_cbranch_vccnz L_t127
    s_waitcnt vmcnt(4)
L_t127:
    buffer_load_dwordx4 v[108:111], v131, s[32:35], s52 offen nt
    v_smfmac_f32_16x16x64_bf16 v[176:179], v[28:31], a[0:7], v210
    v_and_b32_dpp v32, v228, v208 row_newbcast:4 row_mask:0xf bank_mask:0xf
    v_and_b32_dpp v33, v228, v209 row_newbcast:4 row_mask:0xf bank_mask:0xf
    v_and_b32_dpp v34, v229, v208 row_newbcast:4 row_mask:0xf bank_mask:0xf
    v_and_b32_dpp v35, v229, v209 row_newbcast:4 row_mask:0xf bank_mask:0xf
    v_smfmac_f32_16x16x64_bf16 v[180:183], v[28:31], a[8:15], v210
    v_smfmac_f32_16x16x64_bf16 v[184:187], v[28:31], a[16:23], v210
    v_smfmac_f32_16x16x64_bf16 v[188:191], v[28:31], a[24:31], v210
    v_smfmac_f32_16x16x64_bf16 v[192:195], v[28:31], a[32:39], v210
    v_add_f32_dpp v44, v44, v44 row_ror:8 row_mask:0xf bank_mask:0x3
    v_add_f32_dpp v48, v48, v48 row_ror:8 row_mask:0xf bank_mask:0x3
    v_add_f32_dpp v45, v45, v45 row_ror:8 row_mask:0xf bank_mask:0x3
    v_add_f32_dpp v49, v49, v49 row_ror:8 row_mask:0xf bank_mask:0x3
    v_add_f32_dpp v44, v46, v46 row_ror:8 row_mask:0xf bank_mask:0xc
    v_add_f32_dpp v48, v50, v50 row_ror:8 row_mask:0xf bank_mask:0xc
    v_add_f32_dpp v45, v47, v47 row_ror:8 row_mask:0xf bank_mask:0xc
    v_add_f32_dpp v49, v51, v51 row_ror:8 row_mask:0xf bank_mask:0xc
    v_add_f32_dpp v44, v44, v44 row_half_mirror row_mask:0xf bank_mask:0x5
    v_add_f32_dpp v48, v48, v48 row_half_mirror row_mask:0xf bank_mask:0x5
    s_nop 0
    v_add_f32_dpp v44, v45, v45 row_half_mirror row_mask:0xf bank_mask:0xa
    v_add_f32_dpp v48, v49, v49 row_half_mirror row_mask:0xf bank_mask:0xa
    s_nop 0
    v_add_f32_dpp v44, v44, v44 quad_perm:[1,0,3,2] row_mask:0xf bank_mask:0xf
    v_add_f32_dpp v48, v48, v48 quad_perm:[1,0,3,2] row_mask:0xf bank_mask:0xf
    s_nop 0
    v_add_f32_dpp v44, v44, v44 quad_perm:[2,3,0,1] row_mask:0xf bank_mask:0xf
    v_add_f32_dpp v48, v48, v48 quad_perm:[2,3,0,1] row_mask:0xf bank_mask:0xf
    s_waitcnt vmcnt(5)
    s_cbranch_vccnz L_t128
    s_waitcnt vmcnt(4)
L_t128:
    buffer_load_dwordx4 v[112:115], v132, s[32:35], s52 offen nt
    s_waitcnt vmcnt(5)
    s_cbranch_vccnz L_t129
    s_waitcnt vmcnt(4)
L_t129:
    buffer_load_dwordx4 v[116:119], v133, s[32:35], s52 offen nt
    v_cndmask_b32 v136, v136, v44, s[66:67]
    v_cndmask_b32 v136, v136, v48, s[68:69]
    s_waitcnt vmcnt(5)
    s_cbranch_vccnz L_t130
    s_waitcnt vmcnt(4)
L_t130:
    buffer_load_dwordx4 v[120:123], v134, s[32:35], s52 offen nt
    s_waitcnt vmcnt(5)
    s_cbranch_vccnz L_t131
    s_waitcnt vmcnt(4)
L_t131:
    buffer_load_dwordx4 v[124:127], v135, s[32:35], s52 offen nt
    v_smfmac_f32_16x16x64_bf16 v[176:179], v[32:35], a[40:47], v210
    v_and_b32_dpp v28, v228, v208 row_newbcast:8 row_mask:0xf bank_mask:0xf
    v_and_b32_dpp v29, v228, v209 row_newbcast:8 row_mask:0xf bank_mask:0xf
    v_and_b32_dpp v30, v229, v208 row_newbcast:8 row_mask:0xf bank_mask:0xf
    v_and_b32_dpp v31, v229, v209 row_newbcast:8 row_mask:0xf bank_mask:0xf
    v_smfmac_f32_16x16x64_bf16 v[180:183], v[32:35], a[48:55], v210
    v_smfmac_f32_16x16x64_bf16 v[184:187], v[32:35], a[56:63], v210
    v_smfmac_f32_16x16x64_bf16 v[188:191], v[32:35], a[64:71], v210
    v_smfmac_f32_16x16x64_bf16 v[192:195], v[32:35], a[72:79], v210
    s_add_u32 s51, s51, 0x20000
    s_add_u32 s52, s52, 0x20000
    s_cmp_lg_u32 s3, 0
    s_cbranch_scc1 L_t132
    s_atomic_xor s98, s[96:97], 0x4
L_t132:
    s_mov_b32 s55, 1310724
    buffer_load_dword v236, v230, s[40:43], s55 offen sc1
    s_cmp_gt_i32 s75, 0
    s_cselect_b64 vcc, -1, 0
    s_sub_i32 s75, s75, 1
    v_dot2_f32_bf16 v44, v64, v24, 0
    v_dot2_f32_bf16 v45, v68, v24, 0
    v_dot2_f32_bf16 v46, v72, v24, 0
    v_dot2_f32_bf16 v47, v76, v24, 0
    v_dot2_f32_bf16 v44, v65, v25, v44
    v_dot2_f32_bf16 v45, v69, v25, v45
    v_dot2_f32_bf16 v46, v73, v25, v46
    v_dot2_f32_bf16 v47, v77, v25, v47
    v_dot2_f32_bf16 v44, v66, v26, v44
    v_dot2_f32_bf16 v45, v70, v26, v45
    v_dot2_f32_bf16 v46, v74, v26, v46
    v_dot2_f32_bf16 v47, v78, v26, v47
    v_dot2_f32_bf16 v44, v67, v27, v44
    v_dot2_f32_bf16 v45, v71, v27, v45
    v_dot2_f32_bf16 v46, v75, v27, v46
    v_dot2_f32_bf16 v47, v79, v27, v47
    s_waitcnt vmcnt(6)
    s_cbranch_vccnz L_t133
    s_waitcnt vmcnt(5)
L_t133:
    buffer_load_dwordx4 v[64:67], v128, s[32:35], s51 offen nt
    s_waitcnt vmcnt(6)
    s_cbranch_vccnz L_t134
    s_waitcnt vmcnt(5)
L_t134:
    buffer_load_dwordx4 v[68:71], v129, s[32:35], s51 offen nt
    v_dot2_f32_bf16 v48, v80, v24, 0
    v_dot2_f32_bf16 v49, v84, v24, 0
    v_dot2_f32_bf16 v50, v88, v24, 0
    v_dot2_f32_bf16 v51, v92, v24, 0
    v_dot2_f32_bf16 v48, v81, v25, v48
    v_dot2_f32_bf16 v49, v85, v25, v49
    v_dot2_f32_bf16 v50, v89, v25, v50
    v_dot2_f32_bf16 v51, v93, v25, v51
    v_dot2_f32_bf16 v48, v82, v26, v48
    v_dot2_f32_bf16 v49, v86, v26, v49
    v_dot2_f32_bf16 v50, v90, v26, v50
    v_dot2_f32_bf16 v51, v94, v26, v51
    v_dot2_f32_bf16 v48, v83, v27, v48
    v_dot2_f32_bf16 v49, v87, v27, v49
    v_dot2_f32_bf16 v50, v91, v27, v50
    v_dot2_f32_bf16 v51, v95, v27, v51
    s_waitcnt vmcnt(6)
    s_cbranch_vccnz L_t135
    s_waitcnt vmcnt(5)
L_t135:
    buffer_load_dwordx4 v[72:75], v130, s[32:35], s51 offen nt
    s_waitcnt vmcnt(6)
    s_cbranch_vccnz L_t136
    s_waitcnt vmcnt(5)
L_t136:
    buffer_load_dwordx4 v[76:79], v131, s[32:35], s51 offen nt
    v_smfmac_f32_16x16x64_bf16 v[176:179], v[28:31], a[80:87], v210
    v_and_b32_dpp v32, v228, v208 row_newbcast:12 row_mask:0xf bank_mask:0xf
    v_and_b32_dpp v33, v228, v209 row_newbcast:12 row_mask:0xf bank_mask:0xf
    v_and_b32_dpp v34, v229, v208 row_newbcast:12 row_mask:0xf bank_mask:0xf
    v_and_b32_dpp v35, v229, v209 row_newbcast:12 row_mask:0xf bank_mask:0xf
    v_smfmac_f32_16x16x64_bf16 v[180:183], v[28:31], a[88:95], v210
    v_smfmac_f32_16x16x64_bf16 v[184:187], v[28:31], a[96:103], v210
    v_smfmac_f32_16x16x64_bf16 v[188:191], v[28:31], a[104:111], v210
    v_smfmac_f32_16x16x64_bf16 v[192:195], v[28:31], a[112:119], v210
    v_add_f32_dpp v44, v44, v44 row_ror:8 row_mask:0xf bank_mask:0x3
    v_add_f32_dpp v48, v48, v48 row_ror:8 row_mask:0xf bank_mask:0x3
    v_add_f32_dpp v45, v45, v45 row_ror:8 row_mask:0xf bank_mask:0x3
    v_add_f32_dpp v49, v49, v49 row_ror:8 row_mask:0xf bank_mask:0x3
    v_add_f32_dpp v44, v46, v46 row_ror:8 row_mask:0xf bank_mask:0xc
    v_add_f32_dpp v48, v50, v50 row_ror:8 row_mask:0xf bank_mask:0xc
    v_add_f32_dpp v45, v47, v47 row_ror:8 row_mask:0xf bank_mask:0xc
    v_add_f32_dpp v49, v51, v51 row_ror:8 row_mask:0xf bank_mask:0xc
    v_add_f32_dpp v44, v44, v44 row_half_mirror row_mask:0xf bank_mask:0x5
    v_add_f32_dpp v48, v48, v48 row_half_mirror row_mask:0xf bank_mask:0x5
    s_nop 0
    v_add_f32_dpp v44, v45, v45 row_half_mirror row_mask:0xf bank_mask:0xa
    v_add_f32_dpp v48, v49, v49 row_half_mirror row_mask:0xf bank_mask:0xa
    s_nop 0
    v_add_f32_dpp v44, v44, v44 quad_perm:[1,0,3,2] row_mask:0xf bank_mask:0xf
    v_add_f32_dpp v48, v48, v48 quad_perm:[1,0,3,2] row_mask:0xf bank_mask:0xf
    s_nop 0
    v_add_f32_dpp v44, v44, v44 quad_perm:[2,3,0,1] row_mask:0xf bank_mask:0xf
    v_add_f32_dpp v48, v48, v48 quad_perm:[2,3,0,1] row_mask:0xf bank_mask:0xf
    s_waitcnt vmcnt(6)
    s_cbranch_vccnz L_t137
    s_waitcnt vmcnt(5)
L_t137:
    buffer_load_dwordx4 v[80:83], v132, s[32:35], s51 offen nt
    s_waitcnt vmcnt(6)
    s_cbranch_vccnz L_t138
    s_waitcnt vmcnt(4)
L_t138:
    buffer_load_dwordx4 v[84:87], v133, s[32:35], s51 offen nt
    v_cndmask_b32 v137, v44, v48, s[64:65]
    s_waitcnt vmcnt(5)
    s_cbranch_vccnz L_t139
    s_waitcnt vmcnt(4)
L_t139:
    buffer_load_dwordx4 v[88:91], v134, s[32:35], s51 offen nt
    s_waitcnt vmcnt(5)
    s_cbranch_vccnz L_t140
    s_waitcnt vmcnt(4)
L_t140:
    buffer_load_dwordx4 v[92:95], v135, s[32:35], s51 offen nt
    v_smfmac_f32_16x16x64_bf16 v[176:179], v[32:35], a[120:127], v210
    v_smfmac_f32_16x16x64_bf16 v[180:183], v[32:35], a[128:135], v210
    v_smfmac_f32_16x16x64_bf16 v[184:187], v[32:35], a[136:143], v210
    v_smfmac_f32_16x16x64_bf16 v[188:191], v[32:35], a[144:151], v210
    v_smfmac_f32_16x16x64_bf16 v[192:195], v[32:35], a[152:159], v210
    v_dot2_f32_bf16 v44, v96, v24, 0
    v_dot2_f32_bf16 v45, v100, v24, 0
    v_dot2_f32_bf16 v46, v104, v24, 0
    v_dot2_f32_bf16 v47, v108, v24, 0
    v_dot2_f32_bf16 v44, v97, v25, v44
    v_dot2_f32_bf16 v45, v101, v25, v45
    v_dot2_f32_bf16 v46, v105, v25, v46
    v_dot2_f32_bf16 v47, v109, v25, v47
    v_dot2_f32_bf16 v44, v98, v26, v44
    v_dot2_f32_bf16 v45, v102, v26, v45
    v_dot2_f32_bf16 v46, v106, v26, v46
    v_dot2_f32_bf16 v47, v110, v26, v47
    v_dot2_f32_bf16 v44, v99, v27, v44
    v_dot2_f32_bf16 v45, v103, v27, v45
    v_dot2_f32_bf16 v46, v107, v27, v46
    v_dot2_f32_bf16 v47, v111, v27, v47
    s_waitcnt vmcnt(5)
    s_cbranch_vccnz L_t141
    s_waitcnt vmcnt(4)
L_t141:
    buffer_load_dwordx4 v[96:99], v128, s[32:35], s52 offen nt
    s_waitcnt vmcnt(5)
    s_cbranch_vccnz L_t142
    s_waitcnt vmcnt(4)
L_t142:
    buffer_load_dwordx4 v[100:103], v129, s[32:35], s52 offen nt
    v_xor_b32 v236, v236, v233
    v_and_b32 v236, 1, v236
    v_cmp_eq_u32 s[54:55], 1, v236
    s_nop 0
    s_and_b32 s54, s54, -2
    s_bcnt1_i32_b32 s54, s54
    s_mul_i32 s54, s54, 109
    s_sub_i32 s54, s54, 294
    s_ashr_i32 s54, s54, 6
    v_mov_b32 v231, s54
    v_mov_b32 v236, 4400
    s_cmp_lg_u32 s3, 0
    s_cbranch_scc1 L_t143
    ds_write_b32 v236, v231
L_t143:
    v_dot2_f32_bf16 v48, v112, v24, 0
    v_dot2_f32_bf16 v49, v116, v24, 0
    v_dot2_f32_bf16 v50, v120, v24, 0
    v_dot2_f32_bf16 v51, v124, v24, 0
    v_dot2_f32_bf16 v48, v113, v25, v48
    v_dot2_f32_bf16 v49, v117, v25, v49
    v_dot2_f32_bf16 v50, v121, v25, v50
    v_dot2_f32_bf16 v51, v125, v25, v51
    v_dot2_f32_bf16 v48, v114, v26, v48
    v_dot2_f32_bf16 v49, v118, v26, v49
    v_dot2_f32_bf16 v50, v122, v26, v50
    v_dot2_f32_bf16 v51, v126, v26, v51
    v_dot2_f32_bf16 v48, v115, v27, v48
    v_dot2_f32_bf16 v49, v119, v27, v49
    v_dot2_f32_bf16 v50, v123, v27, v50
    v_dot2_f32_bf16 v51, v127, v27, v51
    s_waitcnt vmcnt(5)
    s_cbranch_vccnz L_t144
    s_waitcnt vmcnt(4)
L_t144:
    buffer_load_dwordx4 v[104:107], v130, s[32:35], s52 offen nt
    s_waitcnt vmcnt(5)
    s_cbranch_vccnz L_t145
    s_waitcnt vmcnt(4)
L_t145:
    buffer_load_dwordx4 v[108:111], v131, s[32:35], s52 offen nt
    s_mul_i32 s54, s3, 2560
    v_add_u32 v62, s54, v11
    s_mov_b32 exec_hi, 0
    ds_write_b128 v62, v[176:179] offset:4608
    ds_write_b128 v62, v[180:183] offset:5120
    ds_write_b128 v62, v[184:187] offset:5632
    ds_write_b128 v62, v[188:191] offset:6144
    ds_write_b128 v62, v[192:195] offset:6656
    s_mov_b32 exec_hi, -1
    v_add_f32_dpp v44, v44, v44 row_ror:8 row_mask:0xf bank_mask:0x3
    v_add_f32_dpp v48, v48, v48 row_ror:8 row_mask:0xf bank_mask:0x3
    v_add_f32_dpp v45, v45, v45 row_ror:8 row_mask:0xf bank_mask:0x3
    v_add_f32_dpp v49, v49, v49 row_ror:8 row_mask:0xf bank_mask:0x3
    v_add_f32_dpp v44, v46, v46 row_ror:8 row_mask:0xf bank_mask:0xc
    v_add_f32_dpp v48, v50, v50 row_ror:8 row_mask:0xf bank_mask:0xc
    v_add_f32_dpp v45, v47, v47 row_ror:8 row_mask:0xf bank_mask:0xc
    v_add_f32_dpp v49, v51, v51 row_ror:8 row_mask:0xf bank_mask:0xc
    v_add_f32_dpp v44, v44, v44 row_half_mirror row_mask:0xf bank_mask:0x5
    v_add_f32_dpp v48, v48, v48 row_half_mirror row_mask:0xf bank_mask:0x5
    s_nop 0
    v_add_f32_dpp v44, v45, v45 row_half_mirror row_mask:0xf bank_mask:0xa
    v_add_f32_dpp v48, v49, v49 row_half_mirror row_mask:0xf bank_mask:0xa
    s_nop 0
    v_add_f32_dpp v44, v44, v44 quad_perm:[1,0,3,2] row_mask:0xf bank_mask:0xf
    v_add_f32_dpp v48, v48, v48 quad_perm:[1,0,3,2] row_mask:0xf bank_mask:0xf
    s_nop 0
    v_add_f32_dpp v44, v44, v44 quad_perm:[2,3,0,1] row_mask:0xf bank_mask:0xf
    v_add_f32_dpp v48, v48, v48 quad_perm:[2,3,0,1] row_mask:0xf bank_mask:0xf
    s_waitcnt vmcnt(5)
    s_cbranch_vccnz L_t146
    s_waitcnt vmcnt(4)
L_t146:
    buffer_load_dwordx4 v[112:115], v132, s[32:35], s52 offen nt
    s_waitcnt vmcnt(5)
    s_cbranch_vccnz L_t147
    s_waitcnt vmcnt(4)
L_t147:
    buffer_load_dwordx4 v[116:119], v133, s[32:35], s52 offen nt
    v_cndmask_b32 v137, v137, v44, s[66:67]
    v_cndmask_b32 v137, v137, v48, s[68:69]
    s_waitcnt vmcnt(5)
    s_cbranch_vccnz L_t148
    s_waitcnt vmcnt(4)
L_t148:
    buffer_load_dwordx4 v[120:123], v134, s[32:35], s52 offen nt
    s_waitcnt vmcnt(5)
    s_cbranch_vccnz L_t149
    s_waitcnt vmcnt(4)
L_t149:
    buffer_load_dwordx4 v[124:127], v135, s[32:35], s52 offen nt
    v_lshlrev_b32 v62, 4, v0
    s_waitcnt lgkmcnt(0)
    s_barrier
    ds_read_b128 v[144:147], v62 offset:4608
    ds_read_b128 v[148:151], v62 offset:7168
    ds_read_b128 v[152:155], v62 offset:9728
    ds_read_b128 v[156:159], v62 offset:12288
    s_waitcnt lgkmcnt(0)
    v_add_f32 v144, v144, v148
    v_add_f32 v145, v145, v149
    v_add_f32 v146, v146, v150
    v_add_f32 v147, v147, v151
    s_waitcnt lgkmcnt(0)
    v_add_f32 v144, v144, v152
    v_add_f32 v145, v145, v153
    v_add_f32 v146, v146, v154
    v_add_f32 v147, v147, v155
    s_waitcnt lgkmcnt(0)
    v_add_f32 v144, v144, v156
    v_add_f32 v145, v145, v157
    v_add_f32 v146, v146, v158
    v_add_f32 v147, v147, v159
    v_bfi_b32 v220, 1, v240, v144
    v_bfi_b32 v221, 1, v241, v145
    v_bfi_b32 v222, 1, v242, v146
    v_bfi_b32 v223, 1, v243, v147
    s_add_u32 s51, s51, 0x20000
    s_add_u32 s52, s52, 0x20000
    v_mov_b32 v236, 4400
    ds_read_b32 v231, v236
    s_waitcnt lgkmcnt(0)
    v_readfirstlane_b32 s75, v231
    s_nop 0
    s_cmp_gt_i32 s75, 0
    s_cselect_b64 vcc, -1, 0
    s_sub_i32 s75, s75, 1
    v_dot2_f32_bf16 v44, v64, v24, 0
    v_dot2_f32_bf16 v45, v68, v24, 0
    v_dot2_f32_bf16 v46, v72, v24, 0
    v_dot2_f32_bf16 v47, v76, v24, 0
    v_dot2_f32_bf16 v44, v65, v25, v44
    v_dot2_f32_bf16 v45, v69, v25, v45
    v_dot2_f32_bf16 v46, v73, v25, v46
    v_dot2_f32_bf16 v47, v77, v25, v47
    v_dot2_f32_bf16 v44, v66, v26, v44
    v_dot2_f32_bf16 v45, v70, v26, v45
    v_dot2_f32_bf16 v46, v74, v26, v46
    v_dot2_f32_bf16 v47, v78, v26, v47
    v_dot2_f32_bf16 v44, v67, v27, v44
    v_dot2_f32_bf16 v45, v71, v27, v45
    v_dot2_f32_bf16 v46, v75, v27, v46
    v_dot2_f32_bf16 v47, v79, v27, v47
    s_waitcnt vmcnt(5)
    s_cbranch_vccnz L_t150
    s_waitcnt vmcnt(4)
L_t150:
    buffer_load_dwordx4 v[64:67], v128, s[32:35], s51 offen nt
    s_waitcnt vmcnt(5)
    s_cbranch_vccnz L_t151
    s_waitcnt vmcnt(4)
L_t151:
    buffer_load_dwordx4 v[68:71], v129, s[32:35], s51 offen nt
    v_dot2_f32_bf16 v48, v80, v24, 0
    v_dot2_f32_bf16 v49, v84, v24, 0
    v_dot2_f32_bf16 v50, v88, v24, 0
    v_dot2_f32_bf16 v51, v92, v24, 0
    v_dot2_f32_bf16 v48, v81, v25, v48
    v_dot2_f32_bf16 v49, v85, v25, v49
    v_dot2_f32_bf16 v50, v89, v25, v50
    v_dot2_f32_bf16 v51, v93, v25, v51
    v_dot2_f32_bf16 v48, v82, v26, v48
    v_dot2_f32_bf16 v49, v86, v26, v49
    v_dot2_f32_bf16 v50, v90, v26, v50
    v_dot2_f32_bf16 v51, v94, v26, v51
    v_dot2_f32_bf16 v48, v83, v27, v48
    v_dot2_f32_bf16 v49, v87, v27, v49
    v_dot2_f32_bf16 v50, v91, v27, v50
    v_dot2_f32_bf16 v51, v95, v27, v51
    s_waitcnt vmcnt(5)
    s_cbranch_vccnz L_t152
    s_waitcnt vmcnt(4)
L_t152:
    buffer_load_dwordx4 v[72:75], v130, s[32:35], s51 offen nt
    s_waitcnt vmcnt(5)
    s_cbranch_vccnz L_t153
    s_waitcnt vmcnt(4)
L_t153:
    buffer_load_dwordx4 v[76:79], v131, s[32:35], s51 offen nt
    s_mov_b64 s[36:37], s[22:23]
    s_mov_b32 s58, s60
    buffer_load_dwordx4 a[0:3], v3, s[36:39], s58 offen offset:0
    v_add_f32_dpp v44, v44, v44 row_ror:8 row_mask:0xf bank_mask:0x3
    v_add_f32_dpp v48, v48, v48 row_ror:8 row_mask:0xf bank_mask:0x3
    v_add_f32_dpp v45, v45, v45 row_ror:8 row_mask:0xf bank_mask:0x3
    v_add_f32_dpp v49, v49, v49 row_ror:8 row_mask:0xf bank_mask:0x3
    v_add_f32_dpp v44, v46, v46 row_ror:8 row_mask:0xf bank_mask:0xc
    v_add_f32_dpp v48, v50, v50 row_ror:8 row_mask:0xf bank_mask:0xc
    v_add_f32_dpp v45, v47, v47 row_ror:8 row_mask:0xf bank_mask:0xc
    v_add_f32_dpp v49, v51, v51 row_ror:8 row_mask:0xf bank_mask:0xc
    v_add_f32_dpp v44, v44, v44 row_half_mirror row_mask:0xf bank_mask:0x5
    v_add_f32_dpp v48, v48, v48 row_half_mirror row_mask:0xf bank_mask:0x5
    s_nop 0
    v_add_f32_dpp v44, v45, v45 row_half_mirror row_mask:0xf bank_mask:0xa
    v_add_f32_dpp v48, v49, v49 row_half_mirror row_mask:0xf bank_mask:0xa
    s_nop 0
    v_add_f32_dpp v44, v44, v44 quad_perm:[1,0,3,2] row_mask:0xf bank_mask:0xf
    v_add_f32_dpp v48, v48, v48 quad_perm:[1,0,3,2] row_mask:0xf bank_mask:0xf
    s_nop 0
    v_add_f32_dpp v44, v44, v44 quad_perm:[2,3,0,1] row_mask:0xf bank_mask:0xf
    v_add_f32_dpp v48, v48, v48 quad_perm:[2,3,0,1] row_mask:0xf bank_mask:0xf
    s_waitcnt vmcnt(6)
    s_cbranch_vccnz L_t154
    s_waitcnt vmcnt(5)
L_t154:
    buffer_load_dwordx4 v[80:83], v132, s[32:35], s51 offen nt
    s_waitcnt vmcnt(6)
    s_cbranch_vccnz L_t155
    s_waitcnt vmcnt(5)
L_t155:
    buffer_load_dwordx4 v[84:87], v133, s[32:35], s51 offen nt
    v_cndmask_b32 v138, v44, v48, s[64:65]
    s_waitcnt vmcnt(6)
    s_cbranch_vccnz L_t156
    s_waitcnt vmcnt(5)
L_t156:
    buffer_load_dwordx4 v[88:91], v134, s[32:35], s51 offen nt
    s_waitcnt vmcnt(6)
    s_cbranch_vccnz L_t157
    s_waitcnt vmcnt(5)
L_t157:
    buffer_load_dwordx4 v[92:95], v135, s[32:35], s51 offen nt
    buffer_load_dwordx4 a[8:11], v3, s[36:39], s58 offen offset:256
    v_dot2_f32_bf16 v44, v96, v24, 0
    v_dot2_f32_bf16 v45, v100, v24, 0
    v_dot2_f32_bf16 v46, v104, v24, 0
    v_dot2_f32_bf16 v47, v108, v24, 0
    v_dot2_f32_bf16 v44, v97, v25, v44
    v_dot2_f32_bf16 v45, v101, v25, v45
    v_dot2_f32_bf16 v46, v105, v25, v46
    v_dot2_f32_bf16 v47, v109, v25, v47
    v_dot2_f32_bf16 v44, v98, v26, v44
    v_dot2_f32_bf16 v45, v102, v26, v45
    v_dot2_f32_bf16 v46, v106, v26, v46
    v_dot2_f32_bf16 v47, v110, v26, v47
    v_dot2_f32_bf16 v44, v99, v27, v44
    v_dot2_f32_bf16 v45, v103, v27, v45
    v_dot2_f32_bf16 v46, v107, v27, v46
    v_dot2_f32_bf16 v47, v111, v27, v47
    s_waitcnt vmcnt(7)
    s_cbranch_vccnz L_t158
    s_waitcnt vmcnt(6)
L_t158:
    buffer_load_dwordx4 v[96:99], v128, s[32:35], s52 offen nt
    s_waitcnt vmcnt(7)
    s_cbranch_vccnz L_t159
    s_waitcnt vmcnt(5)
L_t159:
    buffer_load_dwordx4 v[100:103], v129, s[32:35], s52 offen nt
    v_dot2_f32_bf16 v48, v112, v24, 0
    v_dot2_f32_bf16 v49, v116, v24, 0
    v_dot2_f32_bf16 v50, v120, v24, 0
    v_dot2_f32_bf16 v51, v124, v24, 0
    v_dot2_f32_bf16 v48, v113, v25, v48
    v_dot2_f32_bf16 v49, v117, v25, v49
    v_dot2_f32_bf16 v50, v121, v25, v50
    v_dot2_f32_bf16 v51, v125, v25, v51
    v_dot2_f32_bf16 v48, v114, v26, v48
    v_dot2_f32_bf16 v49, v118, v26, v49
    v_dot2_f32_bf16 v50, v122, v26, v50
    v_dot2_f32_bf16 v51, v126, v26, v51
    v_dot2_f32_bf16 v48, v115, v27, v48
    v_dot2_f32_bf16 v49, v119, v27, v49
    v_dot2_f32_bf16 v50, v123, v27, v50
    v_dot2_f32_bf16 v51, v127, v27, v51
    s_waitcnt vmcnt(6)
    s_cbranch_vccnz L_t160
    s_waitcnt vmcnt(5)
L_t160:
    buffer_load_dwordx4 v[104:107], v130, s[32:35], s52 offen nt
    s_waitcnt vmcnt(6)
    s_cbranch_vccnz L_t161
    s_waitcnt vmcnt(5)
L_t161:
    buffer_load_dwordx4 v[108:111], v131, s[32:35], s52 offen nt
    buffer_load_dwordx4 a[16:19], v3, s[36:39], s58 offen offset:512
    v_add_f32_dpp v44, v44, v44 row_ror:8 row_mask:0xf bank_mask:0x3
    v_add_f32_dpp v48, v48, v48 row_ror:8 row_mask:0xf bank_mask:0x3
    v_add_f32_dpp v45, v45, v45 row_ror:8 row_mask:0xf bank_mask:0x3
    v_add_f32_dpp v49, v49, v49 row_ror:8 row_mask:0xf bank_mask:0x3
    v_add_f32_dpp v44, v46, v46 row_ror:8 row_mask:0xf bank_mask:0xc
    v_add_f32_dpp v48, v50, v50 row_ror:8 row_mask:0xf bank_mask:0xc
    v_add_f32_dpp v45, v47, v47 row_ror:8 row_mask:0xf bank_mask:0xc
    v_add_f32_dpp v49, v51, v51 row_ror:8 row_mask:0xf bank_mask:0xc
    v_add_f32_dpp v44, v44, v44 row_half_mirror row_mask:0xf bank_mask:0x5
    v_add_f32_dpp v48, v48, v48 row_half_mirror row_mask:0xf bank_mask:0x5
    s_nop 0
    v_add_f32_dpp v44, v45, v45 row_half_mirror row_mask:0xf bank_mask:0xa
    v_add_f32_dpp v48, v49, v49 row_half_mirror row_mask:0xf bank_mask:0xa
    s_nop 0
    v_add_f32_dpp v44, v44, v44 quad_perm:[1,0,3,2] row_mask:0xf bank_mask:0xf
    v_add_f32_dpp v48, v48, v48 quad_perm:[1,0,3,2] row_mask:0xf bank_mask:0xf
    s_nop 0
    v_add_f32_dpp v44, v44, v44 quad_perm:[2,3,0,1] row_mask:0xf bank_mask:0xf
    v_add_f32_dpp v48, v48, v48 quad_perm:[2,3,0,1] row_mask:0xf bank_mask:0xf
    s_waitcnt vmcnt(7)
    s_cbranch_vccnz L_t162
    s_waitcnt vmcnt(6)
L_t162:
    buffer_load_dwordx4 v[112:115], v132, s[32:35], s52 offen nt
    s_waitcnt vmcnt(7)
    s_cbranch_vccnz L_t163
    s_waitcnt vmcnt(5)
L_t163:
    buffer_load_dwordx4 v[116:119], v133, s[32:35], s52 offen nt
    v_cndmask_b32 v138, v138, v44, s[66:67]
    v_cndmask_b32 v138, v138, v48, s[68:69]
    s_waitcnt vmcnt(6)
    s_cbranch_vccnz L_t164
    s_waitcnt vmcnt(5)
L_t164:
    buffer_load_dwordx4 v[120:123], v134, s[32:35], s52 offen nt
    s_waitcnt vmcnt(6)
    s_cbranch_vccnz L_t165
    s_waitcnt vmcnt(5)
L_t165:
    buffer_load_dwordx4 v[124:127], v135, s[32:35], s52 offen nt
    buffer_load_dwordx4 a[24:27], v3, s[36:39], s58 offen offset:768
    s_add_u32 s51, s51, 0x20000
    s_add_u32 s52, s52, 0x20000
    s_cmp_gt_i32 s75, 0
    s_cselect_b64 vcc, -1, 0
    s_sub_i32 s75, s75, 1
    v_dot2_f32_bf16 v44, v64, v24, 0
    v_dot2_f32_bf16 v45, v68, v24, 0
    v_dot2_f32_bf16 v46, v72, v24, 0
    v_dot2_f32_bf16 v47, v76, v24, 0
    v_dot2_f32_bf16 v44, v65, v25, v44
    v_dot2_f32_bf16 v45, v69, v25, v45
    v_dot2_f32_bf16 v46, v73, v25, v46
    v_dot2_f32_bf16 v47, v77, v25, v47
    v_dot2_f32_bf16 v44, v66, v26, v44
    v_dot2_f32_bf16 v45, v70, v26, v45
    v_dot2_f32_bf16 v46, v74, v26, v46
    v_dot2_f32_bf16 v47, v78, v26, v47
    v_dot2_f32_bf16 v44, v67, v27, v44
    v_dot2_f32_bf16 v45, v71, v27, v45
    v_dot2_f32_bf16 v46, v75, v27, v46
    v_dot2_f32_bf16 v47, v79, v27, v47
    s_waitcnt vmcnt(7)
    s_cbranch_vccnz L_t166
    s_waitcnt vmcnt(6)
L_t166:
    buffer_load_dwordx4 v[64:67], v128, s[32:35], s51 offen nt
    s_waitcnt vmcnt(7)
    s_cbranch_vccnz L_t167
    s_waitcnt vmcnt(5)
L_t167:
    buffer_load_dwordx4 v[68:71], v129, s[32:35], s51 offen nt
    v_dot2_f32_bf16 v48, v80, v24, 0
    v_dot2_f32_bf16 v49, v84, v24, 0
    v_dot2_f32_bf16 v50, v88, v24, 0
    v_dot2_f32_bf16 v51, v92, v24, 0
    v_dot2_f32_bf16 v48, v81, v25, v48
    v_dot2_f32_bf16 v49, v85, v25, v49
    v_dot2_f32_bf16 v50, v89, v25, v50
    v_dot2_f32_bf16 v51, v93, v25, v51
    v_dot2_f32_bf16 v48, v82, v26, v48
    v_dot2_f32_bf16 v49, v86, v26, v49
    v_dot2_f32_bf16 v50, v90, v26, v50
    v_dot2_f32_bf16 v51, v94, v26, v51
    v_dot2_f32_bf16 v48, v83, v27, v48
    v_dot2_f32_bf16 v49, v87, v27, v49
    v_dot2_f32_bf16 v50, v91, v27, v50
    v_dot2_f32_bf16 v51, v95, v27, v51
    s_waitcnt vmcnt(6)
    s_cbranch_vccnz L_t168
    s_waitcnt vmcnt(5)
L_t168:
    buffer_load_dwordx4 v[72:75], v130, s[32:35], s51 offen nt
    s_waitcnt vmcnt(6)
    s_cbranch_vccnz L_t169
    s_waitcnt vmcnt(5)
L_t169:
    buffer_load_dwordx4 v[76:79], v131, s[32:35], s51 offen nt
    buffer_load_dwordx4 a[32:35], v3, s[36:39], s58 offen offset:1024
    s_cmp_eq_u32 s71, 7
    s_cselect_b32 s63, 0xffff7400, s73
    s_add_u32 s58, s58, s63
    v_add_f32_dpp v44, v44, v44 row_ror:8 row_mask:0xf bank_mask:0x3
    v_add_f32_dpp v48, v48, v48 row_ror:8 row_mask:0xf bank_mask:0x3
    v_add_f32_dpp v45, v45, v45 row_ror:8 row_mask:0xf bank_mask:0x3
    v_add_f32_dpp v49, v49, v49 row_ror:8 row_mask:0xf bank_mask:0x3
    v_add_f32_dpp v44, v46, v46 row_ror:8 row_mask:0xf bank_mask:0xc
    v_add_f32_dpp v48, v50, v50 row_ror:8 row_mask:0xf bank_mask:0xc
    v_add_f32_dpp v45, v47, v47 row_ror:8 row_mask:0xf bank_mask:0xc
    v_add_f32_dpp v49, v51, v51 row_ror:8 row_mask:0xf bank_mask:0xc
    v_add_f32_dpp v44, v44, v44 row_half_mirror row_mask:0xf bank_mask:0x5
    v_add_f32_dpp v48, v48, v48 row_half_mirror row_mask:0xf bank_mask:0x5
    s_nop 0
    v_add_f32_dpp v44, v45, v45 row_half_mirror row_mask:0xf bank_mask:0xa
    v_add_f32_dpp v48, v49, v49 row_half_mirror row_mask:0xf bank_mask:0xa
    s_nop 0
    v_add_f32_dpp v44, v44, v44 quad_perm:[1,0,3,2] row_mask:0xf bank_mask:0xf
    v_add_f32_dpp v48, v48, v48 quad_perm:[1,0,3,2] row_mask:0xf bank_mask:0xf
    s_nop 0
    v_add_f32_dpp v44, v44, v44 quad_perm:[2,3,0,1] row_mask:0xf bank_mask:0xf
    v_add_f32_dpp v48, v48, v48 quad_perm:[2,3,0,1] row_mask:0xf bank_mask:0xf
    s_waitcnt vmcnt(7)
    s_cbranch_vccnz L_t170
    s_waitcnt vmcnt(6)
L_t170:
    buffer_load_dwordx4 v[80:83], v132, s[32:35], s51 offen nt
    s_waitcnt vmcnt(7)
    s_cbranch_vccnz L_t171
    s_waitcnt vmcnt(5)
L_t171:
    buffer_load_dwordx4 v[84:87], v133, s[32:35], s51 offen nt
    v_cndmask_b32 v139, v44, v48, s[64:65]
    s_waitcnt vmcnt(6)
    s_cbranch_vccnz L_t172
    s_waitcnt vmcnt(5)
L_t172:
    buffer_load_dwordx4 v[88:91], v134, s[32:35], s51 offen nt
    s_waitcnt vmcnt(6)
    s_cbranch_vccnz L_t173
    s_waitcnt vmcnt(5)
L_t173:
    buffer_load_dwordx4 v[92:95], v135, s[32:35], s51 offen nt
    buffer_load_dwordx4 a[40:43], v3, s[36:39], s58 offen offset:0
    v_dot2_f32_bf16 v44, v96, v24, 0
    v_dot2_f32_bf16 v45, v100, v24, 0
    v_dot2_f32_bf16 v46, v104, v24, 0
    v_dot2_f32_bf16 v47, v108, v24, 0
    v_dot2_f32_bf16 v44, v97, v25, v44
    v_dot2_f32_bf16 v45, v101, v25, v45
    v_dot2_f32_bf16 v46, v105, v25, v46
    v_dot2_f32_bf16 v47, v109, v25, v47
    v_dot2_f32_bf16 v44, v98, v26, v44
    v_dot2_f32_bf16 v45, v102, v26, v45
    v_dot2_f32_bf16 v46, v106, v26, v46
    v_dot2_f32_bf16 v47, v110, v26, v47
    v_dot2_f32_bf16 v44, v99, v27, v44
    v_dot2_f32_bf16 v45, v103, v27, v45
    v_dot2_f32_bf16 v46, v107, v27, v46
    v_dot2_f32_bf16 v47, v111, v27, v47
    s_waitcnt vmcnt(7)
    s_cbranch_vccnz L_t174
    s_waitcnt vmcnt(6)
L_t174:
    buffer_load_dwordx4 v[96:99], v128, s[32:35], s52 offen nt
    s_waitcnt vmcnt(7)
    s_cbranch_vccnz L_t175
    s_waitcnt vmcnt(5)
L_t175:
    buffer_load_dwordx4 v[100:103], v129, s[32:35], s52 offen nt
    v_dot2_f32_bf16 v48, v112, v24, 0
    v_dot2_f32_bf16 v49, v116, v24, 0
    v_dot2_f32_bf16 v50, v120, v24, 0
    v_dot2_f32_bf16 v51, v124, v24, 0
    v_dot2_f32_bf16 v48, v113, v25, v48
    v_dot2_f32_bf16 v49, v117, v25, v49
    v_dot2_f32_bf16 v50, v121, v25, v50
    v_dot2_f32_bf16 v51, v125, v25, v51
    v_dot2_f32_bf16 v48, v114, v26, v48
    v_dot2_f32_bf16 v49, v118, v26, v49
    v_dot2_f32_bf16 v50, v122, v26, v50
    v_dot2_f32_bf16 v51, v126, v26, v51
    v_dot2_f32_bf16 v48, v115, v27, v48
    v_dot2_f32_bf16 v49, v119, v27, v49
    v_dot2_f32_bf16 v50, v123, v27, v50
    v_dot2_f32_bf16 v51, v127, v27, v51
    s_waitcnt vmcnt(6)
    s_cbranch_vccnz L_t176
    s_waitcnt vmcnt(5)
L_t176:
    buffer_load_dwordx4 v[104:107], v130, s[32:35], s52 offen nt
    s_waitcnt vmcnt(6)
    s_cbranch_vccnz L_t177
    s_waitcnt vmcnt(5)
L_t177:
    buffer_load_dwordx4 v[108:111], v131, s[32:35], s52 offen nt
    buffer_load_dwordx4 a[48:51], v3, s[36:39], s58 offen offset:256
    v_add_f32_dpp v44, v44, v44 row_ror:8 row_mask:0xf bank_mask:0x3
    v_add_f32_dpp v48, v48, v48 row_ror:8 row_mask:0xf bank_mask:0x3
    v_add_f32_dpp v45, v45, v45 row_ror:8 row_mask:0xf bank_mask:0x3
    v_add_f32_dpp v49, v49, v49 row_ror:8 row_mask:0xf bank_mask:0x3
    v_add_f32_dpp v44, v46, v46 row_ror:8 row_mask:0xf bank_mask:0xc
    v_add_f32_dpp v48, v50, v50 row_ror:8 row_mask:0xf bank_mask:0xc
    v_add_f32_dpp v45, v47, v47 row_ror:8 row_mask:0xf bank_mask:0xc
    v_add_f32_dpp v49, v51, v51 row_ror:8 row_mask:0xf bank_mask:0xc
    v_add_f32_dpp v44, v44, v44 row_half_mirror row_mask:0xf bank_mask:0x5
    v_add_f32_dpp v48, v48, v48 row_half_mirror row_mask:0xf bank_mask:0x5
    s_nop 0
    v_add_f32_dpp v44, v45, v45 row_half_mirror row_mask:0xf bank_mask:0xa
    v_add_f32_dpp v48, v49, v49 row_half_mirror row_mask:0xf bank_mask:0xa
    s_nop 0
    v_add_f32_dpp v44, v44, v44 quad_perm:[1,0,3,2] row_mask:0xf bank_mask:0xf
    v_add_f32_dpp v48, v48, v48 quad_perm:[1,0,3,2] row_mask:0xf bank_mask:0xf
    s_nop 0
    v_add_f32_dpp v44, v44, v44 quad_perm:[2,3,0,1] row_mask:0xf bank_mask:0xf
    v_add_f32_dpp v48, v48, v48 quad_perm:[2,3,0,1] row_mask:0xf bank_mask:0xf
    s_waitcnt vmcnt(7)
    s_cbranch_vccnz L_t178
    s_waitcnt vmcnt(6)
L_t178:
    buffer_load_dwordx4 v[112:115], v132, s[32:35], s52 offen nt
    s_waitcnt vmcnt(7)
    s_cbranch_vccnz L_t179
    s_waitcnt vmcnt(5)
L_t179:
    buffer_load_dwordx4 v[116:119], v133, s[32:35], s52 offen nt
    v_cndmask_b32 v139, v139, v44, s[66:67]
    v_cndmask_b32 v139, v139, v48, s[68:69]
    s_waitcnt vmcnt(6)
    s_cbranch_vccnz L_t180
    s_waitcnt vmcnt(5)
L_t180:
    buffer_load_dwordx4 v[120:123], v134, s[32:35], s52 offen nt
    s_waitcnt vmcnt(6)
    s_cbranch_vccnz L_t181
    s_waitcnt vmcnt(5)
L_t181:
    buffer_load_dwordx4 v[124:127], v135, s[32:35], s52 offen nt
    buffer_load_dwordx4 a[56:59], v3, s[36:39], s58 offen offset:512
    s_add_u32 s51, s51, 0x20000
    s_add_u32 s52, s52, 0x20000
    s_cmp_gt_i32 s75, 0
    s_cselect_b64 vcc, -1, 0
    s_sub_i32 s75, s75, 1
    v_dot2_f32_bf16 v44, v64, v24, 0
    v_dot2_f32_bf16 v45, v68, v24, 0
    v_dot2_f32_bf16 v46, v72, v24, 0
    v_dot2_f32_bf16 v47, v76, v24, 0
    v_dot2_f32_bf16 v44, v65, v25, v44
    v_dot2_f32_bf16 v45, v69, v25, v45
    v_dot2_f32_bf16 v46, v73, v25, v46
    v_dot2_f32_bf16 v47, v77, v25, v47
    v_dot2_f32_bf16 v44, v66, v26, v44
    v_dot2_f32_bf16 v45, v70, v26, v45
    v_dot2_f32_bf16 v46, v74, v26, v46
    v_dot2_f32_bf16 v47, v78, v26, v47
    v_dot2_f32_bf16 v44, v67, v27, v44
    v_dot2_f32_bf16 v45, v71, v27, v45
    v_dot2_f32_bf16 v46, v75, v27, v46
    v_dot2_f32_bf16 v47, v79, v27, v47
    s_waitcnt vmcnt(7)
    s_cbranch_vccnz L_t182
    s_waitcnt vmcnt(6)
L_t182:
    buffer_load_dwordx4 v[64:67], v128, s[32:35], s51 offen nt
    s_waitcnt vmcnt(7)
    s_cbranch_vccnz L_t183
    s_waitcnt vmcnt(5)
L_t183:
    buffer_load_dwordx4 v[68:71], v129, s[32:35], s51 offen nt
    v_dot2_f32_bf16 v48, v80, v24, 0
    v_dot2_f32_bf16 v49, v84, v24, 0
    v_dot2_f32_bf16 v50, v88, v24, 0
    v_dot2_f32_bf16 v51, v92, v24, 0
    v_dot2_f32_bf16 v48, v81, v25, v48
    v_dot2_f32_bf16 v49, v85, v25, v49
    v_dot2_f32_bf16 v50, v89, v25, v50
    v_dot2_f32_bf16 v51, v93, v25, v51
    v_dot2_f32_bf16 v48, v82, v26, v48
    v_dot2_f32_bf16 v49, v86, v26, v49
    v_dot2_f32_bf16 v50, v90, v26, v50
    v_dot2_f32_bf16 v51, v94, v26, v51
    v_dot2_f32_bf16 v48, v83, v27, v48
    v_dot2_f32_bf16 v49, v87, v27, v49
    v_dot2_f32_bf16 v50, v91, v27, v50
    v_dot2_f32_bf16 v51, v95, v27, v51
    s_waitcnt vmcnt(6)
    s_cbranch_vccnz L_t184
    s_waitcnt vmcnt(5)
L_t184:
    buffer_load_dwordx4 v[72:75], v130, s[32:35], s51 offen nt
    s_waitcnt vmcnt(6)
    s_cbranch_vccnz L_t185
    s_waitcnt vmcnt(5)
L_t185:
    buffer_load_dwordx4 v[76:79], v131, s[32:35], s51 offen nt
    buffer_load_dwordx4 a[64:67], v3, s[36:39], s58 offen offset:768
    v_add_f32_dpp v44, v44, v44 row_ror:8 row_mask:0xf bank_mask:0x3
    v_add_f32_dpp v48, v48, v48 row_ror:8 row_mask:0xf bank_mask:0x3
    v_add_f32_dpp v45, v45, v45 row_ror:8 row_mask:0xf bank_mask:0x3
    v_add_f32_dpp v49, v49, v49 row_ror:8 row_mask:0xf bank_mask:0x3
    v_add_f32_dpp v44, v46, v46 row_ror:8 row_mask:0xf bank_mask:0xc
    v_add_f32_dpp v48, v50, v50 row_ror:8 row_mask:0xf bank_mask:0xc
    v_add_f32_dpp v45, v47, v47 row_ror:8 row_mask:0xf bank_mask:0xc
    v_add_f32_dpp v49, v51, v51 row_ror:8 row_mask:0xf bank_mask:0xc
    v_add_f32_dpp v44, v44, v44 row_half_mirror row_mask:0xf bank_mask:0x5
    v_add_f32_dpp v48, v48, v48 row_half_mirror row_mask:0xf bank_mask:0x5
    s_nop 0
    v_add_f32_dpp v44, v45, v45 row_half_mirror row_mask:0xf bank_mask:0xa
    v_add_f32_dpp v48, v49, v49 row_half_mirror row_mask:0xf bank_mask:0xa
    s_nop 0
    v_add_f32_dpp v44, v44, v44 quad_perm:[1,0,3,2] row_mask:0xf bank_mask:0xf
    v_add_f32_dpp v48, v48, v48 quad_perm:[1,0,3,2] row_mask:0xf bank_mask:0xf
    s_nop 0
    v_add_f32_dpp v44, v44, v44 quad_perm:[2,3,0,1] row_mask:0xf bank_mask:0xf
    v_add_f32_dpp v48, v48, v48 quad_perm:[2,3,0,1] row_mask:0xf bank_mask:0xf
    s_waitcnt vmcnt(7)
    s_cbranch_vccnz L_t186
    s_waitcnt vmcnt(6)
L_t186:
    buffer_load_dwordx4 v[80:83], v132, s[32:35], s51 offen nt
    s_waitcnt vmcnt(7)
    s_cbranch_vccnz L_t187
    s_waitcnt vmcnt(5)
L_t187:
    buffer_load_dwordx4 v[84:87], v133, s[32:35], s51 offen nt
    v_cndmask_b32 v140, v44, v48, s[64:65]
    s_waitcnt vmcnt(6)
    s_cbranch_vccnz L_t188
    s_waitcnt vmcnt(5)
L_t188:
    buffer_load_dwordx4 v[88:91], v134, s[32:35], s51 offen nt
    s_waitcnt vmcnt(6)
    s_cbranch_vccnz L_t189
    s_waitcnt vmcnt(5)
L_t189:
    buffer_load_dwordx4 v[92:95], v135, s[32:35], s51 offen nt
    buffer_load_dwordx4 a[72:75], v3, s[36:39], s58 offen offset:1024
    s_cmp_eq_u32 s71, 6
    s_cselect_b32 s63, 0xffff7400, s73
    s_add_u32 s58, s58, s63
    v_dot2_f32_bf16 v44, v96, v24, 0
    v_dot2_f32_bf16 v45, v100, v24, 0
    v_dot2_f32_bf16 v46, v104, v24, 0
    v_dot2_f32_bf16 v47, v108, v24, 0
    v_dot2_f32_bf16 v44, v97, v25, v44
    v_dot2_f32_bf16 v45, v101, v25, v45
    v_dot2_f32_bf16 v46, v105, v25, v46
    v_dot2_f32_bf16 v47, v109, v25, v47
    v_dot2_f32_bf16 v44, v98, v26, v44
    v_dot2_f32_bf16 v45, v102, v26, v45
    v_dot2_f32_bf16 v46, v106, v26, v46
    v_dot2_f32_bf16 v47, v110, v26, v47
    v_dot2_f32_bf16 v44, v99, v27, v44
    v_dot2_f32_bf16 v45, v103, v27, v45
    v_dot2_f32_bf16 v46, v107, v27, v46
    v_dot2_f32_bf16 v47, v111, v27, v47
    s_waitcnt vmcnt(7)
    s_cbranch_vccnz L_t190
    s_waitcnt vmcnt(6)
L_t190:
    buffer_load_dwordx4 v[96:99], v128, s[32:35], s52 offen nt
    s_waitcnt vmcnt(7)
    s_cbranch_vccnz L_t191
    s_waitcnt vmcnt(5)
L_t191:
    buffer_load_dwordx4 v[100:103], v129, s[32:35], s52 offen nt
    v_dot2_f32_bf16 v48, v112, v24, 0
    v_dot2_f32_bf16 v49, v116, v24, 0
    v_dot2_f32_bf16 v50, v120, v24, 0
    v_dot2_f32_bf16 v51, v124, v24, 0
    v_dot2_f32_bf16 v48, v113, v25, v48
    v_dot2_f32_bf16 v49, v117, v25, v49
    v_dot2_f32_bf16 v50, v121, v25, v50
    v_dot2_f32_bf16 v51, v125, v25, v51
    v_dot2_f32_bf16 v48, v114, v26, v48
    v_dot2_f32_bf16 v49, v118, v26, v49
    v_dot2_f32_bf16 v50, v122, v26, v50
    v_dot2_f32_bf16 v51, v126, v26, v51
    v_dot2_f32_bf16 v48, v115, v27, v48
    v_dot2_f32_bf16 v49, v119, v27, v49
    v_dot2_f32_bf16 v50, v123, v27, v50
    v_dot2_f32_bf16 v51, v127, v27, v51
    s_waitcnt vmcnt(6)
    s_cbranch_vccnz L_t192
    s_waitcnt vmcnt(5)
L_t192:
    buffer_load_dwordx4 v[104:107], v130, s[32:35], s52 offen nt
    s_waitcnt vmcnt(6)
    s_cbranch_vccnz L_t193
    s_waitcnt vmcnt(5)
L_t193:
    buffer_load_dwordx4 v[108:111], v131, s[32:35], s52 offen nt
    buffer_load_dwordx4 a[80:83], v3, s[36:39], s58 offen offset:0
    v_add_f32_dpp v44, v44, v44 row_ror:8 row_mask:0xf bank_mask:0x3
    v_add_f32_dpp v48, v48, v48 row_ror:8 row_mask:0xf bank_mask:0x3
    v_add_f32_dpp v45, v45, v45 row_ror:8 row_mask:0xf bank_mask:0x3
    v_add_f32_dpp v49, v49, v49 row_ror:8 row_mask:0xf bank_mask:0x3
    v_add_f32_dpp v44, v46, v46 row_ror:8 row_mask:0xf bank_mask:0xc
    v_add_f32_dpp v48, v50, v50 row_ror:8 row_mask:0xf bank_mask:0xc
    v_add_f32_dpp v45, v47, v47 row_ror:8 row_mask:0xf bank_mask:0xc
    v_add_f32_dpp v49, v51, v51 row_ror:8 row_mask:0xf bank_mask:0xc
    v_add_f32_dpp v44, v44, v44 row_half_mirror row_mask:0xf bank_mask:0x5
    v_add_f32_dpp v48, v48, v48 row_half_mirror row_mask:0xf bank_mask:0x5
    s_nop 0
    v_add_f32_dpp v44, v45, v45 row_half_mirror row_mask:0xf bank_mask:0xa
    v_add_f32_dpp v48, v49, v49 row_half_mirror row_mask:0xf bank_mask:0xa
    s_nop 0
    v_add_f32_dpp v44, v44, v44 quad_perm:[1,0,3,2] row_mask:0xf bank_mask:0xf
    v_add_f32_dpp v48, v48, v48 quad_perm:[1,0,3,2] row_mask:0xf bank_mask:0xf
    s_nop 0
    v_add_f32_dpp v44, v44, v44 quad_perm:[2,3,0,1] row_mask:0xf bank_mask:0xf
    v_add_f32_dpp v48, v48, v48 quad_perm:[2,3,0,1] row_mask:0xf bank_mask:0xf
    s_waitcnt vmcnt(7)
    s_cbranch_vccnz L_t194
    s_waitcnt vmcnt(6)
L_t194:
    buffer_load_dwordx4 v[112:115], v132, s[32:35], s52 offen nt
    s_waitcnt vmcnt(7)
    s_cbranch_vccnz L_t195
    s_waitcnt vmcnt(5)
L_t195:
    buffer_load_dwordx4 v[116:119], v133, s[32:35], s52 offen nt
    v_cndmask_b32 v140, v140, v44, s[66:67]
    v_cndmask_b32 v140, v140, v48, s[68:69]
    s_waitcnt vmcnt(6)
    s_cbranch_vccnz L_t196
    s_waitcnt vmcnt(5)
L_t196:
    buffer_load_dwordx4 v[120:123], v134, s[32:35], s52 offen nt
    s_waitcnt vmcnt(6)
    s_cbranch_vccnz L_t197
    s_waitcnt vmcnt(5)
L_t197:
    buffer_load_dwordx4 v[124:127], v135, s[32:35], s52 offen nt
    buffer_load_dwordx4 a[88:91], v3, s[36:39], s58 offen offset:256
    s_add_u32 s51, s51, 0x20000
    s_add_u32 s52, s52, 0x20000
    s_cmp_gt_i32 s75, 0
    s_cselect_b64 vcc, -1, 0
    s_sub_i32 s75, s75, 1
    v_dot2_f32_bf16 v44, v64, v24, 0
    v_dot2_f32_bf16 v45, v68, v24, 0
    v_dot2_f32_bf16 v46, v72, v24, 0
    v_dot2_f32_bf16 v47, v76, v24, 0
    v_dot2_f32_bf16 v44, v65, v25, v44
    v_dot2_f32_bf16 v45, v69, v25, v45
    v_dot2_f32_bf16 v46, v73, v25, v46
    v_dot2_f32_bf16 v47, v77, v25, v47
    v_dot2_f32_bf16 v44, v66, v26, v44
    v_dot2_f32_bf16 v45, v70, v26, v45
    v_dot2_f32_bf16 v46, v74, v26, v46
    v_dot2_f32_bf16 v47, v78, v26, v47
    v_dot2_f32_bf16 v44, v67, v27, v44
    v_dot2_f32_bf16 v45, v71, v27, v45
    v_dot2_f32_bf16 v46, v75, v27, v46
    v_dot2_f32_bf16 v47, v79, v27, v47
    s_waitcnt vmcnt(7)
    s_cbranch_vccnz L_t198
    s_waitcnt vmcnt(6)
L_t198:
    buffer_load_dwordx4 v[64:67], v128, s[32:35], s51 offen nt
    s_waitcnt vmcnt(7)
    s_cbranch_vccnz L_t199
    s_waitcnt vmcnt(5)
L_t199:
    buffer_load_dwordx4 v[68:71], v129, s[32:35], s51 offen nt
    v_dot2_f32_bf16 v48, v80, v24, 0
    v_dot2_f32_bf16 v49, v84, v24, 0
    v_dot2_f32_bf16 v50, v88, v24, 0
    v_dot2_f32_bf16 v51, v92, v24, 0
    v_dot2_f32_bf16 v48, v81, v25, v48
    v_dot2_f32_bf16 v49, v85, v25, v49
    v_dot2_f32_bf16 v50, v89, v25, v50
    v_dot2_f32_bf16 v51, v93, v25, v51
    v_dot2_f32_bf16 v48, v82, v26, v48
    v_dot2_f32_bf16 v49, v86, v26, v49
    v_dot2_f32_bf16 v50, v90, v26, v50
    v_dot2_f32_bf16 v51, v94, v26, v51
    v_dot2_f32_bf16 v48, v83, v27, v48
    v_dot2_f32_bf16 v49, v87, v27, v49
    v_dot2_f32_bf16 v50, v91, v27, v50
    v_dot2_f32_bf16 v51, v95, v27, v51
    s_waitcnt vmcnt(6)
    s_cbranch_vccnz L_t200
    s_waitcnt vmcnt(5)
L_t200:
    buffer_load_dwordx4 v[72:75], v130, s[32:35], s51 offen nt
    s_waitcnt vmcnt(6)
    s_cbranch_vccnz L_t201
    s_waitcnt vmcnt(5)
L_t201:
    buffer_load_dwordx4 v[76:79], v131, s[32:35], s51 offen nt
    buffer_load_dwordx4 a[96:99], v3, s[36:39], s58 offen offset:512
    v_add_f32_dpp v44, v44, v44 row_ror:8 row_mask:0xf bank_mask:0x3
    v_add_f32_dpp v48, v48, v48 row_ror:8 row_mask:0xf bank_mask:0x3
    v_add_f32_dpp v45, v45, v45 row_ror:8 row_mask:0xf bank_mask:0x3
    v_add_f32_dpp v49, v49, v49 row_ror:8 row_mask:0xf bank_mask:0x3
    v_add_f32_dpp v44, v46, v46 row_ror:8 row_mask:0xf bank_mask:0xc
    v_add_f32_dpp v48, v50, v50 row_ror:8 row_mask:0xf bank_mask:0xc
    v_add_f32_dpp v45, v47, v47 row_ror:8 row_mask:0xf bank_mask:0xc
    v_add_f32_dpp v49, v51, v51 row_ror:8 row_mask:0xf bank_mask:0xc
    v_add_f32_dpp v44, v44, v44 row_half_mirror row_mask:0xf bank_mask:0x5
    v_add_f32_dpp v48, v48, v48 row_half_mirror row_mask:0xf bank_mask:0x5
    s_nop 0
    v_add_f32_dpp v44, v45, v45 row_half_mirror row_mask:0xf bank_mask:0xa
    v_add_f32_dpp v48, v49, v49 row_half_mirror row_mask:0xf bank_mask:0xa
    s_nop 0
    v_add_f32_dpp v44, v44, v44 quad_perm:[1,0,3,2] row_mask:0xf bank_mask:0xf
    v_add_f32_dpp v48, v48, v48 quad_perm:[1,0,3,2] row_mask:0xf bank_mask:0xf
    s_nop 0
    v_add_f32_dpp v44, v44, v44 quad_perm:[2,3,0,1] row_mask:0xf bank_mask:0xf
    v_add_f32_dpp v48, v48, v48 quad_perm:[2,3,0,1] row_mask:0xf bank_mask:0xf
    s_waitcnt vmcnt(7)
    s_cbranch_vccnz L_t202
    s_waitcnt vmcnt(6)
L_t202:
    buffer_load_dwordx4 v[80:83], v132, s[32:35], s51 offen nt
    s_waitcnt vmcnt(7)
    s_cbranch_vccnz L_t203
    s_waitcnt vmcnt(5)
L_t203:
    buffer_load_dwordx4 v[84:87], v133, s[32:35], s51 offen nt
    v_cndmask_b32 v141, v44, v48, s[64:65]
    s_waitcnt vmcnt(6)
    s_cbranch_vccnz L_t204
    s_waitcnt vmcnt(5)
L_t204:
    buffer_load_dwordx4 v[88:91], v134, s[32:35], s51 offen nt
    s_waitcnt vmcnt(6)
    s_cbranch_vccnz L_t205
    s_waitcnt vmcnt(5)
L_t205:
    buffer_load_dwordx4 v[92:95], v135, s[32:35], s51 offen nt
    buffer_load_dwordx4 a[104:107], v3, s[36:39], s58 offen offset:768
    v_dot2_f32_bf16 v44, v96, v24, 0
    v_dot2_f32_bf16 v45, v100, v24, 0
    v_dot2_f32_bf16 v46, v104, v24, 0
    v_dot2_f32_bf16 v47, v108, v24, 0
    v_dot2_f32_bf16 v44, v97, v25, v44
    v_dot2_f32_bf16 v45, v101, v25, v45
    v_dot2_f32_bf16 v46, v105, v25, v46
    v_dot2_f32_bf16 v47, v109, v25, v47
    v_dot2_f32_bf16 v44, v98, v26, v44
    v_dot2_f32_bf16 v45, v102, v26, v45
    v_dot2_f32_bf16 v46, v106, v26, v46
    v_dot2_f32_bf16 v47, v110, v26, v47
    v_dot2_f32_bf16 v44, v99, v27, v44
    v_dot2_f32_bf16 v45, v103, v27, v45
    v_dot2_f32_bf16 v46, v107, v27, v46
    v_dot2_f32_bf16 v47, v111, v27, v47
    s_waitcnt vmcnt(7)
    s_cbranch_vccnz L_t206
    s_waitcnt vmcnt(6)
L_t206:
    buffer_load_dwordx4 v[96:99], v128, s[32:35], s52 offen nt
    s_waitcnt vmcnt(7)
    s_cbranch_vccnz L_t207
    s_waitcnt vmcnt(5)
L_t207:
    buffer_load_dwordx4 v[100:103], v129, s[32:35], s52 offen nt
    v_dot2_f32_bf16 v48, v112, v24, 0
    v_dot2_f32_bf16 v49, v116, v24, 0
    v_dot2_f32_bf16 v50, v120, v24, 0
    v_dot2_f32_bf16 v51, v124, v24, 0
    v_dot2_f32_bf16 v48, v113, v25, v48
    v_dot2_f32_bf16 v49, v117, v25, v49
    v_dot2_f32_bf16 v50, v121, v25, v50
    v_dot2_f32_bf16 v51, v125, v25, v51
    v_dot2_f32_bf16 v48, v114, v26, v48
    v_dot2_f32_bf16 v49, v118, v26, v49
    v_dot2_f32_bf16 v50, v122, v26, v50
    v_dot2_f32_bf16 v51, v126, v26, v51
    v_dot2_f32_bf16 v48, v115, v27, v48
    v_dot2_f32_bf16 v49, v119, v27, v49
    v_dot2_f32_bf16 v50, v123, v27, v50
    v_dot2_f32_bf16 v51, v127, v27, v51
    s_waitcnt vmcnt(6)
    s_cbranch_vccnz L_t208
    s_waitcnt vmcnt(5)
L_t208:
    buffer_load_dwordx4 v[104:107], v130, s[32:35], s52 offen nt
    s_waitcnt vmcnt(6)
    s_cbranch_vccnz L_t209
    s_waitcnt vmcnt(5)
L_t209:
    buffer_load_dwordx4 v[108:111], v131, s[32:35], s52 offen nt
    buffer_load_dwordx4 a[112:115], v3, s[36:39], s58 offen offset:1024
    s_cmp_eq_u32 s71, 5
    s_cselect_b32 s63, 0xffff7400, s73
    s_add_u32 s58, s58, s63
    v_add_f32_dpp v44, v44, v44 row_ror:8 row_mask:0xf bank_mask:0x3
    v_add_f32_dpp v48, v48, v48 row_ror:8 row_mask:0xf bank_mask:0x3
    v_add_f32_dpp v45, v45, v45 row_ror:8 row_mask:0xf bank_mask:0x3
    v_add_f32_dpp v49, v49, v49 row_ror:8 row_mask:0xf bank_mask:0x3
    v_add_f32_dpp v44, v46, v46 row_ror:8 row_mask:0xf bank_mask:0xc
    v_add_f32_dpp v48, v50, v50 row_ror:8 row_mask:0xf bank_mask:0xc
    v_add_f32_dpp v45, v47, v47 row_ror:8 row_mask:0xf bank_mask:0xc
    v_add_f32_dpp v49, v51, v51 row_ror:8 row_mask:0xf bank_mask:0xc
    v_add_f32_dpp v44, v44, v44 row_half_mirror row_mask:0xf bank_mask:0x5
    v_add_f32_dpp v48, v48, v48 row_half_mirror row_mask:0xf bank_mask:0x5
    s_nop 0
    v_add_f32_dpp v44, v45, v45 row_half_mirror row_mask:0xf bank_mask:0xa
    v_add_f32_dpp v48, v49, v49 row_half_mirror row_mask:0xf bank_mask:0xa
    s_nop 0
    v_add_f32_dpp v44, v44, v44 quad_perm:[1,0,3,2] row_mask:0xf bank_mask:0xf
    v_add_f32_dpp v48, v48, v48 quad_perm:[1,0,3,2] row_mask:0xf bank_mask:0xf
    s_nop 0
    v_add_f32_dpp v44, v44, v44 quad_perm:[2,3,0,1] row_mask:0xf bank_mask:0xf
    v_add_f32_dpp v48, v48, v48 quad_perm:[2,3,0,1] row_mask:0xf bank_mask:0xf
    s_waitcnt vmcnt(7)
    s_cbranch_vccnz L_t210
    s_waitcnt vmcnt(6)
L_t210:
    buffer_load_dwordx4 v[112:115], v132, s[32:35], s52 offen nt
    s_waitcnt vmcnt(7)
    s_cbranch_vccnz L_t211
    s_waitcnt vmcnt(5)
L_t211:
    buffer_load_dwordx4 v[116:119], v133, s[32:35], s52 offen nt
    v_cndmask_b32 v141, v141, v44, s[66:67]
    v_cndmask_b32 v141, v141, v48, s[68:69]
    s_waitcnt vmcnt(6)
    s_cbranch_vccnz L_t212
    s_waitcnt vmcnt(5)
L_t212:
    buffer_load_dwordx4 v[120:123], v134, s[32:35], s52 offen nt
    s_waitcnt vmcnt(6)
    s_cbranch_vccnz L_t213
    s_waitcnt vmcnt(5)
L_t213:
    buffer_load_dwordx4 v[124:127], v135, s[32:35], s52 offen nt
    buffer_load_dwordx4 a[120:123], v3, s[36:39], s58 offen offset:0
    s_add_u32 s51, s51, 0x20000
    s_add_u32 s52, s52, 0x20000
    s_cmp_gt_i32 s75, 0
    s_cselect_b64 vcc, -1, 0
    s_sub_i32 s75, s75, 1
    v_dot2_f32_bf16 v44, v64, v24, 0
    v_dot2_f32_bf16 v45, v68, v24, 0
    v_dot2_f32_bf16 v46, v72, v24, 0
    v_dot2_f32_bf16 v47, v76, v24, 0
    v_dot2_f32_bf16 v44, v65, v25, v44
    v_dot2_f32_bf16 v45, v69, v25, v45
    v_dot2_f32_bf16 v46, v73, v25, v46
    v_dot2_f32_bf16 v47, v77, v25, v47
    v_dot2_f32_bf16 v44, v66, v26, v44
    v_dot2_f32_bf16 v45, v70, v26, v45
    v_dot2_f32_bf16 v46, v74, v26, v46
    v_dot2_f32_bf16 v47, v78, v26, v47
    v_dot2_f32_bf16 v44, v67, v27, v44
    v_dot2_f32_bf16 v45, v71, v27, v45
    v_dot2_f32_bf16 v46, v75, v27, v46
    v_dot2_f32_bf16 v47, v79, v27, v47
    s_waitcnt vmcnt(7)
    s_cbranch_vccnz L_t214
    s_waitcnt vmcnt(6)
L_t214:
    buffer_load_dwordx4 v[64:67], v128, s[32:35], s51 offen nt
    s_waitcnt vmcnt(7)
    s_cbranch_vccnz L_t215
    s_waitcnt vmcnt(5)
L_t215:
    buffer_load_dwordx4 v[68:71], v129, s[32:35], s51 offen nt
    v_dot2_f32_bf16 v48, v80, v24, 0
    v_dot2_f32_bf16 v49, v84, v24, 0
    v_dot2_f32_bf16 v50, v88, v24, 0
    v_dot2_f32_bf16 v51, v92, v24, 0
    v_dot2_f32_bf16 v48, v81, v25, v48
    v_dot2_f32_bf16 v49, v85, v25, v49
    v_dot2_f32_bf16 v50, v89, v25, v50
    v_dot2_f32_bf16 v51, v93, v25, v51
    v_dot2_f32_bf16 v48, v82, v26, v48
    v_dot2_f32_bf16 v49, v86, v26, v49
    v_dot2_f32_bf16 v50, v90, v26, v50
    v_dot2_f32_bf16 v51, v94, v26, v51
    v_dot2_f32_bf16 v48, v83, v27, v48
    v_dot2_f32_bf16 v49, v87, v27, v49
    v_dot2_f32_bf16 v50, v91, v27, v50
    v_dot2_f32_bf16 v51, v95, v27, v51
    s_waitcnt vmcnt(6)
    s_cbranch_vccnz L_t216
    s_waitcnt vmcnt(5)
L_t216:
    buffer_load_dwordx4 v[72:75], v130, s[32:35], s51 offen nt
    s_waitcnt vmcnt(6)
    s_cbranch_vccnz L_t217
    s_waitcnt vmcnt(5)
L_t217:
    buffer_load_dwordx4 v[76:79], v131, s[32:35], s51 offen nt
    buffer_load_dwordx4 a[128:131], v3, s[36:39], s58 offen offset:256
    v_add_f32_dpp v44, v44, v44 row_ror:8 row_mask:0xf bank_mask:0x3
    v_add_f32_dpp v48, v48, v48 row_ror:8 row_mask:0xf bank_mask:0x3
    v_add_f32_dpp v45, v45, v45 row_ror:8 row_mask:0xf bank_mask:0x3
    v_add_f32_dpp v49, v49, v49 row_ror:8 row_mask:0xf bank_mask:0x3
    v_add_f32_dpp v44, v46, v46 row_ror:8 row_mask:0xf bank_mask:0xc
    v_add_f32_dpp v48, v50, v50 row_ror:8 row_mask:0xf bank_mask:0xc
    v_add_f32_dpp v45, v47, v47 row_ror:8 row_mask:0xf bank_mask:0xc
    v_add_f32_dpp v49, v51, v51 row_ror:8 row_mask:0xf bank_mask:0xc
    v_add_f32_dpp v44, v44, v44 row_half_mirror row_mask:0xf bank_mask:0x5
    v_add_f32_dpp v48, v48, v48 row_half_mirror row_mask:0xf bank_mask:0x5
    s_nop 0
    v_add_f32_dpp v44, v45, v45 row_half_mirror row_mask:0xf bank_mask:0xa
    v_add_f32_dpp v48, v49, v49 row_half_mirror row_mask:0xf bank_mask:0xa
    s_nop 0
    v_add_f32_dpp v44, v44, v44 quad_perm:[1,0,3,2] row_mask:0xf bank_mask:0xf
    v_add_f32_dpp v48, v48, v48 quad_perm:[1,0,3,2] row_mask:0xf bank_mask:0xf
    s_nop 0
    v_add_f32_dpp v44, v44, v44 quad_perm:[2,3,0,1] row_mask:0xf bank_mask:0xf
    v_add_f32_dpp v48, v48, v48 quad_perm:[2,3,0,1] row_mask:0xf bank_mask:0xf
    s_waitcnt vmcnt(7)
    s_cbranch_vccnz L_t218
    s_waitcnt vmcnt(6)
L_t218:
    buffer_load_dwordx4 v[80:83], v132, s[32:35], s51 offen nt
    s_waitcnt vmcnt(7)
    s_cbranch_vccnz L_t219
    s_waitcnt vmcnt(5)
L_t219:
    buffer_load_dwordx4 v[84:87], v133, s[32:35], s51 offen nt
    v_cndmask_b32 v142, v44, v48, s[64:65]
    s_waitcnt vmcnt(6)
    s_cbranch_vccnz L_t220
    s_waitcnt vmcnt(5)
L_t220:
    buffer_load_dwordx4 v[88:91], v134, s[32:35], s51 offen nt
    s_waitcnt vmcnt(6)
    s_cbranch_vccnz L_t221
    s_waitcnt vmcnt(5)
L_t221:
    buffer_load_dwordx4 v[92:95], v135, s[32:35], s51 offen nt
    buffer_load_dwordx4 a[136:139], v3, s[36:39], s58 offen offset:512
    v_dot2_f32_bf16 v44, v96, v24, 0
    v_dot2_f32_bf16 v45, v100, v24, 0
    v_dot2_f32_bf16 v46, v104, v24, 0
    v_dot2_f32_bf16 v47, v108, v24, 0
    v_dot2_f32_bf16 v44, v97, v25, v44
    v_dot2_f32_bf16 v45, v101, v25, v45
    v_dot2_f32_bf16 v46, v105, v25, v46
    v_dot2_f32_bf16 v47, v109, v25, v47
    v_dot2_f32_bf16 v44, v98, v26, v44
    v_dot2_f32_bf16 v45, v102, v26, v45
    v_dot2_f32_bf16 v46, v106, v26, v46
    v_dot2_f32_bf16 v47, v110, v26, v47
    v_dot2_f32_bf16 v44, v99, v27, v44
    v_dot2_f32_bf16 v45, v103, v27, v45
    v_dot2_f32_bf16 v46, v107, v27, v46
    v_dot2_f32_bf16 v47, v111, v27, v47
    s_waitcnt vmcnt(7)
    s_cbranch_vccnz L_t222
    s_waitcnt vmcnt(6)
L_t222:
    buffer_load_dwordx4 v[96:99], v128, s[32:35], s52 offen nt
    s_waitcnt vmcnt(7)
    s_cbranch_vccnz L_t223
    s_waitcnt vmcnt(5)
L_t223:
    buffer_load_dwordx4 v[100:103], v129, s[32:35], s52 offen nt
    v_dot2_f32_bf16 v48, v112, v24, 0
    v_dot2_f32_bf16 v49, v116, v24, 0
    v_dot2_f32_bf16 v50, v120, v24, 0
    v_dot2_f32_bf16 v51, v124, v24, 0
    v_dot2_f32_bf16 v48, v113, v25, v48
    v_dot2_f32_bf16 v49, v117, v25, v49
    v_dot2_f32_bf16 v50, v121, v25, v50
    v_dot2_f32_bf16 v51, v125, v25, v51
    v_dot2_f32_bf16 v48, v114, v26, v48
    v_dot2_f32_bf16 v49, v118, v26, v49
    v_dot2_f32_bf16 v50, v122, v26, v50
    v_dot2_f32_bf16 v51, v126, v26, v51
    v_dot2_f32_bf16 v48, v115, v27, v48
    v_dot2_f32_bf16 v49, v119, v27, v49
    v_dot2_f32_bf16 v50, v123, v27, v50
    v_dot2_f32_bf16 v51, v127, v27, v51
    s_waitcnt vmcnt(6)
    s_cbranch_vccnz L_t224
    s_waitcnt vmcnt(5)
L_t224:
    buffer_load_dwordx4 v[104:107], v130, s[32:35], s52 offen nt
    s_waitcnt vmcnt(6)
    s_cbranch_vccnz L_t225
    s_waitcnt vmcnt(5)
L_t225:
    buffer_load_dwordx4 v[108:111], v131, s[32:35], s52 offen nt
    buffer_load_dwordx4 a[144:147], v3, s[36:39], s58 offen offset:768
    v_add_f32_dpp v44, v44, v44 row_ror:8 row_mask:0xf bank_mask:0x3
    v_add_f32_dpp v48, v48, v48 row_ror:8 row_mask:0xf bank_mask:0x3
    v_add_f32_dpp v45, v45, v45 row_ror:8 row_mask:0xf bank_mask:0x3
    v_add_f32_dpp v49, v49, v49 row_ror:8 row_mask:0xf bank_mask:0x3
    v_add_f32_dpp v44, v46, v46 row_ror:8 row_mask:0xf bank_mask:0xc
    v_add_f32_dpp v48, v50, v50 row_ror:8 row_mask:0xf bank_mask:0xc
    v_add_f32_dpp v45, v47, v47 row_ror:8 row_mask:0xf bank_mask:0xc
    v_add_f32_dpp v49, v51, v51 row_ror:8 row_mask:0xf bank_mask:0xc
    v_add_f32_dpp v44, v44, v44 row_half_mirror row_mask:0xf bank_mask:0x5
    v_add_f32_dpp v48, v48, v48 row_half_mirror row_mask:0xf bank_mask:0x5
    s_nop 0
    v_add_f32_dpp v44, v45, v45 row_half_mirror row_mask:0xf bank_mask:0xa
    v_add_f32_dpp v48, v49, v49 row_half_mirror row_mask:0xf bank_mask:0xa
    s_nop 0
    v_add_f32_dpp v44, v44, v44 quad_perm:[1,0,3,2] row_mask:0xf bank_mask:0xf
    v_add_f32_dpp v48, v48, v48 quad_perm:[1,0,3,2] row_mask:0xf bank_mask:0xf
    s_nop 0
    v_add_f32_dpp v44, v44, v44 quad_perm:[2,3,0,1] row_mask:0xf bank_mask:0xf
    v_add_f32_dpp v48, v48, v48 quad_perm:[2,3,0,1] row_mask:0xf bank_mask:0xf
    s_waitcnt vmcnt(7)
    s_cbranch_vccnz L_t226
    s_waitcnt vmcnt(6)
L_t226:
    buffer_load_dwordx4 v[112:115], v132, s[32:35], s52 offen nt
    s_waitcnt vmcnt(7)
    s_cbranch_vccnz L_t227
    s_waitcnt vmcnt(5)
L_t227:
    buffer_load_dwordx4 v[116:119], v133, s[32:35], s52 offen nt
    v_cndmask_b32 v142, v142, v44, s[66:67]
    v_cndmask_b32 v142, v142, v48, s[68:69]
    s_waitcnt vmcnt(6)
    s_cbranch_vccnz L_t228
    s_waitcnt vmcnt(5)
L_t228:
    buffer_load_dwordx4 v[120:123], v134, s[32:35], s52 offen nt
    s_waitcnt vmcnt(6)
    s_cbranch_vccnz L_t229
    s_waitcnt vmcnt(5)
L_t229:
    buffer_load_dwordx4 v[124:127], v135, s[32:35], s52 offen nt
    buffer_load_dwordx4 a[152:155], v3, s[36:39], s58 offen offset:1024
    s_cmp_eq_u32 s71, 4
    s_cselect_b32 s63, 0xffff7400, s73
    s_add_u32 s58, s58, s63
    s_mov_b64 s[32:33], s[18:19]
    s_mov_b32 s51, s53
    s_add_u32 s52, s53, 0x8000
    s_cmp_gt_i32 s75, 0
    s_cselect_b64 vcc, -1, 0
    s_sub_i32 s75, s75, 1
    v_dot2_f32_bf16 v44, v64, v24, 0
    v_dot2_f32_bf16 v45, v68, v24, 0
    v_dot2_f32_bf16 v46, v72, v24, 0
    v_dot2_f32_bf16 v47, v76, v24, 0
    v_dot2_f32_bf16 v44, v65, v25, v44
    v_dot2_f32_bf16 v45, v69, v25, v45
    v_dot2_f32_bf16 v46, v73, v25, v46
    v_dot2_f32_bf16 v47, v77, v25, v47
    v_dot2_f32_bf16 v44, v66, v26, v44
    v_dot2_f32_bf16 v45, v70, v26, v45
    v_dot2_f32_bf16 v46, v74, v26, v46
    v_dot2_f32_bf16 v47, v78, v26, v47
    v_dot2_f32_bf16 v44, v67, v27, v44
    v_dot2_f32_bf16 v45, v71, v27, v45
    v_dot2_f32_bf16 v46, v75, v27, v46
    v_dot2_f32_bf16 v47, v79, v27, v47
    s_waitcnt vmcnt(7)
    s_cbranch_vccnz L_t230
    s_waitcnt vmcnt(6)
L_t230:
    buffer_load_dwordx4 v[64:67], v128, s[32:35], s51 offen nt
    s_waitcnt vmcnt(7)
    s_cbranch_vccnz L_t231
    s_waitcnt vmcnt(5)
L_t231:
    buffer_load_dwordx4 v[68:71], v129, s[32:35], s51 offen nt
    v_dot2_f32_bf16 v48, v80, v24, 0
    v_dot2_f32_bf16 v49, v84, v24, 0
    v_dot2_f32_bf16 v50, v88, v24, 0
    v_dot2_f32_bf16 v51, v92, v24, 0
    v_dot2_f32_bf16 v48, v81, v25, v48
    v_dot2_f32_bf16 v49, v85, v25, v49
    v_dot2_f32_bf16 v50, v89, v25, v50
    v_dot2_f32_bf16 v51, v93, v25, v51
    v_dot2_f32_bf16 v48, v82, v26, v48
    v_dot2_f32_bf16 v49, v86, v26, v49
    v_dot2_f32_bf16 v50, v90, v26, v50
    v_dot2_f32_bf16 v51, v94, v26, v51
    v_dot2_f32_bf16 v48, v83, v27, v48
    v_dot2_f32_bf16 v49, v87, v27, v49
    v_dot2_f32_bf16 v50, v91, v27, v50
    v_dot2_f32_bf16 v51, v95, v27, v51
    s_waitcnt vmcnt(6)
    s_cbranch_vccnz L_t232
    s_waitcnt vmcnt(5)
L_t232:
    buffer_load_dwordx4 v[72:75], v130, s[32:35], s51 offen nt
    s_waitcnt vmcnt(6)
    s_cbranch_vccnz L_t233
    s_waitcnt vmcnt(5)
L_t233:
    buffer_load_dwordx4 v[76:79], v131, s[32:35], s51 offen nt
    buffer_load_dwordx4 a[4:7], v3, s[36:39], s58 offen offset:0
    v_add_f32_dpp v44, v44, v44 row_ror:8 row_mask:0xf bank_mask:0x3
    v_add_f32_dpp v48, v48, v48 row_ror:8 row_mask:0xf bank_mask:0x3
    v_add_f32_dpp v45, v45, v45 row_ror:8 row_mask:0xf bank_mask:0x3
    v_add_f32_dpp v49, v49, v49 row_ror:8 row_mask:0xf bank_mask:0x3
    v_add_f32_dpp v44, v46, v46 row_ror:8 row_mask:0xf bank_mask:0xc
    v_add_f32_dpp v48, v50, v50 row_ror:8 row_mask:0xf bank_mask:0xc
    v_add_f32_dpp v45, v47, v47 row_ror:8 row_mask:0xf bank_mask:0xc
    v_add_f32_dpp v49, v51, v51 row_ror:8 row_mask:0xf bank_mask:0xc
    v_add_f32_dpp v44, v44, v44 row_half_mirror row_mask:0xf bank_mask:0x5
    v_add_f32_dpp v48, v48, v48 row_half_mirror row_mask:0xf bank_mask:0x5
    s_nop 0
    v_add_f32_dpp v44, v45, v45 row_half_mirror row_mask:0xf bank_mask:0xa
    v_add_f32_dpp v48, v49, v49 row_half_mirror row_mask:0xf bank_mask:0xa
    s_nop 0
    v_add_f32_dpp v44, v44, v44 quad_perm:[1,0,3,2] row_mask:0xf bank_mask:0xf
    v_add_f32_dpp v48, v48, v48 quad_perm:[1,0,3,2] row_mask:0xf bank_mask:0xf
    s_nop 0
    v_add_f32_dpp v44, v44, v44 quad_perm:[2,3,0,1] row_mask:0xf bank_mask:0xf
    v_add_f32_dpp v48, v48, v48 quad_perm:[2,3,0,1] row_mask:0xf bank_mask:0xf
    s_waitcnt vmcnt(7)
    s_cbranch_vccnz L_t234
    s_waitcnt vmcnt(6)
L_t234:
    buffer_load_dwordx4 v[80:83], v132, s[32:35], s51 offen nt
    v_cndmask_b32 v143, v44, v48, s[64:65]
    v_dot2_f32_bf16 v44, v96, v24, 0
    v_dot2_f32_bf16 v45, v100, v24, 0
    v_dot2_f32_bf16 v46, v104, v24, 0
    v_dot2_f32_bf16 v47, v108, v24, 0
    v_dot2_f32_bf16 v44, v97, v25, v44
    v_dot2_f32_bf16 v45, v101, v25, v45
    v_dot2_f32_bf16 v46, v105, v25, v46
    v_dot2_f32_bf16 v47, v109, v25, v47
    v_dot2_f32_bf16 v44, v98, v26, v44
    v_dot2_f32_bf16 v45, v102, v26, v45
    v_dot2_f32_bf16 v46, v106, v26, v46
    v_dot2_f32_bf16 v47, v110, v26, v47
    v_dot2_f32_bf16 v44, v99, v27, v44
    v_dot2_f32_bf16 v45, v103, v27, v45
    v_dot2_f32_bf16 v46, v107, v27, v46
    v_dot2_f32_bf16 v47, v111, v27, v47
    s_waitcnt vmcnt(7)
    s_cbranch_vccnz L_t235
    s_waitcnt vmcnt(5)
L_t235:
    buffer_load_dwordx4 v[84:87], v133, s[32:35], s51 offen nt
    s_waitcnt vmcnt(6)
    s_cbranch_vccnz L_t236
    s_waitcnt vmcnt(5)
L_t236:
    buffer_load_dwordx4 v[88:91], v134, s[32:35], s51 offen nt
    v_dot2_f32_bf16 v48, v112, v24, 0
    v_dot2_f32_bf16 v49, v116, v24, 0
    v_dot2_f32_bf16 v50, v120, v24, 0
    v_dot2_f32_bf16 v51, v124, v24, 0
    v_dot2_f32_bf16 v48, v113, v25, v48
    v_dot2_f32_bf16 v49, v117, v25, v49
    v_dot2_f32_bf16 v50, v121, v25, v50
    v_dot2_f32_bf16 v51, v125, v25, v51
    v_dot2_f32_bf16 v48, v114, v26, v48
    v_dot2_f32_bf16 v49, v118, v26, v49
    v_dot2_f32_bf16 v50, v122, v26, v50
    v_dot2_f32_bf16 v51, v126, v26, v51
    v_dot2_f32_bf16 v48, v115, v27, v48
    v_dot2_f32_bf16 v49, v119, v27, v49
    v_dot2_f32_bf16 v50, v123, v27, v50
    v_dot2_f32_bf16 v51, v127, v27, v51
    s_waitcnt vmcnt(6)
    s_cbranch_vccnz L_t237
    s_waitcnt vmcnt(5)
L_t237:
    buffer_load_dwordx4 v[92:95], v135, s[32:35], s51 offen nt
    buffer_load_dwordx4 a[12:15], v3, s[36:39], s58 offen offset:256
    s_waitcnt vmcnt(7)
    s_cbranch_vccnz L_t238
    s_waitcnt vmcnt(6)
L_t238:
    buffer_load_dwordx4 v[96:99], v128, s[32:35], s52 offen nt
    v_add_f32_dpp v44, v44, v44 row_ror:8 row_mask:0xf bank_mask:0x3
    v_add_f32_dpp v48, v48, v48 row_ror:8 row_mask:0xf bank_mask:0x3
    v_add_f32_dpp v45, v45, v45 row_ror:8 row_mask:0xf bank_mask:0x3
    v_add_f32_dpp v49, v49, v49 row_ror:8 row_mask:0xf bank_mask:0x3
    v_add_f32_dpp v44, v46, v46 row_ror:8 row_mask:0xf bank_mask:0xc
    v_add_f32_dpp v48, v50, v50 row_ror:8 row_mask:0xf bank_mask:0xc
    v_add_f32_dpp v45, v47, v47 row_ror:8 row_mask:0xf bank_mask:0xc
    v_add_f32_dpp v49, v51, v51 row_ror:8 row_mask:0xf bank_mask:0xc
    v_add_f32_dpp v44, v44, v44 row_half_mirror row_mask:0xf bank_mask:0x5
    v_add_f32_dpp v48, v48, v48 row_half_mirror row_mask:0xf bank_mask:0x5
    s_nop 0
    v_add_f32_dpp v44, v45, v45 row_half_mirror row_mask:0xf bank_mask:0xa
    v_add_f32_dpp v48, v49, v49 row_half_mirror row_mask:0xf bank_mask:0xa
    s_nop 0
    v_add_f32_dpp v44, v44, v44 quad_perm:[1,0,3,2] row_mask:0xf bank_mask:0xf
    v_add_f32_dpp v48, v48, v48 quad_perm:[1,0,3,2] row_mask:0xf bank_mask:0xf
    s_nop 0
    v_add_f32_dpp v44, v44, v44 quad_perm:[2,3,0,1] row_mask:0xf bank_mask:0xf
    v_add_f32_dpp v48, v48, v48 quad_perm:[2,3,0,1] row_mask:0xf bank_mask:0xf
    s_waitcnt vmcnt(7)
    s_cbranch_vccnz L_t239
    s_waitcnt vmcnt(5)
L_t239:
    buffer_load_dwordx4 v[100:103], v129, s[32:35], s52 offen nt
    v_cndmask_b32 v143, v143, v44, s[66:67]
    v_cndmask_b32 v143, v143, v48, s[68:69]
    v_cvt_pk_bf16_f32 v136, v136, v136
    v_cvt_pk_bf16_f32 v137, v137, v137
    v_cvt_pk_bf16_f32 v138, v138, v138
    v_cvt_pk_bf16_f32 v139, v139, v139
    v_cvt_pk_bf16_f32 v140, v140, v140
    v_cvt_pk_bf16_f32 v141, v141, v141
    v_cvt_pk_bf16_f32 v142, v142, v142
    v_cvt_pk_bf16_f32 v143, v143, v143
    v_and_b32 v136, 0xffff0000, v136
    v_and_b32 v137, 0xffff0000, v137
    v_and_b32 v138, 0xffff0000, v138
    v_and_b32 v139, 0xffff0000, v139
    v_and_b32 v140, 0xffff0000, v140
    v_and_b32 v141, 0xffff0000, v141
    v_and_b32 v142, 0xffff0000, v142
    v_and_b32 v143, 0xffff0000, v143
    v_mul_f32 v136, 0x3db504f3, v136
    v_mul_f32 v137, 0x3db504f3, v137
    v_mul_f32 v138, 0x3db504f3, v138
    v_mul_f32 v139, 0x3db504f3, v139
    v_mul_f32 v140, 0x3db504f3, v140
    v_mul_f32 v141, 0x3db504f3, v141
    v_mul_f32 v142, 0x3db504f3, v142
    v_mul_f32 v143, 0x3db504f3, v143
    s_waitcnt vmcnt(6)
    s_cbranch_vccnz L_t240
    s_waitcnt vmcnt(5)
L_t240:
    buffer_load_dwordx4 v[104:107], v130, s[32:35], s52 offen nt
    v_cvt_pk_bf16_f32 v136, v136, v136
    v_cvt_pk_bf16_f32 v137, v137, v137
    v_cvt_pk_bf16_f32 v138, v138, v138
    v_cvt_pk_bf16_f32 v139, v139, v139
    v_cvt_pk_bf16_f32 v140, v140, v140
    v_cvt_pk_bf16_f32 v141, v141, v141
    v_cvt_pk_bf16_f32 v142, v142, v142
    v_cvt_pk_bf16_f32 v143, v143, v143
    v_and_b32 v136, 0xffff0000, v136
    v_and_b32 v137, 0xffff0000, v137
    v_and_b32 v138, 0xffff0000, v138
    v_and_b32 v139, 0xffff0000, v139
    v_and_b32 v140, 0xffff0000, v140
    v_and_b32 v141, 0xffff0000, v141
    v_and_b32 v142, 0xffff0000, v142
    v_and_b32 v143, 0xffff0000, v143
    v_max3_f32 v54, v136, v137, v138
    v_max3_f32 v55, v139, v140, v141
    v_max3_f32 v54, v54, v142, v143
    v_max_f32 v54, v54, v55
    s_nop 1
    v_max_f32_dpp v54, v54, v54 row_ror:8 row_mask:0xf bank_mask:0xf
    s_nop 1
    v_max_f32_dpp v54, v54, v54 row_ror:4 row_mask:0xf bank_mask:0xf
    s_nop 1
    v_max_f32_dpp v54, v54, v54 row_ror:2 row_mask:0xf bank_mask:0xf
    s_nop 1
    v_max_f32_dpp v54, v54, v54 row_ror:1 row_mask:0xf bank_mask:0xf
    s_nop 1
    v_max_f32_dpp v54, v54, v54 row_bcast:15 row_mask:0xa bank_mask:0xf
    s_nop 1
    v_max_f32_dpp v54, v54, v54 row_bcast:31 row_mask:0xc bank_mask:0xf
    s_nop 0
    v_readlane_b32 s56, v54, 63
    s_waitcnt vmcnt(6)
    s_cbranch_vccnz L_t241
    s_waitcnt vmcnt(5)
L_t241:
    buffer_load_dwordx4 v[108:111], v131, s[32:35], s52 offen nt
    buffer_load_dwordx4 a[20:23], v3, s[36:39], s58 offen offset:512
    v_subrev_f32 v136, s56, v136
    v_subrev_f32 v137, s56, v137
    v_subrev_f32 v138, s56, v138
    v_subrev_f32 v139, s56, v139
    v_subrev_f32 v140, s56, v140
    v_subrev_f32 v141, s56, v141
    v_subrev_f32 v142, s56, v142
    v_subrev_f32 v143, s56, v143
    v_mul_f32 v136, 0x3fb8aa3b, v136
    v_mul_f32 v137, 0x3fb8aa3b, v137
    v_mul_f32 v138, 0x3fb8aa3b, v138
    v_mul_f32 v139, 0x3fb8aa3b, v139
    v_mul_f32 v140, 0x3fb8aa3b, v140
    v_mul_f32 v141, 0x3fb8aa3b, v141
    v_mul_f32 v142, 0x3fb8aa3b, v142
    v_mul_f32 v143, 0x3fb8aa3b, v143
    v_exp_f32 v136, v136
    v_exp_f32 v137, v137
    v_exp_f32 v138, v138
    v_exp_f32 v139, v139
    v_exp_f32 v140, v140
    v_exp_f32 v141, v141
    v_exp_f32 v142, v142
    v_exp_f32 v143, v143
    s_waitcnt vmcnt(7)
    s_cbranch_vccnz L_t242
    s_waitcnt vmcnt(6)
L_t242:
    buffer_load_dwordx4 v[112:115], v132, s[32:35], s52 offen nt
    v_mov_b32 v52, s56
    v_add_f32 v53, v136, v137
    v_add_f32 v54, v138, v139
    v_add_f32 v55, v140, v141
    v_add_f32 v62, v142, v143
    v_add_f32 v53, v53, v54
    v_add_f32 v55, v55, v62
    v_add_f32 v53, v53, v55
    s_nop 1
    v_add_f32_dpp v53, v53, v53 row_ror:8 row_mask:0xf bank_mask:0xf
    s_nop 1
    v_add_f32_dpp v53, v53, v53 row_ror:4 row_mask:0xf bank_mask:0xf
    s_nop 1
    v_add_f32_dpp v53, v53, v53 row_ror:2 row_mask:0xf bank_mask:0xf
    s_nop 1
    v_add_f32_dpp v53, v53, v53 row_ror:1 row_mask:0xf bank_mask:0xf
    s_nop 1
    v_add_f32_dpp v53, v53, v53 row_bcast:15 row_mask:0xa bank_mask:0xf
    s_nop 1
    v_add_f32_dpp v53, v53, v53 row_bcast:31 row_mask:0xc bank_mask:0xf
    s_lshl_b32 s54, s3, 3
    v_mov_b32 v62, s54
    s_mov_b32 exec_lo, 0
    s_mov_b32 exec_hi, 0x80000000
    ds_write_b64 v62, v[52:53] offset:4352
    s_mov_b64 exec, -1
    s_waitcnt vmcnt(7)
    s_cbranch_vccnz L_t243
    s_waitcnt vmcnt(5)
L_t243:
    buffer_load_dwordx4 v[116:119], v133, s[32:35], s52 offen nt
    s_waitcnt lgkmcnt(0)
    s_barrier
    ds_read_b64 v[44:45], v13 offset:4352
    s_waitcnt lgkmcnt(0)
    v_max_f32_dpp v226, v44, v44 quad_perm:[1,0,3,2] row_mask:0xf bank_mask:0xf
    s_nop 1
    v_max_f32_dpp v226, v226, v226 quad_perm:[2,3,0,1] row_mask:0xf bank_mask:0xf
    v_sub_f32 v44, v44, v226
    v_sub_f32 v52, v52, v226
    v_mul_f32 v44, 0x3fb8aa3b, v44
    v_mul_f32 v52, 0x3fb8aa3b, v52
    v_exp_f32 v44, v44
    v_exp_f32 v52, v52
    v_mul_f32 v227, v45, v44
    s_nop 1
    v_add_f32_dpp v227, v227, v227 quad_perm:[1,0,3,2] row_mask:0xf bank_mask:0xf
    s_nop 1
    v_add_f32_dpp v227, v227, v227 quad_perm:[2,3,0,1] row_mask:0xf bank_mask:0xf
    v_rcp_f32 v55, v227
    s_nop 0
    v_mul_f32 v55, v55, v52
    s_waitcnt vmcnt(6)
    s_cbranch_vccnz L_t244
    s_waitcnt vmcnt(5)
L_t244:
    buffer_load_dwordx4 v[120:123], v134, s[32:35], s52 offen nt
    v_mul_f32 v136, v136, v55
    v_mul_f32 v137, v137, v55
    v_mul_f32 v138, v138, v55
    v_mul_f32 v139, v139, v55
    v_mul_f32 v140, v140, v55
    v_mul_f32 v141, v141, v55
    v_mul_f32 v142, v142, v55
    v_mul_f32 v143, v143, v55
    v_cvt_pk_bf16_f32 v136, v136, v136
    v_cvt_pk_bf16_f32 v137, v137, v137
    v_cvt_pk_bf16_f32 v138, v138, v138
    v_cvt_pk_bf16_f32 v139, v139, v139
    v_cvt_pk_bf16_f32 v140, v140, v140
    v_cvt_pk_bf16_f32 v141, v141, v141
    v_cvt_pk_bf16_f32 v142, v142, v142
    v_cvt_pk_bf16_f32 v143, v143, v143
    v_readfirstlane_b32 s30, v226
    v_readfirstlane_b32 s31, v227
    s_bitcmp1_b32 s70, 2
    s_cselect_b32 s54, 1, 0
    s_and_b32 s30, s30, -2
    s_or_b32 s30, s30, s54
    s_bitcmp1_b32 s70, 3
    s_cselect_b32 s54, 1, 0
    s_and_b32 s31, s31, -2
    s_or_b32 s31, s31, s54
    s_cmp_lg_u32 s3, 0
    s_cbranch_scc1 L_t245
    s_atomic_swap_x2 s[30:31], s[96:97], 0x18
L_t245:
    s_waitcnt vmcnt(6)
    s_cbranch_vccnz L_t246
    s_waitcnt vmcnt(5)
L_t246:
    buffer_load_dwordx4 v[124:127], v135, s[32:35], s52 offen nt
    buffer_load_dwordx4 a[28:31], v3, s[36:39], s58 offen offset:768
    s_add_u32 s51, s51, 0x20000
    s_add_u32 s52, s52, 0x20000
    s_cmp_lg_u32 s3, 0
    s_cbranch_scc1 L_t247
    s_atomic_xor s98, s[96:97], 0x8
L_t247:
    s_mov_b32 s55, 1310728
    buffer_load_dword v236, v230, s[40:43], s55 offen sc1
    s_cmp_gt_i32 s75, 0
    s_cselect_b64 vcc, -1, 0
    s_sub_i32 s75, s75, 1
    v_and_b32_dpp v28, v136, v16 row_newbcast:0 row_mask:0xf bank_mask:0xf
    v_and_b32_dpp v29, v136, v17 row_newbcast:0 row_mask:0xf bank_mask:0xf
    v_and_b32_dpp v30, v136, v18 row_newbcast:0 row_mask:0xf bank_mask:0xf
    v_and_b32_dpp v31, v136, v19 row_newbcast:0 row_mask:0xf bank_mask:0xf
    v_and_b32_dpp v32, v136, v16 row_newbcast:4 row_mask:0xf bank_mask:0xf
    v_and_b32_dpp v33, v136, v17 row_newbcast:4 row_mask:0xf bank_mask:0xf
    v_and_b32_dpp v34, v136, v18 row_newbcast:4 row_mask:0xf bank_mask:0xf
    v_and_b32_dpp v35, v136, v19 row_newbcast:4 row_mask:0xf bank_mask:0xf
    v_mfma_f32_16x16x32_bf16 v[36:39], v[28:31], v[64:67], 0
    s_waitcnt vmcnt(8)
    s_cbranch_vccnz L_t248
    s_waitcnt vmcnt(7)
L_t248:
    buffer_load_dwordx4 v[64:67], v128, s[32:35], s51 offen nt
    v_and_b32_dpp v28, v136, v16 row_newbcast:8 row_mask:0xf bank_mask:0xf
    v_and_b32_dpp v29, v136, v17 row_newbcast:8 row_mask:0xf bank_mask:0xf
    v_and_b32_dpp v30, v136, v18 row_newbcast:8 row_mask:0xf bank_mask:0xf
    v_and_b32_dpp v31, v136, v19 row_newbcast:8 row_mask:0xf bank_mask:0xf
    v_mfma_f32_16x16x32_bf16 v[36:39], v[32:35], v[68:71], v[36:39]
    s_waitcnt vmcnt(8)
    s_cbranch_vccnz L_t249
    s_waitcnt vmcnt(6)
L_t249:
    buffer_load_dwordx4 v[68:71], v129, s[32:35], s51 offen nt
    v_and_b32_dpp v32, v136, v16 row_newbcast:12 row_mask:0xf bank_mask:0xf
    v_and_b32_dpp v33, v136, v17 row_newbcast:12 row_mask:0xf bank_mask:0xf
    v_and_b32_dpp v34, v136, v18 row_newbcast:12 row_mask:0xf bank_mask:0xf
    v_and_b32_dpp v35, v136, v19 row_newbcast:12 row_mask:0xf bank_mask:0xf
    v_mfma_f32_16x16x32_bf16 v[36:39], v[28:31], v[72:75], v[36:39]
    s_waitcnt vmcnt(7)
    s_cbranch_vccnz L_t250
    s_waitcnt vmcnt(6)
L_t250:
    buffer_load_dwordx4 v[72:75], v130, s[32:35], s51 offen nt
    v_and_b32_dpp v28, v136, v16 row_newbcast:1 row_mask:0xf bank_mask:0xf
    v_and_b32_dpp v29, v136, v17 row_newbcast:1 row_mask:0xf bank_mask:0xf
    v_and_b32_dpp v30, v136, v18 row_newbcast:1 row_mask:0xf bank_mask:0xf
    v_and_b32_dpp v31, v136, v19 row_newbcast:1 row_mask:0xf bank_mask:0xf
    v_mfma_f32_16x16x32_bf16 v[36:39], v[32:35], v[76:79], v[36:39]
    s_waitcnt vmcnt(7)
    s_cbranch_vccnz L_t251
    s_waitcnt vmcnt(6)
L_t251:
    buffer_load_dwordx4 v[76:79], v131, s[32:35], s51 offen nt
    buffer_load_dwordx4 a[36:39], v3, s[36:39], s58 offen offset:1024
    s_cmp_eq_u32 s71, 3
    s_cselect_b32 s63, 0xffff7400, s73
    s_add_u32 s58, s58, s63
    v_and_b32_dpp v32, v136, v16 row_newbcast:5 row_mask:0xf bank_mask:0xf
    v_and_b32_dpp v33, v136, v17 row_newbcast:5 row_mask:0xf bank_mask:0xf
    v_and_b32_dpp v34, v136, v18 row_newbcast:5 row_mask:0xf bank_mask:0xf
    v_and_b32_dpp v35, v136, v19 row_newbcast:5 row_mask:0xf bank_mask:0xf
    v_mfma_f32_16x16x32_bf16 v[36:39], v[28:31], v[80:83], v[36:39]
    s_waitcnt vmcnt(8)
    s_cbranch_vccnz L_t252
    s_waitcnt vmcnt(7)
L_t252:
    buffer_load_dwordx4 v[80:83], v132, s[32:35], s51 offen nt
    v_and_b32_dpp v28, v136, v16 row_newbcast:9 row_mask:0xf bank_mask:0xf
    v_and_b32_dpp v29, v136, v17 row_newbcast:9 row_mask:0xf bank_mask:0xf
    v_and_b32_dpp v30, v136, v18 row_newbcast:9 row_mask:0xf bank_mask:0xf
    v_and_b32_dpp v31, v136, v19 row_newbcast:9 row_mask:0xf bank_mask:0xf
    v_mfma_f32_16x16x32_bf16 v[36:39], v[32:35], v[84:87], v[36:39]
    s_waitcnt vmcnt(8)
    s_cbranch_vccnz L_t253
    s_waitcnt vmcnt(5)
L_t253:
    buffer_load_dwordx4 v[84:87], v133, s[32:35], s51 offen nt
    v_and_b32_dpp v32, v136, v16 row_newbcast:13 row_mask:0xf bank_mask:0xf
    v_and_b32_dpp v33, v136, v17 row_newbcast:13 row_mask:0xf bank_mask:0xf
    v_and_b32_dpp v34, v136, v18 row_newbcast:13 row_mask:0xf bank_mask:0xf
    v_and_b32_dpp v35, v136, v19 row_newbcast:13 row_mask:0xf bank_mask:0xf
    v_mfma_f32_16x16x32_bf16 v[36:39], v[28:31], v[88:91], v[36:39]
    s_waitcnt vmcnt(6)
    s_cbranch_vccnz L_t254
    s_waitcnt vmcnt(5)
L_t254:
    buffer_load_dwordx4 v[88:91], v134, s[32:35], s51 offen nt
    v_and_b32_dpp v28, v136, v16 row_newbcast:2 row_mask:0xf bank_mask:0xf
    v_and_b32_dpp v29, v136, v17 row_newbcast:2 row_mask:0xf bank_mask:0xf
    v_and_b32_dpp v30, v136, v18 row_newbcast:2 row_mask:0xf bank_mask:0xf
    v_and_b32_dpp v31, v136, v19 row_newbcast:2 row_mask:0xf bank_mask:0xf
    v_mfma_f32_16x16x32_bf16 v[36:39], v[32:35], v[92:95], v[36:39]
    s_waitcnt vmcnt(6)
    s_cbranch_vccnz L_t255
    s_waitcnt vmcnt(5)
L_t255:
    buffer_load_dwordx4 v[92:95], v135, s[32:35], s51 offen nt
    buffer_load_dwordx4 a[44:47], v3, s[36:39], s58 offen offset:0
    v_and_b32_dpp v32, v136, v16 row_newbcast:6 row_mask:0xf bank_mask:0xf
    v_and_b32_dpp v33, v136, v17 row_newbcast:6 row_mask:0xf bank_mask:0xf
    v_and_b32_dpp v34, v136, v18 row_newbcast:6 row_mask:0xf bank_mask:0xf
    v_and_b32_dpp v35, v136, v19 row_newbcast:6 row_mask:0xf bank_mask:0xf
    v_mfma_f32_16x16x32_bf16 v[36:39], v[28:31], v[96:99], v[36:39]
    s_waitcnt vmcnt(7)
    s_cbranch_vccnz L_t256
    s_waitcnt vmcnt(6)
L_t256:
    buffer_load_dwordx4 v[96:99], v128, s[32:35], s52 offen nt
    v_and_b32_dpp v28, v136, v16 row_newbcast:10 row_mask:0xf bank_mask:0xf
    v_and_b32_dpp v29, v136, v17 row_newbcast:10 row_mask:0xf bank_mask:0xf
    v_and_b32_dpp v30, v136, v18 row_newbcast:10 row_mask:0xf bank_mask:0xf
    v_and_b32_dpp v31, v136, v19 row_newbcast:10 row_mask:0xf bank_mask:0xf
    v_mfma_f32_16x16x32_bf16 v[36:39], v[32:35], v[100:103], v[36:39]
    s_waitcnt vmcnt(7)
    s_cbranch_vccnz L_t257
    s_waitcnt vmcnt(5)
L_t257:
    buffer_load_dwordx4 v[100:103], v129, s[32:35], s52 offen nt
    v_xor_b32 v236, v236, v234
    v_and_b32 v236, 1, v236
    v_cmp_eq_u32 s[54:55], 1, v236
    s_nop 0
    s_and_b32 s54, s54, -2
    s_bcnt1_i32_b32 s54, s54
    s_mul_i32 s54, s54, 109
    s_sub_i32 s54, s54, 294
    s_ashr_i32 s54, s54, 6
    v_mov_b32 v231, s54
    v_mov_b32 v236, 4400
    s_cmp_lg_u32 s3, 0
    s_cbranch_scc1 L_t258
    ds_write_b32 v236, v231
L_t258:
    v_and_b32_dpp v32, v136, v16 row_newbcast:14 row_mask:0xf bank_mask:0xf
    v_and_b32_dpp v33, v136, v17 row_newbcast:14 row_mask:0xf bank_mask:0xf
    v_and_b32_dpp v34, v136, v18 row_newbcast:14 row_mask:0xf bank_mask:0xf
    v_and_b32_dpp v35, v136, v19 row_newbcast:14 row_mask:0xf bank_mask:0xf
    v_mfma_f32_16x16x32_bf16 v[36:39], v[28:31], v[104:107], v[36:39]
    s_waitcnt vmcnt(6)
    s_cbranch_vccnz L_t259
    s_waitcnt vmcnt(5)
L_t259:
    buffer_load_dwordx4 v[104:107], v130, s[32:35], s52 offen nt
    v_and_b32_dpp v28, v136, v16 row_newbcast:3 row_mask:0xf bank_mask:0xf
    v_and_b32_dpp v29, v136, v17 row_newbcast:3 row_mask:0xf bank_mask:0xf
    v_and_b32_dpp v30, v136, v18 row_newbcast:3 row_mask:0xf bank_mask:0xf
    v_and_b32_dpp v31, v136, v19 row_newbcast:3 row_mask:0xf bank_mask:0xf
    v_mfma_f32_16x16x32_bf16 v[36:39], v[32:35], v[108:111], v[36:39]
    s_waitcnt vmcnt(6)
    s_cbranch_vccnz L_t260
    s_waitcnt vmcnt(5)
L_t260:
    buffer_load_dwordx4 v[108:111], v131, s[32:35], s52 offen nt
    buffer_load_dwordx4 a[52:55], v3, s[36:39], s58 offen offset:256
    v_and_b32_dpp v32, v136, v16 row_newbcast:7 row_mask:0xf bank_mask:0xf
    v_and_b32_dpp v33, v136, v17 row_newbcast:7 row_mask:0xf bank_mask:0xf
    v_and_b32_dpp v34, v136, v18 row_newbcast:7 row_mask:0xf bank_mask:0xf
    v_and_b32_dpp v35, v136, v19 row_newbcast:7 row_mask:0xf bank_mask:0xf
    v_mfma_f32_16x16x32_bf16 v[36:39], v[28:31], v[112:115], v[36:39]
    s_waitcnt vmcnt(7)
    s_cbranch_vccnz L_t261
    s_waitcnt vmcnt(6)
L_t261:
    buffer_load_dwordx4 v[112:115], v132, s[32:35], s52 offen nt
    v_and_b32_dpp v28, v136, v16 row_newbcast:11 row_mask:0xf bank_mask:0xf
    v_and_b32_dpp v29, v136, v17 row_newbcast:11 row_mask:0xf bank_mask:0xf
    v_and_b32_dpp v30, v136, v18 row_newbcast:11 row_mask:0xf bank_mask:0xf
    v_and_b32_dpp v31, v136, v19 row_newbcast:11 row_mask:0xf bank_mask:0xf
    v_mfma_f32_16x16x32_bf16 v[36:39], v[32:35], v[116:119], v[36:39]
    s_waitcnt vmcnt(7)
    s_cbranch_vccnz L_t262
    s_waitcnt vmcnt(5)
L_t262:
    buffer_load_dwordx4 v[116:119], v133, s[32:35], s52 offen nt
    v_and_b32_dpp v32, v136, v16 row_newbcast:15 row_mask:0xf bank_mask:0xf
    v_and_b32_dpp v33, v136, v17 row_newbcast:15 row_mask:0xf bank_mask:0xf
    v_and_b32_dpp v34, v136, v18 row_newbcast:15 row_mask:0xf bank_mask:0xf
    v_and_b32_dpp v35, v136, v19 row_newbcast:15 row_mask:0xf bank_mask:0xf
    v_mfma_f32_16x16x32_bf16 v[36:39], v[28:31], v[120:123], v[36:39]
    s_waitcnt vmcnt(6)
    s_cbranch_vccnz L_t263
    s_waitcnt vmcnt(5)
L_t263:
    buffer_load_dwordx4 v[120:123], v134, s[32:35], s52 offen nt
    v_mfma_f32_16x16x32_bf16 v[36:39], v[32:35], v[124:127], v[36:39]
    s_waitcnt vmcnt(6)
    s_cbranch_vccnz L_t264
    s_waitcnt vmcnt(5)
L_t264:
    buffer_load_dwordx4 v[124:127], v135, s[32:35], s52 offen nt
    buffer_load_dwordx4 a[60:63], v3, s[36:39], s58 offen offset:512
    s_add_u32 s51, s51, 0x20000
    s_add_u32 s52, s52, 0x20000
    v_mov_b32 v236, 4400
    ds_read_b32 v231, v236
    s_waitcnt lgkmcnt(0)
    v_readfirstlane_b32 s75, v231
    s_nop 0
    s_cmp_gt_i32 s75, 0
    s_cselect_b64 vcc, -1, 0
    s_sub_i32 s75, s75, 1
    v_and_b32_dpp v28, v137, v16 row_newbcast:0 row_mask:0xf bank_mask:0xf
    v_and_b32_dpp v29, v137, v17 row_newbcast:0 row_mask:0xf bank_mask:0xf
    v_and_b32_dpp v30, v137, v18 row_newbcast:0 row_mask:0xf bank_mask:0xf
    v_and_b32_dpp v31, v137, v19 row_newbcast:0 row_mask:0xf bank_mask:0xf
    v_and_b32_dpp v32, v137, v16 row_newbcast:4 row_mask:0xf bank_mask:0xf
    v_and_b32_dpp v33, v137, v17 row_newbcast:4 row_mask:0xf bank_mask:0xf
    v_and_b32_dpp v34, v137, v18 row_newbcast:4 row_mask:0xf bank_mask:0xf
    v_and_b32_dpp v35, v137, v19 row_newbcast:4 row_mask:0xf bank_mask:0xf
    v_mfma_f32_16x16x32_bf16 v[36:39], v[28:31], v[64:67], v[36:39]
    s_waitcnt vmcnt(7)
    s_cbranch_vccnz L_t265
    s_waitcnt vmcnt(6)
L_t265:
    buffer_load_dwordx4 v[64:67], v128, s[32:35], s51 offen nt
    v_and_b32_dpp v28, v137, v16 row_newbcast:8 row_mask:0xf bank_mask:0xf
    v_and_b32_dpp v29, v137, v17 row_newbcast:8 row_mask:0xf bank_mask:0xf
    v_and_b32_dpp v30, v137, v18 row_newbcast:8 row_mask:0xf bank_mask:0xf
    v_and_b32_dpp v31, v137, v19 row_newbcast:8 row_mask:0xf bank_mask:0xf
    v_mfma_f32_16x16x32_bf16 v[36:39], v[32:35], v[68:71], v[36:39]
    s_waitcnt vmcnt(7)
    s_cbranch_vccnz L_t266
    s_waitcnt vmcnt(5)
L_t266:
    buffer_load_dwordx4 v[68:71], v129, s[32:35], s51 offen nt
    v_and_b32_dpp v32, v137, v16 row_newbcast:12 row_mask:0xf bank_mask:0xf
    v_and_b32_dpp v33, v137, v17 row_newbcast:12 row_mask:0xf bank_mask:0xf
    v_and_b32_dpp v34, v137, v18 row_newbcast:12 row_mask:0xf bank_mask:0xf
    v_and_b32_dpp v35, v137, v19 row_newbcast:12 row_mask:0xf bank_mask:0xf
    v_mfma_f32_16x16x32_bf16 v[36:39], v[28:31], v[72:75], v[36:39]
    s_waitcnt vmcnt(6)
    s_cbranch_vccnz L_t267
    s_waitcnt vmcnt(5)
L_t267:
    buffer_load_dwordx4 v[72:75], v130, s[32:35], s51 offen nt
    v_and_b32_dpp v28, v137, v16 row_newbcast:1 row_mask:0xf bank_mask:0xf
    v_and_b32_dpp v29, v137, v17 row_newbcast:1 row_mask:0xf bank_mask:0xf
    v_and_b32_dpp v30, v137, v18 row_newbcast:1 row_mask:0xf bank_mask:0xf
    v_and_b32_dpp v31, v137, v19 row_newbcast:1 row_mask:0xf bank_mask:0xf
    v_mfma_f32_16x16x32_bf16 v[36:39], v[32:35], v[76:79], v[36:39]
    s_waitcnt vmcnt(6)
    s_cbranch_vccnz L_t268
    s_waitcnt vmcnt(5)
L_t268:
    buffer_load_dwordx4 v[76:79], v131, s[32:35], s51 offen nt
    buffer_load_dwordx4 a[68:71], v3, s[36:39], s58 offen offset:768
    v_and_b32_dpp v32, v137, v16 row_newbcast:5 row_mask:0xf bank_mask:0xf
    v_and_b32_dpp v33, v137, v17 row_newbcast:5 row_mask:0xf bank_mask:0xf
    v_and_b32_dpp v34, v137, v18 row_newbcast:5 row_mask:0xf bank_mask:0xf
    v_and_b32_dpp v35, v137, v19 row_newbcast:5 row_mask:0xf bank_mask:0xf
    v_mfma_f32_16x16x32_bf16 v[36:39], v[28:31], v[80:83], v[36:39]
    s_waitcnt vmcnt(7)
    s_cbranch_vccnz L_t269
    s_waitcnt vmcnt(6)
L_t269:
    buffer_load_dwordx4 v[80:83], v132, s[32:35], s51 offen nt
    v_and_b32_dpp v28, v137, v16 row_newbcast:9 row_mask:0xf bank_mask:0xf
    v_and_b32_dpp v29, v137, v17 row_newbcast:9 row_mask:0xf bank_mask:0xf
    v_and_b32_dpp v30, v137, v18 row_newbcast:9 row_mask:0xf bank_mask:0xf
    v_and_b32_dpp v31, v137, v19 row_newbcast:9 row_mask:0xf bank_mask:0xf
    v_mfma_f32_16x16x32_bf16 v[36:39], v[32:35], v[84:87], v[36:39]
    s_waitcnt vmcnt(7)
    s_cbranch_vccnz L_t270
    s_waitcnt vmcnt(5)
L_t270:
    buffer_load_dwordx4 v[84:87], v133, s[32:35], s51 offen nt
    v_and_b32_dpp v32, v137, v16 row_newbcast:13 row_mask:0xf bank_mask:0xf
    v_and_b32_dpp v33, v137, v17 row_newbcast:13 row_mask:0xf bank_mask:0xf
    v_and_b32_dpp v34, v137, v18 row_newbcast:13 row_mask:0xf bank_mask:0xf
    v_and_b32_dpp v35, v137, v19 row_newbcast:13 row_mask:0xf bank_mask:0xf
    v_mfma_f32_16x16x32_bf16 v[36:39], v[28:31], v[88:91], v[36:39]
    s_waitcnt vmcnt(6)
    s_cbranch_vccnz L_t271
    s_waitcnt vmcnt(5)
L_t271:
    buffer_load_dwordx4 v[88:91], v134, s[32:35], s51 offen nt
    v_and_b32_dpp v28, v137, v16 row_newbcast:2 row_mask:0xf bank_mask:0xf
    v_and_b32_dpp v29, v137, v17 row_newbcast:2 row_mask:0xf bank_mask:0xf
    v_and_b32_dpp v30, v137, v18 row_newbcast:2 row_mask:0xf bank_mask:0xf
    v_and_b32_dpp v31, v137, v19 row_newbcast:2 row_mask:0xf bank_mask:0xf
    v_mfma_f32_16x16x32_bf16 v[36:39], v[32:35], v[92:95], v[36:39]
    s_waitcnt vmcnt(6)
    s_cbranch_vccnz L_t272
    s_waitcnt vmcnt(5)
L_t272:
    buffer_load_dwordx4 v[92:95], v135, s[32:35], s51 offen nt
    buffer_load_dwordx4 a[76:79], v3, s[36:39], s58 offen offset:1024
    s_cmp_eq_u32 s71, 2
    s_cselect_b32 s63, 0xffff7400, s73
    s_add_u32 s58, s58, s63
    v_and_b32_dpp v32, v137, v16 row_newbcast:6 row_mask:0xf bank_mask:0xf
    v_and_b32_dpp v33, v137, v17 row_newbcast:6 row_mask:0xf bank_mask:0xf
    v_and_b32_dpp v34, v137, v18 row_newbcast:6 row_mask:0xf bank_mask:0xf
    v_and_b32_dpp v35, v137, v19 row_newbcast:6 row_mask:0xf bank_mask:0xf
    v_mfma_f32_16x16x32_bf16 v[36:39], v[28:31], v[96:99], v[36:39]
    s_waitcnt vmcnt(7)
    s_cbranch_vccnz L_t273
    s_waitcnt vmcnt(6)
L_t273:
    buffer_load_dwordx4 v[96:99], v128, s[32:35], s52 offen nt
    v_and_b32_dpp v28, v137, v16 row_newbcast:10 row_mask:0xf bank_mask:0xf
    v_and_b32_dpp v29, v137, v17 row_newbcast:10 row_mask:0xf bank_mask:0xf
    v_and_b32_dpp v30, v137, v18 row_newbcast:10 row_mask:0xf bank_mask:0xf
    v_and_b32_dpp v31, v137, v19 row_newbcast:10 row_mask:0xf bank_mask:0xf
    v_mfma_f32_16x16x32_bf16 v[36:39], v[32:35], v[100:103], v[36:39]
    s_waitcnt vmcnt(7)
    s_cbranch_vccnz L_t274
    s_waitcnt vmcnt(5)
L_t274:
    buffer_load_dwordx4 v[100:103], v129, s[32:35], s52 offen nt
    v_and_b32_dpp v32, v137, v16 row_newbcast:14 row_mask:0xf bank_mask:0xf
    v_and_b32_dpp v33, v137, v17 row_newbcast:14 row_mask:0xf bank_mask:0xf
    v_and_b32_dpp v34, v137, v18 row_newbcast:14 row_mask:0xf bank_mask:0xf
    v_and_b32_dpp v35, v137, v19 row_newbcast:14 row_mask:0xf bank_mask:0xf
    v_mfma_f32_16x16x32_bf16 v[36:39], v[28:31], v[104:107], v[36:39]
    s_waitcnt vmcnt(6)
    s_cbranch_vccnz L_t275
    s_waitcnt vmcnt(5)
L_t275:
    buffer_load_dwordx4 v[104:107], v130, s[32:35], s52 offen nt
    v_and_b32_dpp v28, v137, v16 row_newbcast:3 row_mask:0xf bank_mask:0xf
    v_and_b32_dpp v29, v137, v17 row_newbcast:3 row_mask:0xf bank_mask:0xf
    v_and_b32_dpp v30, v137, v18 row_newbcast:3 row_mask:0xf bank_mask:0xf
    v_and_b32_dpp v31, v137, v19 row_newbcast:3 row_mask:0xf bank_mask:0xf
    v_mfma_f32_16x16x32_bf16 v[36:39], v[32:35], v[108:111], v[36:39]
    s_waitcnt vmcnt(6)
    s_cbranch_vccnz L_t276
    s_waitcnt vmcnt(5)
L_t276:
    buffer_load_dwordx4 v[108:111], v131, s[32:35], s52 offen nt
    buffer_load_dwordx4 a[84:87], v3, s[36:39], s58 offen offset:0
    v_and_b32_dpp v32, v137, v16 row_newbcast:7 row_mask:0xf bank_mask:0xf
    v_and_b32_dpp v33, v137, v17 row_newbcast:7 row_mask:0xf bank_mask:0xf
    v_and_b32_dpp v34, v137, v18 row_newbcast:7 row_mask:0xf bank_mask:0xf
    v_and_b32_dpp v35, v137, v19 row_newbcast:7 row_mask:0xf bank_mask:0xf
    v_mfma_f32_16x16x32_bf16 v[36:39], v[28:31], v[112:115], v[36:39]
    s_waitcnt vmcnt(7)
    s_cbranch_vccnz L_t277
    s_waitcnt vmcnt(6)
L_t277:
    buffer_load_dwordx4 v[112:115], v132, s[32:35], s52 offen nt
    v_and_b32_dpp v28, v137, v16 row_newbcast:11 row_mask:0xf bank_mask:0xf
    v_and_b32_dpp v29, v137, v17 row_newbcast:11 row_mask:0xf bank_mask:0xf
    v_and_b32_dpp v30, v137, v18 row_newbcast:11 row_mask:0xf bank_mask:0xf
    v_and_b32_dpp v31, v137, v19 row_newbcast:11 row_mask:0xf bank_mask:0xf
    v_mfma_f32_16x16x32_bf16 v[36:39], v[32:35], v[116:119], v[36:39]
    s_waitcnt vmcnt(7)
    s_cbranch_vccnz L_t278
    s_waitcnt vmcnt(5)
L_t278:
    buffer_load_dwordx4 v[116:119], v133, s[32:35], s52 offen nt
    v_and_b32_dpp v32, v137, v16 row_newbcast:15 row_mask:0xf bank_mask:0xf
    v_and_b32_dpp v33, v137, v17 row_newbcast:15 row_mask:0xf bank_mask:0xf
    v_and_b32_dpp v34, v137, v18 row_newbcast:15 row_mask:0xf bank_mask:0xf
    v_and_b32_dpp v35, v137, v19 row_newbcast:15 row_mask:0xf bank_mask:0xf
    v_mfma_f32_16x16x32_bf16 v[36:39], v[28:31], v[120:123], v[36:39]
    s_waitcnt vmcnt(6)
    s_cbranch_vccnz L_t279
    s_waitcnt vmcnt(5)
L_t279:
    buffer_load_dwordx4 v[120:123], v134, s[32:35], s52 offen nt
    v_mfma_f32_16x16x32_bf16 v[36:39], v[32:35], v[124:127], v[36:39]
    s_waitcnt vmcnt(6)
    s_cbranch_vccnz L_t280
    s_waitcnt vmcnt(5)
L_t280:
    buffer_load_dwordx4 v[124:127], v135, s[32:35], s52 offen nt
    buffer_load_dwordx4 a[92:95], v3, s[36:39], s58 offen offset:256
    s_add_u32 s51, s51, 0x20000
    s_add_u32 s52, s52, 0x20000
    buffer_load_dwordx2 v[196:197], v15, s[40:43], s99 offen offset:24 sc1
    s_cmp_gt_i32 s75, 0
    s_cselect_b64 vcc, -1, 0
    s_sub_i32 s75, s75, 1
    v_and_b32_dpp v28, v138, v16 row_newbcast:0 row_mask:0xf bank_mask:0xf
    v_and_b32_dpp v29, v138, v17 row_newbcast:0 row_mask:0xf bank_mask:0xf
    v_and_b32_dpp v30, v138, v18 row_newbcast:0 row_mask:0xf bank_mask:0xf
    v_and_b32_dpp v31, v138, v19 row_newbcast:0 row_mask:0xf bank_mask:0xf
    v_and_b32_dpp v32, v138, v16 row_newbcast:4 row_mask:0xf bank_mask:0xf
    v_and_b32_dpp v33, v138, v17 row_newbcast:4 row_mask:0xf bank_mask:0xf
    v_and_b32_dpp v34, v138, v18 row_newbcast:4 row_mask:0xf bank_mask:0xf
    v_and_b32_dpp v35, v138, v19 row_newbcast:4 row_mask:0xf bank_mask:0xf
    v_mfma_f32_16x16x32_bf16 v[36:39], v[28:31], v[64:67], v[36:39]
    s_waitcnt vmcnt(8)
    s_cbranch_vccnz L_t281
    s_waitcnt vmcnt(7)
L_t281:
    buffer_load_dwordx4 v[64:67], v128, s[32:35], s51 offen nt
    v_and_b32_dpp v28, v138, v16 row_newbcast:8 row_mask:0xf bank_mask:0xf
    v_and_b32_dpp v29, v138, v17 row_newbcast:8 row_mask:0xf bank_mask:0xf
    v_and_b32_dpp v30, v138, v18 row_newbcast:8 row_mask:0xf bank_mask:0xf
    v_and_b32_dpp v31, v138, v19 row_newbcast:8 row_mask:0xf bank_mask:0xf
    v_mfma_f32_16x16x32_bf16 v[36:39], v[32:35], v[68:71], v[36:39]
    s_waitcnt vmcnt(8)
    s_cbranch_vccnz L_t282
    s_waitcnt vmcnt(6)
L_t282:
    buffer_load_dwordx4 v[68:71], v129, s[32:35], s51 offen nt
    v_and_b32_dpp v32, v138, v16 row_newbcast:12 row_mask:0xf bank_mask:0xf
    v_and_b32_dpp v33, v138, v17 row_newbcast:12 row_mask:0xf bank_mask:0xf
    v_and_b32_dpp v34, v138, v18 row_newbcast:12 row_mask:0xf bank_mask:0xf
    v_and_b32_dpp v35, v138, v19 row_newbcast:12 row_mask:0xf bank_mask:0xf
    v_mfma_f32_16x16x32_bf16 v[36:39], v[28:31], v[72:75], v[36:39]
    s_waitcnt vmcnt(7)
    s_cbranch_vccnz L_t283
    s_waitcnt vmcnt(6)
L_t283:
    buffer_load_dwordx4 v[72:75], v130, s[32:35], s51 offen nt
    v_and_b32_dpp v28, v138, v16 row_newbcast:1 row_mask:0xf bank_mask:0xf
    v_and_b32_dpp v29, v138, v17 row_newbcast:1 row_mask:0xf bank_mask:0xf
    v_and_b32_dpp v30, v138, v18 row_newbcast:1 row_mask:0xf bank_mask:0xf
    v_and_b32_dpp v31, v138, v19 row_newbcast:1 row_mask:0xf bank_mask:0xf
    v_mfma_f32_16x16x32_bf16 v[36:39], v[32:35], v[76:79], v[36:39]
    s_waitcnt vmcnt(7)
    s_cbranch_vccnz L_t284
    s_waitcnt vmcnt(6)
L_t284:
    buffer_load_dwordx4 v[76:79], v131, s[32:35], s51 offen nt
    buffer_load_dwordx4 a[100:103], v3, s[36:39], s58 offen offset:512
    v_and_b32_dpp v32, v138, v16 row_newbcast:5 row_mask:0xf bank_mask:0xf
    v_and_b32_dpp v33, v138, v17 row_newbcast:5 row_mask:0xf bank_mask:0xf
    v_and_b32_dpp v34, v138, v18 row_newbcast:5 row_mask:0xf bank_mask:0xf
    v_and_b32_dpp v35, v138, v19 row_newbcast:5 row_mask:0xf bank_mask:0xf
    v_mfma_f32_16x16x32_bf16 v[36:39], v[28:31], v[80:83], v[36:39]
    s_waitcnt vmcnt(8)
    s_cbranch_vccnz L_t285
    s_waitcnt vmcnt(7)
L_t285:
    buffer_load_dwordx4 v[80:83], v132, s[32:35], s51 offen nt
    v_and_b32_dpp v28, v138, v16 row_newbcast:9 row_mask:0xf bank_mask:0xf
    v_and_b32_dpp v29, v138, v17 row_newbcast:9 row_mask:0xf bank_mask:0xf
    v_and_b32_dpp v30, v138, v18 row_newbcast:9 row_mask:0xf bank_mask:0xf
    v_and_b32_dpp v31, v138, v19 row_newbcast:9 row_mask:0xf bank_mask:0xf
    v_mfma_f32_16x16x32_bf16 v[36:39], v[32:35], v[84:87], v[36:39]
    s_waitcnt vmcnt(8)
    s_cbranch_vccnz L_t286
    s_waitcnt vmcnt(5)
L_t286:
    buffer_load_dwordx4 v[84:87], v133, s[32:35], s51 offen nt
    v_and_b32_dpp v32, v138, v16 row_newbcast:13 row_mask:0xf bank_mask:0xf
    v_and_b32_dpp v33, v138, v17 row_newbcast:13 row_mask:0xf bank_mask:0xf
    v_and_b32_dpp v34, v138, v18 row_newbcast:13 row_mask:0xf bank_mask:0xf
    v_and_b32_dpp v35, v138, v19 row_newbcast:13 row_mask:0xf bank_mask:0xf
    v_mfma_f32_16x16x32_bf16 v[36:39], v[28:31], v[88:91], v[36:39]
    s_waitcnt vmcnt(6)
    s_cbranch_vccnz L_t287
    s_waitcnt vmcnt(5)
L_t287:
    buffer_load_dwordx4 v[88:91], v134, s[32:35], s51 offen nt
    v_and_b32_dpp v28, v138, v16 row_newbcast:2 row_mask:0xf bank_mask:0xf
    v_and_b32_dpp v29, v138, v17 row_newbcast:2 row_mask:0xf bank_mask:0xf
    v_and_b32_dpp v30, v138, v18 row_newbcast:2 row_mask:0xf bank_mask:0xf
    v_and_b32_dpp v31, v138, v19 row_newbcast:2 row_mask:0xf bank_mask:0xf
    v_mfma_f32_16x16x32_bf16 v[36:39], v[32:35], v[92:95], v[36:39]
    s_waitcnt vmcnt(6)
    s_cbranch_vccnz L_t288
    s_waitcnt vmcnt(5)
L_t288:
    buffer_load_dwordx4 v[92:95], v135, s[32:35], s51 offen nt
    buffer_load_dwordx4 a[108:111], v3, s[36:39], s58 offen offset:768
    v_and_b32_dpp v32, v138, v16 row_newbcast:6 row_mask:0xf bank_mask:0xf
    v_and_b32_dpp v33, v138, v17 row_newbcast:6 row_mask:0xf bank_mask:0xf
    v_and_b32_dpp v34, v138, v18 row_newbcast:6 row_mask:0xf bank_mask:0xf
    v_and_b32_dpp v35, v138, v19 row_newbcast:6 row_mask:0xf bank_mask:0xf
    v_mfma_f32_16x16x32_bf16 v[36:39], v[28:31], v[96:99], v[36:39]
    s_waitcnt vmcnt(7)
    s_cbranch_vccnz L_t289
    s_waitcnt vmcnt(6)
L_t289:
    buffer_load_dwordx4 v[96:99], v128, s[32:35], s52 offen nt
    v_and_b32_dpp v28, v138, v16 row_newbcast:10 row_mask:0xf bank_mask:0xf
    v_and_b32_dpp v29, v138, v17 row_newbcast:10 row_mask:0xf bank_mask:0xf
    v_and_b32_dpp v30, v138, v18 row_newbcast:10 row_mask:0xf bank_mask:0xf
    v_and_b32_dpp v31, v138, v19 row_newbcast:10 row_mask:0xf bank_mask:0xf
    v_mfma_f32_16x16x32_bf16 v[36:39], v[32:35], v[100:103], v[36:39]
    s_waitcnt vmcnt(7)
    s_cbranch_vccnz L_t290
    s_waitcnt vmcnt(5)
L_t290:
    buffer_load_dwordx4 v[100:103], v129, s[32:35], s52 offen nt
    v_and_b32_dpp v32, v138, v16 row_newbcast:14 row_mask:0xf bank_mask:0xf
    v_and_b32_dpp v33, v138, v17 row_newbcast:14 row_mask:0xf bank_mask:0xf
    v_and_b32_dpp v34, v138, v18 row_newbcast:14 row_mask:0xf bank_mask:0xf
    v_and_b32_dpp v35, v138, v19 row_newbcast:14 row_mask:0xf bank_mask:0xf
    v_mfma_f32_16x16x32_bf16 v[36:39], v[28:31], v[104:107], v[36:39]
    s_waitcnt vmcnt(6)
    s_cbranch_vccnz L_t291
    s_waitcnt vmcnt(5)
L_t291:
    buffer_load_dwordx4 v[104:107], v130, s[32:35], s52 offen nt
    v_and_b32_dpp v28, v138, v16 row_newbcast:3 row_mask:0xf bank_mask:0xf
    v_and_b32_dpp v29, v138, v17 row_newbcast:3 row_mask:0xf bank_mask:0xf
    v_and_b32_dpp v30, v138, v18 row_newbcast:3 row_mask:0xf bank_mask:0xf
    v_and_b32_dpp v31, v138, v19 row_newbcast:3 row_mask:0xf bank_mask:0xf
    v_mfma_f32_16x16x32_bf16 v[36:39], v[32:35], v[108:111], v[36:39]
    s_waitcnt vmcnt(6)
    s_cbranch_vccnz L_t292
    s_waitcnt vmcnt(5)
L_t292:
    buffer_load_dwordx4 v[108:111], v131, s[32:35], s52 offen nt
    buffer_load_dwordx4 a[116:119], v3, s[36:39], s58 offen offset:1024
    s_cmp_eq_u32 s71, 1
    s_cselect_b32 s63, 0xffff7400, s73
    s_add_u32 s58, s58, s63
    v_and_b32_dpp v32, v138, v16 row_newbcast:7 row_mask:0xf bank_mask:0xf
    v_and_b32_dpp v33, v138, v17 row_newbcast:7 row_mask:0xf bank_mask:0xf
    v_and_b32_dpp v34, v138, v18 row_newbcast:7 row_mask:0xf bank_mask:0xf
    v_and_b32_dpp v35, v138, v19 row_newbcast:7 row_mask:0xf bank_mask:0xf
    v_mfma_f32_16x16x32_bf16 v[36:39], v[28:31], v[112:115], v[36:39]
    s_waitcnt vmcnt(7)
    s_cbranch_vccnz L_t293
    s_waitcnt vmcnt(6)
L_t293:
    buffer_load_dwordx4 v[112:115], v132, s[32:35], s52 offen nt
    s_mov_b32 s57, 0
L_ps1:
    v_xor_b32 v54, v196, v202
    v_xor_b32 v55, v197, v203
    v_and_b32 v54, v54, v55
    s_nop 0
    v_readfirstlane_b32 s54, v54
    s_nop 0
    s_bitcmp1_b32 s54, 0
    s_cbranch_scc1 L_pd1
    s_add_u32 s57, s57, 1
    s_cmp_ge_u32 s57, 0x4000
    s_cbranch_scc1 L_pd1
    buffer_load_dwordx2 v[196:197], v15, s[40:43], s99 offen offset:24 sc1
    s_waitcnt vmcnt(0)
    s_branch L_ps1
L_pd1:
    v_and_b32 v196, -2, v196
    v_and_b32 v197, -2, v197
    v_max_f32 v54, v226, v196
    v_sub_f32 v55, v226, v54
    v_sub_f32 v54, v196, v54
    v_mul_f32 v55, 0x3fb8aa3b, v55
    v_mul_f32 v54, 0x3fb8aa3b, v54
    v_exp_f32 v55, v55
    v_exp_f32 v54, v54
    v_mul_f32 v55, v55, v227
    v_fma_f32 v54, v54, v197, v55
    v_rcp_f32 v54, v54
    s_nop 0
    v_mul_f32 v199, v55, v54
    v_and_b32_dpp v28, v138, v16 row_newbcast:11 row_mask:0xf bank_mask:0xf
    v_and_b32_dpp v29, v138, v17 row_newbcast:11 row_mask:0xf bank_mask:0xf
    v_and_b32_dpp v30, v138, v18 row_newbcast:11 row_mask:0xf bank_mask:0xf
    v_and_b32_dpp v31, v138, v19 row_newbcast:11 row_mask:0xf bank_mask:0xf
    v_mfma_f32_16x16x32_bf16 v[36:39], v[32:35], v[116:119], v[36:39]
    s_waitcnt vmcnt(7)
    s_cbranch_vccnz L_t294
    s_waitcnt vmcnt(5)
L_t294:
    buffer_load_dwordx4 v[116:119], v133, s[32:35], s52 offen nt
    v_and_b32_dpp v32, v138, v16 row_newbcast:15 row_mask:0xf bank_mask:0xf
    v_and_b32_dpp v33, v138, v17 row_newbcast:15 row_mask:0xf bank_mask:0xf
    v_and_b32_dpp v34, v138, v18 row_newbcast:15 row_mask:0xf bank_mask:0xf
    v_and_b32_dpp v35, v138, v19 row_newbcast:15 row_mask:0xf bank_mask:0xf
    v_mfma_f32_16x16x32_bf16 v[36:39], v[28:31], v[120:123], v[36:39]
    s_waitcnt vmcnt(6)
    s_cbranch_vccnz L_t295
    s_waitcnt vmcnt(5)
L_t295:
    buffer_load_dwordx4 v[120:123], v134, s[32:35], s52 offen nt
    v_mfma_f32_16x16x32_bf16 v[36:39], v[32:35], v[124:127], v[36:39]
    s_waitcnt vmcnt(6)
    s_cbranch_vccnz L_t296
    s_waitcnt vmcnt(5)
L_t296:
    buffer_load_dwordx4 v[124:127], v135, s[32:35], s52 offen nt
    buffer_load_dwordx4 a[124:127], v3, s[36:39], s58 offen offset:0
    s_add_u32 s51, s51, 0x20000
    s_add_u32 s52, s52, 0x20000
    s_cmp_gt_i32 s75, 0
    s_cselect_b64 vcc, -1, 0
    s_sub_i32 s75, s75, 1
    v_and_b32_dpp v28, v139, v16 row_newbcast:0 row_mask:0xf bank_mask:0xf
    v_and_b32_dpp v29, v139, v17 row_newbcast:0 row_mask:0xf bank_mask:0xf
    v_and_b32_dpp v30, v139, v18 row_newbcast:0 row_mask:0xf bank_mask:0xf
    v_and_b32_dpp v31, v139, v19 row_newbcast:0 row_mask:0xf bank_mask:0xf
    v_and_b32_dpp v32, v139, v16 row_newbcast:4 row_mask:0xf bank_mask:0xf
    v_and_b32_dpp v33, v139, v17 row_newbcast:4 row_mask:0xf bank_mask:0xf
    v_and_b32_dpp v34, v139, v18 row_newbcast:4 row_mask:0xf bank_mask:0xf
    v_and_b32_dpp v35, v139, v19 row_newbcast:4 row_mask:0xf bank_mask:0xf
    v_mfma_f32_16x16x32_bf16 v[36:39], v[28:31], v[64:67], v[36:39]
    s_waitcnt vmcnt(7)
    s_cbranch_vccnz L_t297
    s_waitcnt vmcnt(6)
L_t297:
    buffer_load_dwordx4 v[64:67], v128, s[32:35], s51 offen nt
    v_and_b32_dpp v28, v139, v16 row_newbcast:8 row_mask:0xf bank_mask:0xf
    v_and_b32_dpp v29, v139, v17 row_newbcast:8 row_mask:0xf bank_mask:0xf
    v_and_b32_dpp v30, v139, v18 row_newbcast:8 row_mask:0xf bank_mask:0xf
    v_and_b32_dpp v31, v139, v19 row_newbcast:8 row_mask:0xf bank_mask:0xf
    v_mfma_f32_16x16x32_bf16 v[36:39], v[32:35], v[68:71], v[36:39]
    s_waitcnt vmcnt(7)
    s_cbranch_vccnz L_t298
    s_waitcnt vmcnt(5)
L_t298:
    buffer_load_dwordx4 v[68:71], v129, s[32:35], s51 offen nt
    v_and_b32_dpp v32, v139, v16 row_newbcast:12 row_mask:0xf bank_mask:0xf
    v_and_b32_dpp v33, v139, v17 row_newbcast:12 row_mask:0xf bank_mask:0xf
    v_and_b32_dpp v34, v139, v18 row_newbcast:12 row_mask:0xf bank_mask:0xf
    v_and_b32_dpp v35, v139, v19 row_newbcast:12 row_mask:0xf bank_mask:0xf
    v_mfma_f32_16x16x32_bf16 v[36:39], v[28:31], v[72:75], v[36:39]
    s_waitcnt vmcnt(6)
    s_cbranch_vccnz L_t299
    s_waitcnt vmcnt(5)
L_t299:
    buffer_load_dwordx4 v[72:75], v130, s[32:35], s51 offen nt
    v_and_b32_dpp v28, v139, v16 row_newbcast:1 row_mask:0xf bank_mask:0xf
    v_and_b32_dpp v29, v139, v17 row_newbcast:1 row_mask:0xf bank_mask:0xf
    v_and_b32_dpp v30, v139, v18 row_newbcast:1 row_mask:0xf bank_mask:0xf
    v_and_b32_dpp v31, v139, v19 row_newbcast:1 row_mask:0xf bank_mask:0xf
    v_mfma_f32_16x16x32_bf16 v[36:39], v[32:35], v[76:79], v[36:39]
    s_waitcnt vmcnt(6)
    s_cbranch_vccnz L_t300
    s_waitcnt vmcnt(5)
L_t300:
    buffer_load_dwordx4 v[76:79], v131, s[32:35], s51 offen nt
    buffer_load_dwordx4 a[132:135], v3, s[36:39], s58 offen offset:256
    v_and_b32_dpp v32, v139, v16 row_newbcast:5 row_mask:0xf bank_mask:0xf
    v_and_b32_dpp v33, v139, v17 row_newbcast:5 row_mask:0xf bank_mask:0xf
    v_and_b32_dpp v34, v139, v18 row_newbcast:5 row_mask:0xf bank_mask:0xf
    v_and_b32_dpp v35, v139, v19 row_newbcast:5 row_mask:0xf bank_mask:0xf
    v_mfma_f32_16x16x32_bf16 v[36:39], v[28:31], v[80:83], v[36:39]
    s_waitcnt vmcnt(7)
    s_cbranch_vccnz L_t301
    s_waitcnt vmcnt(6)
L_t301:
    buffer_load_dwordx4 v[80:83], v132, s[32:35], s51 offen nt
    v_and_b32_dpp v28, v139, v16 row_newbcast:9 row_mask:0xf bank_mask:0xf
    v_and_b32_dpp v29, v139, v17 row_newbcast:9 row_mask:0xf bank_mask:0xf
    v_and_b32_dpp v30, v139, v18 row_newbcast:9 row_mask:0xf bank_mask:0xf
    v_and_b32_dpp v31, v139, v19 row_newbcast:9 row_mask:0xf bank_mask:0xf
    v_mfma_f32_16x16x32_bf16 v[36:39], v[32:35], v[84:87], v[36:39]
    s_waitcnt vmcnt(7)
    s_cbranch_vccnz L_t302
    s_waitcnt vmcnt(5)
L_t302:
    buffer_load_dwordx4 v[84:87], v133, s[32:35], s51 offen nt
    v_and_b32_dpp v32, v139, v16 row_newbcast:13 row_mask:0xf bank_mask:0xf
    v_and_b32_dpp v33, v139, v17 row_newbcast:13 row_mask:0xf bank_mask:0xf
    v_and_b32_dpp v34, v139, v18 row_newbcast:13 row_mask:0xf bank_mask:0xf
    v_and_b32_dpp v35, v139, v19 row_newbcast:13 row_mask:0xf bank_mask:0xf
    v_mfma_f32_16x16x32_bf16 v[36:39], v[28:31], v[88:91], v[36:39]
    s_waitcnt vmcnt(6)
    s_cbranch_vccnz L_t303
    s_waitcnt vmcnt(5)
L_t303:
    buffer_load_dwordx4 v[88:91], v134, s[32:35], s51 offen nt
    v_and_b32_dpp v28, v139, v16 row_newbcast:2 row_mask:0xf bank_mask:0xf
    v_and_b32_dpp v29, v139, v17 row_newbcast:2 row_mask:0xf bank_mask:0xf
    v_and_b32_dpp v30, v139, v18 row_newbcast:2 row_mask:0xf bank_mask:0xf
    v_and_b32_dpp v31, v139, v19 row_newbcast:2 row_mask:0xf bank_mask:0xf
    v_mfma_f32_16x16x32_bf16 v[36:39], v[32:35], v[92:95], v[36:39]
    s_waitcnt vmcnt(6)
    s_cbranch_vccnz L_t304
    s_waitcnt vmcnt(5)
L_t304:
    buffer_load_dwordx4 v[92:95], v135, s[32:35], s51 offen nt
    buffer_load_dwordx4 a[140:143], v3, s[36:39], s58 offen offset:512
    v_and_b32_dpp v32, v139, v16 row_newbcast:6 row_mask:0xf bank_mask:0xf
    v_and_b32_dpp v33, v139, v17 row_newbcast:6 row_mask:0xf bank_mask:0xf
    v_and_b32_dpp v34, v139, v18 row_newbcast:6 row_mask:0xf bank_mask:0xf
    v_and_b32_dpp v35, v139, v19 row_newbcast:6 row_mask:0xf bank_mask:0xf
    v_mfma_f32_16x16x32_bf16 v[36:39], v[28:31], v[96:99], v[36:39]
    s_waitcnt vmcnt(7)
    s_cbranch_vccnz L_t305
    s_waitcnt vmcnt(6)
L_t305:
    buffer_load_dwordx4 v[96:99], v128, s[32:35], s52 offen nt
    v_and_b32_dpp v28, v139, v16 row_newbcast:10 row_mask:0xf bank_mask:0xf
    v_and_b32_dpp v29, v139, v17 row_newbcast:10 row_mask:0xf bank_mask:0xf
    v_and_b32_dpp v30, v139, v18 row_newbcast:10 row_mask:0xf bank_mask:0xf
    v_and_b32_dpp v31, v139, v19 row_newbcast:10 row_mask:0xf bank_mask:0xf
    v_mfma_f32_16x16x32_bf16 v[36:39], v[32:35], v[100:103], v[36:39]
    s_waitcnt vmcnt(7)
    s_cbranch_vccnz L_t306
    s_waitcnt vmcnt(5)
L_t306:
    buffer_load_dwordx4 v[100:103], v129, s[32:35], s52 offen nt
    v_and_b32_dpp v32, v139, v16 row_newbcast:14 row_mask:0xf bank_mask:0xf
    v_and_b32_dpp v33, v139, v17 row_newbcast:14 row_mask:0xf bank_mask:0xf
    v_and_b32_dpp v34, v139, v18 row_newbcast:14 row_mask:0xf bank_mask:0xf
    v_and_b32_dpp v35, v139, v19 row_newbcast:14 row_mask:0xf bank_mask:0xf
    v_mfma_f32_16x16x32_bf16 v[36:39], v[28:31], v[104:107], v[36:39]
    s_waitcnt vmcnt(6)
    s_cbranch_vccnz L_t307
    s_waitcnt vmcnt(5)
L_t307:
    buffer_load_dwordx4 v[104:107], v130, s[32:35], s52 offen nt
    v_and_b32_dpp v28, v139, v16 row_newbcast:3 row_mask:0xf bank_mask:0xf
    v_and_b32_dpp v29, v139, v17 row_newbcast:3 row_mask:0xf bank_mask:0xf
    v_and_b32_dpp v30, v139, v18 row_newbcast:3 row_mask:0xf bank_mask:0xf
    v_and_b32_dpp v31, v139, v19 row_newbcast:3 row_mask:0xf bank_mask:0xf
    v_mfma_f32_16x16x32_bf16 v[36:39], v[32:35], v[108:111], v[36:39]
    s_waitcnt vmcnt(6)
    s_cbranch_vccnz L_t308
    s_waitcnt vmcnt(5)
L_t308:
    buffer_load_dwordx4 v[108:111], v131, s[32:35], s52 offen nt
    buffer_load_dwordx4 a[148:151], v3, s[36:39], s58 offen offset:768
    v_and_b32_dpp v32, v139, v16 row_newbcast:7 row_mask:0xf bank_mask:0xf
    v_and_b32_dpp v33, v139, v17 row_newbcast:7 row_mask:0xf bank_mask:0xf
    v_and_b32_dpp v34, v139, v18 row_newbcast:7 row_mask:0xf bank_mask:0xf
    v_and_b32_dpp v35, v139, v19 row_newbcast:7 row_mask:0xf bank_mask:0xf
    v_mfma_f32_16x16x32_bf16 v[36:39], v[28:31], v[112:115], v[36:39]
    s_waitcnt vmcnt(7)
    s_cbranch_vccnz L_t309
    s_waitcnt vmcnt(6)
L_t309:
    buffer_load_dwordx4 v[112:115], v132, s[32:35], s52 offen nt
    v_and_b32_dpp v28, v139, v16 row_newbcast:11 row_mask:0xf bank_mask:0xf
    v_and_b32_dpp v29, v139, v17 row_newbcast:11 row_mask:0xf bank_mask:0xf
    v_and_b32_dpp v30, v139, v18 row_newbcast:11 row_mask:0xf bank_mask:0xf
    v_and_b32_dpp v31, v139, v19 row_newbcast:11 row_mask:0xf bank_mask:0xf
    v_mfma_f32_16x16x32_bf16 v[36:39], v[32:35], v[116:119], v[36:39]
    s_waitcnt vmcnt(7)
    s_cbranch_vccnz L_t310
    s_waitcnt vmcnt(5)
L_t310:
    buffer_load_dwordx4 v[116:119], v133, s[32:35], s52 offen nt
    v_and_b32_dpp v32, v139, v16 row_newbcast:15 row_mask:0xf bank_mask:0xf
    v_and_b32_dpp v33, v139, v17 row_newbcast:15 row_mask:0xf bank_mask:0xf
    v_and_b32_dpp v34, v139, v18 row_newbcast:15 row_mask:0xf bank_mask:0xf
    v_and_b32_dpp v35, v139, v19 row_newbcast:15 row_mask:0xf bank_mask:0xf
    v_mfma_f32_16x16x32_bf16 v[36:39], v[28:31], v[120:123], v[36:39]
    s_waitcnt vmcnt(6)
    s_cbranch_vccnz L_t311
    s_waitcnt vmcnt(5)
L_t311:
    buffer_load_dwordx4 v[120:123], v134, s[32:35], s52 offen nt
    v_mfma_f32_16x16x32_bf16 v[36:39], v[32:35], v[124:127], v[36:39]
    s_waitcnt vmcnt(6)
    s_cbranch_vccnz L_t312
    s_waitcnt vmcnt(5)
L_t312:
    buffer_load_dwordx4 v[124:127], v135, s[32:35], s52 offen nt
    buffer_load_dwordx4 a[156:159], v3, s[36:39], s58 offen offset:1024
    s_add_u32 s51, s51, 0x20000
    s_add_u32 s52, s52, 0x20000
    s_cmp_gt_i32 s75, 0
    s_cselect_b64 vcc, -1, 0
    s_sub_i32 s75, s75, 1
    v_and_b32_dpp v28, v140, v16 row_newbcast:0 row_mask:0xf bank_mask:0xf
    v_and_b32_dpp v29, v140, v17 row_newbcast:0 row_mask:0xf bank_mask:0xf
    v_and_b32_dpp v30, v140, v18 row_newbcast:0 row_mask:0xf bank_mask:0xf
    v_and_b32_dpp v31, v140, v19 row_newbcast:0 row_mask:0xf bank_mask:0xf
    v_and_b32_dpp v32, v140, v16 row_newbcast:4 row_mask:0xf bank_mask:0xf
    v_and_b32_dpp v33, v140, v17 row_newbcast:4 row_mask:0xf bank_mask:0xf
    v_and_b32_dpp v34, v140, v18 row_newbcast:4 row_mask:0xf bank_mask:0xf
    v_and_b32_dpp v35, v140, v19 row_newbcast:4 row_mask:0xf bank_mask:0xf
    v_mfma_f32_16x16x32_bf16 v[36:39], v[28:31], v[64:67], v[36:39]
    s_waitcnt vmcnt(7)
    s_cbranch_vccnz L_t313
    s_waitcnt vmcnt(6)
L_t313:
    buffer_load_dwordx4 v[64:67], v128, s[32:35], s51 offen nt
    v_and_b32_dpp v28, v140, v16 row_newbcast:8 row_mask:0xf bank_mask:0xf
    v_and_b32_dpp v29, v140, v17 row_newbcast:8 row_mask:0xf bank_mask:0xf
    v_and_b32_dpp v30, v140, v18 row_newbcast:8 row_mask:0xf bank_mask:0xf
    v_and_b32_dpp v31, v140, v19 row_newbcast:8 row_mask:0xf bank_mask:0xf
    v_mfma_f32_16x16x32_bf16 v[36:39], v[32:35], v[68:71], v[36:39]
    s_waitcnt vmcnt(7)
    s_cbranch_vccnz L_t314
    s_waitcnt vmcnt(5)
L_t314:
    buffer_load_dwordx4 v[68:71], v129, s[32:35], s51 offen nt
    v_and_b32_dpp v32, v140, v16 row_newbcast:12 row_mask:0xf bank_mask:0xf
    v_and_b32_dpp v33, v140, v17 row_newbcast:12 row_mask:0xf bank_mask:0xf
    v_and_b32_dpp v34, v140, v18 row_newbcast:12 row_mask:0xf bank_mask:0xf
    v_and_b32_dpp v35, v140, v19 row_newbcast:12 row_mask:0xf bank_mask:0xf
    v_mfma_f32_16x16x32_bf16 v[36:39], v[28:31], v[72:75], v[36:39]
    s_waitcnt vmcnt(6)
    s_cbranch_vccnz L_t315
    s_waitcnt vmcnt(5)
L_t315:
    buffer_load_dwordx4 v[72:75], v130, s[32:35], s51 offen nt
    v_and_b32_dpp v28, v140, v16 row_newbcast:1 row_mask:0xf bank_mask:0xf
    v_and_b32_dpp v29, v140, v17 row_newbcast:1 row_mask:0xf bank_mask:0xf
    v_and_b32_dpp v30, v140, v18 row_newbcast:1 row_mask:0xf bank_mask:0xf
    v_and_b32_dpp v31, v140, v19 row_newbcast:1 row_mask:0xf bank_mask:0xf
    v_mfma_f32_16x16x32_bf16 v[36:39], v[32:35], v[76:79], v[36:39]
    s_waitcnt vmcnt(6)
    s_cbranch_vccnz L_t316
    s_waitcnt vmcnt(5)
L_t316:
    buffer_load_dwordx4 v[76:79], v131, s[32:35], s51 offen nt
    v_and_b32_dpp v32, v140, v16 row_newbcast:5 row_mask:0xf bank_mask:0xf
    v_and_b32_dpp v33, v140, v17 row_newbcast:5 row_mask:0xf bank_mask:0xf
    v_and_b32_dpp v34, v140, v18 row_newbcast:5 row_mask:0xf bank_mask:0xf
    v_and_b32_dpp v35, v140, v19 row_newbcast:5 row_mask:0xf bank_mask:0xf
    v_mfma_f32_16x16x32_bf16 v[36:39], v[28:31], v[80:83], v[36:39]
    s_waitcnt vmcnt(6)
    s_cbranch_vccnz L_t317
    s_waitcnt vmcnt(5)
L_t317:
    buffer_load_dwordx4 v[80:83], v132, s[32:35], s51 offen nt
    v_and_b32_dpp v28, v140, v16 row_newbcast:9 row_mask:0xf bank_mask:0xf
    v_and_b32_dpp v29, v140, v17 row_newbcast:9 row_mask:0xf bank_mask:0xf
    v_and_b32_dpp v30, v140, v18 row_newbcast:9 row_mask:0xf bank_mask:0xf
    v_and_b32_dpp v31, v140, v19 row_newbcast:9 row_mask:0xf bank_mask:0xf
    v_mfma_f32_16x16x32_bf16 v[36:39], v[32:35], v[84:87], v[36:39]
    s_waitcnt vmcnt(6)
    s_cbranch_vccnz L_t318
    s_waitcnt vmcnt(4)
L_t318:
    buffer_load_dwordx4 v[84:87], v133, s[32:35], s51 offen nt
    v_and_b32_dpp v32, v140, v16 row_newbcast:13 row_mask:0xf bank_mask:0xf
    v_and_b32_dpp v33, v140, v17 row_newbcast:13 row_mask:0xf bank_mask:0xf
    v_and_b32_dpp v34, v140, v18 row_newbcast:13 row_mask:0xf bank_mask:0xf
    v_and_b32_dpp v35, v140, v19 row_newbcast:13 row_mask:0xf bank_mask:0xf
    v_mfma_f32_16x16x32_bf16 v[36:39], v[28:31], v[88:91], v[36:39]
    s_waitcnt vmcnt(5)
    s_cbranch_vccnz L_t319
    s_waitcnt vmcnt(4)
L_t319:
    buffer_load_dwordx4 v[88:91], v134, s[32:35], s51 offen nt
    v_and_b32_dpp v28, v140, v16 row_newbcast:2 row_mask:0xf bank_mask:0xf
    v_and_b32_dpp v29, v140, v17 row_newbcast:2 row_mask:0xf bank_mask:0xf
    v_and_b32_dpp v30, v140, v18 row_newbcast:2 row_mask:0xf bank_mask:0xf
    v_and_b32_dpp v31, v140, v19 row_newbcast:2 row_mask:0xf bank_mask:0xf
    v_mfma_f32_16x16x32_bf16 v[36:39], v[32:35], v[92:95], v[36:39]
    s_waitcnt vmcnt(5)
    s_cbranch_vccnz L_t320
    s_waitcnt vmcnt(4)
L_t320:
    buffer_load_dwordx4 v[92:95], v135, s[32:35], s51 offen nt
    v_and_b32_dpp v32, v140, v16 row_newbcast:6 row_mask:0xf bank_mask:0xf
    v_and_b32_dpp v33, v140, v17 row_newbcast:6 row_mask:0xf bank_mask:0xf
    v_and_b32_dpp v34, v140, v18 row_newbcast:6 row_mask:0xf bank_mask:0xf
    v_and_b32_dpp v35, v140, v19 row_newbcast:6 row_mask:0xf bank_mask:0xf
    v_mfma_f32_16x16x32_bf16 v[36:39], v[28:31], v[96:99], v[36:39]
    s_waitcnt vmcnt(5)
    s_cbranch_vccnz L_t321
    s_waitcnt vmcnt(4)
L_t321:
    buffer_load_dwordx4 v[96:99], v128, s[32:35], s52 offen nt
    v_and_b32_dpp v28, v140, v16 row_newbcast:10 row_mask:0xf bank_mask:0xf
    v_and_b32_dpp v29, v140, v17 row_newbcast:10 row_mask:0xf bank_mask:0xf
    v_and_b32_dpp v30, v140, v18 row_newbcast:10 row_mask:0xf bank_mask:0xf
    v_and_b32_dpp v31, v140, v19 row_newbcast:10 row_mask:0xf bank_mask:0xf
    v_mfma_f32_16x16x32_bf16 v[36:39], v[32:35], v[100:103], v[36:39]
    s_waitcnt vmcnt(5)
    s_cbranch_vccnz L_t322
    s_waitcnt vmcnt(4)
L_t322:
    buffer_load_dwordx4 v[100:103], v129, s[32:35], s52 offen nt
    v_and_b32_dpp v32, v140, v16 row_newbcast:14 row_mask:0xf bank_mask:0xf
    v_and_b32_dpp v33, v140, v17 row_newbcast:14 row_mask:0xf bank_mask:0xf
    v_and_b32_dpp v34, v140, v18 row_newbcast:14 row_mask:0xf bank_mask:0xf
    v_and_b32_dpp v35, v140, v19 row_newbcast:14 row_mask:0xf bank_mask:0xf
    v_mfma_f32_16x16x32_bf16 v[36:39], v[28:31], v[104:107], v[36:39]
    s_waitcnt vmcnt(5)
    s_cbranch_vccnz L_t323
    s_waitcnt vmcnt(4)
L_t323:
    buffer_load_dwordx4 v[104:107], v130, s[32:35], s52 offen nt
    v_and_b32_dpp v28, v140, v16 row_newbcast:3 row_mask:0xf bank_mask:0xf
    v_and_b32_dpp v29, v140, v17 row_newbcast:3 row_mask:0xf bank_mask:0xf
    v_and_b32_dpp v30, v140, v18 row_newbcast:3 row_mask:0xf bank_mask:0xf
    v_and_b32_dpp v31, v140, v19 row_newbcast:3 row_mask:0xf bank_mask:0xf
    v_mfma_f32_16x16x32_bf16 v[36:39], v[32:35], v[108:111], v[36:39]
    s_waitcnt vmcnt(5)
    s_cbranch_vccnz L_t324
    s_waitcnt vmcnt(4)
L_t324:
    buffer_load_dwordx4 v[108:111], v131, s[32:35], s52 offen nt
    v_and_b32_dpp v32, v140, v16 row_newbcast:7 row_mask:0xf bank_mask:0xf
    v_and_b32_dpp v33, v140, v17 row_newbcast:7 row_mask:0xf bank_mask:0xf
    v_and_b32_dpp v34, v140, v18 row_newbcast:7 row_mask:0xf bank_mask:0xf
    v_and_b32_dpp v35, v140, v19 row_newbcast:7 row_mask:0xf bank_mask:0xf
    v_mfma_f32_16x16x32_bf16 v[36:39], v[28:31], v[112:115], v[36:39]
    s_waitcnt vmcnt(5)
    s_cbranch_vccnz L_t325
    s_waitcnt vmcnt(4)
L_t325:
    buffer_load_dwordx4 v[112:115], v132, s[32:35], s52 offen nt
    v_and_b32_dpp v28, v140, v16 row_newbcast:11 row_mask:0xf bank_mask:0xf
    v_and_b32_dpp v29, v140, v17 row_newbcast:11 row_mask:0xf bank_mask:0xf
    v_and_b32_dpp v30, v140, v18 row_newbcast:11 row_mask:0xf bank_mask:0xf
    v_and_b32_dpp v31, v140, v19 row_newbcast:11 row_mask:0xf bank_mask:0xf
    v_mfma_f32_16x16x32_bf16 v[36:39], v[32:35], v[116:119], v[36:39]
    s_waitcnt vmcnt(5)
    s_cbranch_vccnz L_t326
    s_waitcnt vmcnt(4)
L_t326:
    buffer_load_dwordx4 v[116:119], v133, s[32:35], s52 offen nt
    v_and_b32_dpp v32, v140, v16 row_newbcast:15 row_mask:0xf bank_mask:0xf
    v_and_b32_dpp v33, v140, v17 row_newbcast:15 row_mask:0xf bank_mask:0xf
    v_and_b32_dpp v34, v140, v18 row_newbcast:15 row_mask:0xf bank_mask:0xf
    v_and_b32_dpp v35, v140, v19 row_newbcast:15 row_mask:0xf bank_mask:0xf
    v_mfma_f32_16x16x32_bf16 v[36:39], v[28:31], v[120:123], v[36:39]
    s_waitcnt vmcnt(5)
    s_cbranch_vccnz L_t327
    s_waitcnt vmcnt(4)
L_t327:
    buffer_load_dwordx4 v[120:123], v134, s[32:35], s52 offen nt
    v_mfma_f32_16x16x32_bf16 v[36:39], v[32:35], v[124:127], v[36:39]
    s_waitcnt vmcnt(5)
    s_cbranch_vccnz L_t328
    s_waitcnt vmcnt(4)
L_t328:
    buffer_load_dwordx4 v[124:127], v135, s[32:35], s52 offen nt
    s_add_u32 s51, s51, 0x20000
    s_add_u32 s52, s52, 0x20000
    s_cmp_gt_i32 s75, 0
    s_cselect_b64 vcc, -1, 0
    s_sub_i32 s75, s75, 1
    v_and_b32_dpp v28, v141, v16 row_newbcast:0 row_mask:0xf bank_mask:0xf
    v_and_b32_dpp v29, v141, v17 row_newbcast:0 row_mask:0xf bank_mask:0xf
    v_and_b32_dpp v30, v141, v18 row_newbcast:0 row_mask:0xf bank_mask:0xf
    v_and_b32_dpp v31, v141, v19 row_newbcast:0 row_mask:0xf bank_mask:0xf
    v_and_b32_dpp v32, v141, v16 row_newbcast:4 row_mask:0xf bank_mask:0xf
    v_and_b32_dpp v33, v141, v17 row_newbcast:4 row_mask:0xf bank_mask:0xf
    v_and_b32_dpp v34, v141, v18 row_newbcast:4 row_mask:0xf bank_mask:0xf
    v_and_b32_dpp v35, v141, v19 row_newbcast:4 row_mask:0xf bank_mask:0xf
    v_mfma_f32_16x16x32_bf16 v[36:39], v[28:31], v[64:67], v[36:39]
    s_waitcnt vmcnt(5)
    s_cbranch_vccnz L_t329
    s_waitcnt vmcnt(4)
L_t329:
    buffer_load_dwordx4 v[64:67], v128, s[32:35], s51 offen nt
    v_and_b32_dpp v28, v141, v16 row_newbcast:8 row_mask:0xf bank_mask:0xf
    v_and_b32_dpp v29, v141, v17 row_newbcast:8 row_mask:0xf bank_mask:0xf
    v_and_b32_dpp v30, v141, v18 row_newbcast:8 row_mask:0xf bank_mask:0xf
    v_and_b32_dpp v31, v141, v19 row_newbcast:8 row_mask:0xf bank_mask:0xf
    v_mfma_f32_16x16x32_bf16 v[36:39], v[32:35], v[68:71], v[36:39]
    s_waitcnt vmcnt(5)
    s_cbranch_vccnz L_t330
    s_waitcnt vmcnt(4)
L_t330:
    buffer_load_dwordx4 v[68:71], v129, s[32:35], s51 offen nt
    v_and_b32_dpp v32, v141, v16 row_newbcast:12 row_mask:0xf bank_mask:0xf
    v_and_b32_dpp v33, v141, v17 row_newbcast:12 row_mask:0xf bank_mask:0xf
    v_and_b32_dpp v34, v141, v18 row_newbcast:12 row_mask:0xf bank_mask:0xf
    v_and_b32_dpp v35, v141, v19 row_newbcast:12 row_mask:0xf bank_mask:0xf
    v_mfma_f32_16x16x32_bf16 v[36:39], v[28:31], v[72:75], v[36:39]
    s_waitcnt vmcnt(5)
    s_cbranch_vccnz L_t331
    s_waitcnt vmcnt(4)
L_t331:
    buffer_load_dwordx4 v[72:75], v130, s[32:35], s51 offen nt
    v_and_b32_dpp v28, v141, v16 row_newbcast:1 row_mask:0xf bank_mask:0xf
    v_and_b32_dpp v29, v141, v17 row_newbcast:1 row_mask:0xf bank_mask:0xf
    v_and_b32_dpp v30, v141, v18 row_newbcast:1 row_mask:0xf bank_mask:0xf
    v_and_b32_dpp v31, v141, v19 row_newbcast:1 row_mask:0xf bank_mask:0xf
    v_mfma_f32_16x16x32_bf16 v[36:39], v[32:35], v[76:79], v[36:39]
    s_waitcnt vmcnt(5)
    s_cbranch_vccnz L_t332
    s_waitcnt vmcnt(4)
L_t332:
    buffer_load_dwordx4 v[76:79], v131, s[32:35], s51 offen nt
    v_and_b32_dpp v32, v141, v16 row_newbcast:5 row_mask:0xf bank_mask:0xf
    v_and_b32_dpp v33, v141, v17 row_newbcast:5 row_mask:0xf bank_mask:0xf
    v_and_b32_dpp v34, v141, v18 row_newbcast:5 row_mask:0xf bank_mask:0xf
    v_and_b32_dpp v35, v141, v19 row_newbcast:5 row_mask:0xf bank_mask:0xf
    v_mfma_f32_16x16x32_bf16 v[36:39], v[28:31], v[80:83], v[36:39]
    s_waitcnt vmcnt(5)
    s_cbranch_vccnz L_t333
    s_waitcnt vmcnt(4)
L_t333:
    buffer_load_dwordx4 v[80:83], v132, s[32:35], s51 offen nt
    v_and_b32_dpp v28, v141, v16 row_newbcast:9 row_mask:0xf bank_mask:0xf
    v_and_b32_dpp v29, v141, v17 row_newbcast:9 row_mask:0xf bank_mask:0xf
    v_and_b32_dpp v30, v141, v18 row_newbcast:9 row_mask:0xf bank_mask:0xf
    v_and_b32_dpp v31, v141, v19 row_newbcast:9 row_mask:0xf bank_mask:0xf
    v_mfma_f32_16x16x32_bf16 v[36:39], v[32:35], v[84:87], v[36:39]
    s_waitcnt vmcnt(5)
    s_cbranch_vccnz L_t334
    s_waitcnt vmcnt(4)
L_t334:
    buffer_load_dwordx4 v[84:87], v133, s[32:35], s51 offen nt
    v_and_b32_dpp v32, v141, v16 row_newbcast:13 row_mask:0xf bank_mask:0xf
    v_and_b32_dpp v33, v141, v17 row_newbcast:13 row_mask:0xf bank_mask:0xf
    v_and_b32_dpp v34, v141, v18 row_newbcast:13 row_mask:0xf bank_mask:0xf
    v_and_b32_dpp v35, v141, v19 row_newbcast:13 row_mask:0xf bank_mask:0xf
    v_mfma_f32_16x16x32_bf16 v[36:39], v[28:31], v[88:91], v[36:39]
    s_waitcnt vmcnt(5)
    s_cbranch_vccnz L_t335
    s_waitcnt vmcnt(4)
L_t335:
    buffer_load_dwordx4 v[88:91], v134, s[32:35], s51 offen nt
    v_and_b32_dpp v28, v141, v16 row_newbcast:2 row_mask:0xf bank_mask:0xf
    v_and_b32_dpp v29, v141, v17 row_newbcast:2 row_mask:0xf bank_mask:0xf
    v_and_b32_dpp v30, v141, v18 row_newbcast:2 row_mask:0xf bank_mask:0xf
    v_and_b32_dpp v31, v141, v19 row_newbcast:2 row_mask:0xf bank_mask:0xf
    v_mfma_f32_16x16x32_bf16 v[36:39], v[32:35], v[92:95], v[36:39]
    s_waitcnt vmcnt(5)
    s_cbranch_vccnz L_t336
    s_waitcnt vmcnt(4)
L_t336:
    buffer_load_dwordx4 v[92:95], v135, s[32:35], s51 offen nt
    v_and_b32_dpp v32, v141, v16 row_newbcast:6 row_mask:0xf bank_mask:0xf
    v_and_b32_dpp v33, v141, v17 row_newbcast:6 row_mask:0xf bank_mask:0xf
    v_and_b32_dpp v34, v141, v18 row_newbcast:6 row_mask:0xf bank_mask:0xf
    v_and_b32_dpp v35, v141, v19 row_newbcast:6 row_mask:0xf bank_mask:0xf
    v_mfma_f32_16x16x32_bf16 v[36:39], v[28:31], v[96:99], v[36:39]
    s_waitcnt vmcnt(5)
    s_cbranch_vccnz L_t337
    s_waitcnt vmcnt(4)
L_t337:
    buffer_load_dwordx4 v[96:99], v128, s[32:35], s52 offen nt
    v_and_b32_dpp v28, v141, v16 row_newbcast:10 row_mask:0xf bank_mask:0xf
    v_and_b32_dpp v29, v141, v17 row_newbcast:10 row_mask:0xf bank_mask:0xf
    v_and_b32_dpp v30, v141, v18 row_newbcast:10 row_mask:0xf bank_mask:0xf
    v_and_b32_dpp v31, v141, v19 row_newbcast:10 row_mask:0xf bank_mask:0xf
    v_mfma_f32_16x16x32_bf16 v[36:39], v[32:35], v[100:103], v[36:39]
    s_waitcnt vmcnt(5)
    s_cbranch_vccnz L_t338
    s_waitcnt vmcnt(4)
L_t338:
    buffer_load_dwordx4 v[100:103], v129, s[32:35], s52 offen nt
    v_and_b32_dpp v32, v141, v16 row_newbcast:14 row_mask:0xf bank_mask:0xf
    v_and_b32_dpp v33, v141, v17 row_newbcast:14 row_mask:0xf bank_mask:0xf
    v_and_b32_dpp v34, v141, v18 row_newbcast:14 row_mask:0xf bank_mask:0xf
    v_and_b32_dpp v35, v141, v19 row_newbcast:14 row_mask:0xf bank_mask:0xf
    v_mfma_f32_16x16x32_bf16 v[36:39], v[28:31], v[104:107], v[36:39]
    s_waitcnt vmcnt(5)
    s_cbranch_vccnz L_t339
    s_waitcnt vmcnt(4)
L_t339:
    buffer_load_dwordx4 v[104:107], v130, s[32:35], s52 offen nt
    v_and_b32_dpp v28, v141, v16 row_newbcast:3 row_mask:0xf bank_mask:0xf
    v_and_b32_dpp v29, v141, v17 row_newbcast:3 row_mask:0xf bank_mask:0xf
    v_and_b32_dpp v30, v141, v18 row_newbcast:3 row_mask:0xf bank_mask:0xf
    v_and_b32_dpp v31, v141, v19 row_newbcast:3 row_mask:0xf bank_mask:0xf
    v_mfma_f32_16x16x32_bf16 v[36:39], v[32:35], v[108:111], v[36:39]
    s_waitcnt vmcnt(5)
    s_cbranch_vccnz L_t340
    s_waitcnt vmcnt(4)
L_t340:
    buffer_load_dwordx4 v[108:111], v131, s[32:35], s52 offen nt
    v_and_b32_dpp v32, v141, v16 row_newbcast:7 row_mask:0xf bank_mask:0xf
    v_and_b32_dpp v33, v141, v17 row_newbcast:7 row_mask:0xf bank_mask:0xf
    v_and_b32_dpp v34, v141, v18 row_newbcast:7 row_mask:0xf bank_mask:0xf
    v_and_b32_dpp v35, v141, v19 row_newbcast:7 row_mask:0xf bank_mask:0xf
    v_mfma_f32_16x16x32_bf16 v[36:39], v[28:31], v[112:115], v[36:39]
    s_waitcnt vmcnt(5)
    s_cbranch_vccnz L_t341
    s_waitcnt vmcnt(4)
L_t341:
    buffer_load_dwordx4 v[112:115], v132, s[32:35], s52 offen nt
    v_and_b32_dpp v28, v141, v16 row_newbcast:11 row_mask:0xf bank_mask:0xf
    v_and_b32_dpp v29, v141, v17 row_newbcast:11 row_mask:0xf bank_mask:0xf
    v_and_b32_dpp v30, v141, v18 row_newbcast:11 row_mask:0xf bank_mask:0xf
    v_and_b32_dpp v31, v141, v19 row_newbcast:11 row_mask:0xf bank_mask:0xf
    v_mfma_f32_16x16x32_bf16 v[36:39], v[32:35], v[116:119], v[36:39]
    s_waitcnt vmcnt(5)
    s_cbranch_vccnz L_t342
    s_waitcnt vmcnt(4)
L_t342:
    buffer_load_dwordx4 v[116:119], v133, s[32:35], s52 offen nt
    v_and_b32_dpp v32, v141, v16 row_newbcast:15 row_mask:0xf bank_mask:0xf
    v_and_b32_dpp v33, v141, v17 row_newbcast:15 row_mask:0xf bank_mask:0xf
    v_and_b32_dpp v34, v141, v18 row_newbcast:15 row_mask:0xf bank_mask:0xf
    v_and_b32_dpp v35, v141, v19 row_newbcast:15 row_mask:0xf bank_mask:0xf
    v_mfma_f32_16x16x32_bf16 v[36:39], v[28:31], v[120:123], v[36:39]
    s_waitcnt vmcnt(5)
    s_cbranch_vccnz L_t343
    s_waitcnt vmcnt(4)
L_t343:
    buffer_load_dwordx4 v[120:123], v134, s[32:35], s52 offen nt
    v_mfma_f32_16x16x32_bf16 v[36:39], v[32:35], v[124:127], v[36:39]
    s_waitcnt vmcnt(5)
    s_cbranch_vccnz L_t344
    s_waitcnt vmcnt(4)
L_t344:
    buffer_load_dwordx4 v[124:127], v135, s[32:35], s52 offen nt
    s_add_u32 s51, s51, 0x20000
    s_add_u32 s52, s52, 0x20000
    v_and_b32_dpp v28, v142, v16 row_newbcast:0 row_mask:0xf bank_mask:0xf
    v_and_b32_dpp v29, v142, v17 row_newbcast:0 row_mask:0xf bank_mask:0xf
    v_and_b32_dpp v30, v142, v18 row_newbcast:0 row_mask:0xf bank_mask:0xf
    v_and_b32_dpp v31, v142, v19 row_newbcast:0 row_mask:0xf bank_mask:0xf
    v_and_b32_dpp v32, v142, v16 row_newbcast:4 row_mask:0xf bank_mask:0xf
    v_and_b32_dpp v33, v142, v17 row_newbcast:4 row_mask:0xf bank_mask:0xf
    v_and_b32_dpp v34, v142, v18 row_newbcast:4 row_mask:0xf bank_mask:0xf
    v_and_b32_dpp v35, v142, v19 row_newbcast:4 row_mask:0xf bank_mask:0xf
    v_mfma_f32_16x16x32_bf16 v[36:39], v[28:31], v[64:67], v[36:39]
    buffer_load_dwordx4 v[64:67], v128, s[32:35], s51 offen nt
    v_and_b32_dpp v28, v142, v16 row_newbcast:8 row_mask:0xf bank_mask:0xf
    v_and_b32_dpp v29, v142, v17 row_newbcast:8 row_mask:0xf bank_mask:0xf
    v_and_b32_dpp v30, v142, v18 row_newbcast:8 row_mask:0xf bank_mask:0xf
    v_and_b32_dpp v31, v142, v19 row_newbcast:8 row_mask:0xf bank_mask:0xf
    v_mfma_f32_16x16x32_bf16 v[36:39], v[32:35], v[68:71], v[36:39]
    buffer_load_dwordx4 v[68:71], v129, s[32:35], s51 offen nt
    v_and_b32_dpp v32, v142, v16 row_newbcast:12 row_mask:0xf bank_mask:0xf
    v_and_b32_dpp v33, v142, v17 row_newbcast:12 row_mask:0xf bank_mask:0xf
    v_and_b32_dpp v34, v142, v18 row_newbcast:12 row_mask:0xf bank_mask:0xf
    v_and_b32_dpp v35, v142, v19 row_newbcast:12 row_mask:0xf bank_mask:0xf
    v_mfma_f32_16x16x32_bf16 v[36:39], v[28:31], v[72:75], v[36:39]
    s_waitcnt vmcnt(7)
    buffer_load_dwordx4 v[72:75], v130, s[32:35], s51 offen nt
    v_and_b32_dpp v28, v142, v16 row_newbcast:1 row_mask:0xf bank_mask:0xf
    v_and_b32_dpp v29, v142, v17 row_newbcast:1 row_mask:0xf bank_mask:0xf
    v_and_b32_dpp v30, v142, v18 row_newbcast:1 row_mask:0xf bank_mask:0xf
    v_and_b32_dpp v31, v142, v19 row_newbcast:1 row_mask:0xf bank_mask:0xf
    v_mfma_f32_16x16x32_bf16 v[36:39], v[32:35], v[76:79], v[36:39]
    s_waitcnt vmcnt(7)
    buffer_load_dwordx4 v[76:79], v131, s[32:35], s51 offen nt
    v_and_b32_dpp v32, v142, v16 row_newbcast:5 row_mask:0xf bank_mask:0xf
    v_and_b32_dpp v33, v142, v17 row_newbcast:5 row_mask:0xf bank_mask:0xf
    v_and_b32_dpp v34, v142, v18 row_newbcast:5 row_mask:0xf bank_mask:0xf
    v_and_b32_dpp v35, v142, v19 row_newbcast:5 row_mask:0xf bank_mask:0xf
    v_mfma_f32_16x16x32_bf16 v[36:39], v[28:31], v[80:83], v[36:39]
    s_waitcnt vmcnt(7)
    buffer_load_dwordx4 v[80:83], v132, s[32:35], s51 offen nt
    v_and_b32_dpp v28, v142, v16 row_newbcast:9 row_mask:0xf bank_mask:0xf
    v_and_b32_dpp v29, v142, v17 row_newbcast:9 row_mask:0xf bank_mask:0xf
    v_and_b32_dpp v30, v142, v18 row_newbcast:9 row_mask:0xf bank_mask:0xf
    v_and_b32_dpp v31, v142, v19 row_newbcast:9 row_mask:0xf bank_mask:0xf
    v_mfma_f32_16x16x32_bf16 v[36:39], v[32:35], v[84:87], v[36:39]
    s_waitcnt vmcnt(7)
    buffer_load_dwordx4 v[84:87], v133, s[32:35], s51 offen nt
    v_and_b32_dpp v32, v142, v16 row_newbcast:13 row_mask:0xf bank_mask:0xf
    v_and_b32_dpp v33, v142, v17 row_newbcast:13 row_mask:0xf bank_mask:0xf
    v_and_b32_dpp v34, v142, v18 row_newbcast:13 row_mask:0xf bank_mask:0xf
    v_and_b32_dpp v35, v142, v19 row_newbcast:13 row_mask:0xf bank_mask:0xf
    v_mfma_f32_16x16x32_bf16 v[36:39], v[28:31], v[88:91], v[36:39]
    s_waitcnt vmcnt(7)
    buffer_load_dwordx4 v[88:91], v134, s[32:35], s51 offen nt
    v_and_b32_dpp v28, v142, v16 row_newbcast:2 row_mask:0xf bank_mask:0xf
    v_and_b32_dpp v29, v142, v17 row_newbcast:2 row_mask:0xf bank_mask:0xf
    v_and_b32_dpp v30, v142, v18 row_newbcast:2 row_mask:0xf bank_mask:0xf
    v_and_b32_dpp v31, v142, v19 row_newbcast:2 row_mask:0xf bank_mask:0xf
    v_mfma_f32_16x16x32_bf16 v[36:39], v[32:35], v[92:95], v[36:39]
    s_waitcnt vmcnt(7)
    buffer_load_dwordx4 v[92:95], v135, s[32:35], s51 offen nt
    v_and_b32_dpp v32, v142, v16 row_newbcast:6 row_mask:0xf bank_mask:0xf
    v_and_b32_dpp v33, v142, v17 row_newbcast:6 row_mask:0xf bank_mask:0xf
    v_and_b32_dpp v34, v142, v18 row_newbcast:6 row_mask:0xf bank_mask:0xf
    v_and_b32_dpp v35, v142, v19 row_newbcast:6 row_mask:0xf bank_mask:0xf
    v_mfma_f32_16x16x32_bf16 v[36:39], v[28:31], v[96:99], v[36:39]
    s_waitcnt vmcnt(7)
    buffer_load_dwordx4 v[96:99], v128, s[32:35], s52 offen nt
    v_and_b32_dpp v28, v142, v16 row_newbcast:10 row_mask:0xf bank_mask:0xf
    v_and_b32_dpp v29, v142, v17 row_newbcast:10 row_mask:0xf bank_mask:0xf
    v_and_b32_dpp v30, v142, v18 row_newbcast:10 row_mask:0xf bank_mask:0xf
    v_and_b32_dpp v31, v142, v19 row_newbcast:10 row_mask:0xf bank_mask:0xf
    v_mfma_f32_16x16x32_bf16 v[36:39], v[32:35], v[100:103], v[36:39]
    s_waitcnt vmcnt(7)
    buffer_load_dwordx4 v[100:103], v129, s[32:35], s52 offen nt
    v_and_b32_dpp v32, v142, v16 row_newbcast:14 row_mask:0xf bank_mask:0xf
    v_and_b32_dpp v33, v142, v17 row_newbcast:14 row_mask:0xf bank_mask:0xf
    v_and_b32_dpp v34, v142, v18 row_newbcast:14 row_mask:0xf bank_mask:0xf
    v_and_b32_dpp v35, v142, v19 row_newbcast:14 row_mask:0xf bank_mask:0xf
    v_mfma_f32_16x16x32_bf16 v[36:39], v[28:31], v[104:107], v[36:39]
    s_waitcnt vmcnt(7)
    buffer_load_dwordx4 v[104:107], v130, s[32:35], s52 offen nt
    v_and_b32_dpp v28, v142, v16 row_newbcast:3 row_mask:0xf bank_mask:0xf
    v_and_b32_dpp v29, v142, v17 row_newbcast:3 row_mask:0xf bank_mask:0xf
    v_and_b32_dpp v30, v142, v18 row_newbcast:3 row_mask:0xf bank_mask:0xf
    v_and_b32_dpp v31, v142, v19 row_newbcast:3 row_mask:0xf bank_mask:0xf
    v_mfma_f32_16x16x32_bf16 v[36:39], v[32:35], v[108:111], v[36:39]
    s_waitcnt vmcnt(7)
    buffer_load_dwordx4 v[108:111], v131, s[32:35], s52 offen nt
    v_and_b32_dpp v32, v142, v16 row_newbcast:7 row_mask:0xf bank_mask:0xf
    v_and_b32_dpp v33, v142, v17 row_newbcast:7 row_mask:0xf bank_mask:0xf
    v_and_b32_dpp v34, v142, v18 row_newbcast:7 row_mask:0xf bank_mask:0xf
    v_and_b32_dpp v35, v142, v19 row_newbcast:7 row_mask:0xf bank_mask:0xf
    v_mfma_f32_16x16x32_bf16 v[36:39], v[28:31], v[112:115], v[36:39]
    s_waitcnt vmcnt(7)
    buffer_load_dwordx4 v[112:115], v132, s[32:35], s52 offen nt
    v_and_b32_dpp v28, v142, v16 row_newbcast:11 row_mask:0xf bank_mask:0xf
    v_and_b32_dpp v29, v142, v17 row_newbcast:11 row_mask:0xf bank_mask:0xf
    v_and_b32_dpp v30, v142, v18 row_newbcast:11 row_mask:0xf bank_mask:0xf
    v_and_b32_dpp v31, v142, v19 row_newbcast:11 row_mask:0xf bank_mask:0xf
    v_mfma_f32_16x16x32_bf16 v[36:39], v[32:35], v[116:119], v[36:39]
    s_waitcnt vmcnt(7)
    buffer_load_dwordx4 v[116:119], v133, s[32:35], s52 offen nt
    v_and_b32_dpp v32, v142, v16 row_newbcast:15 row_mask:0xf bank_mask:0xf
    v_and_b32_dpp v33, v142, v17 row_newbcast:15 row_mask:0xf bank_mask:0xf
    v_and_b32_dpp v34, v142, v18 row_newbcast:15 row_mask:0xf bank_mask:0xf
    v_and_b32_dpp v35, v142, v19 row_newbcast:15 row_mask:0xf bank_mask:0xf
    v_mfma_f32_16x16x32_bf16 v[36:39], v[28:31], v[120:123], v[36:39]
    s_waitcnt vmcnt(7)
    buffer_load_dwordx4 v[120:123], v134, s[32:35], s52 offen nt
    v_mfma_f32_16x16x32_bf16 v[36:39], v[32:35], v[124:127], v[36:39]
    s_waitcnt vmcnt(7)
    buffer_load_dwordx4 v[124:127], v135, s[32:35], s52 offen nt
    v_mov_b32 v176, 0
    v_mov_b32 v177, 0
    v_mov_b32 v178, 0
    v_mov_b32 v179, 0
    v_mov_b32 v180, 0
    v_mov_b32 v181, 0
    v_mov_b32 v182, 0
    v_mov_b32 v183, 0
    v_mov_b32 v184, 0
    v_mov_b32 v185, 0
    v_mov_b32 v186, 0
    v_mov_b32 v187, 0
    v_mov_b32 v188, 0
    v_mov_b32 v189, 0
    v_mov_b32 v190, 0
    v_mov_b32 v191, 0
    v_mov_b32 v192, 0
    v_mov_b32 v193, 0
    v_mov_b32 v194, 0
    v_mov_b32 v195, 0
    s_mov_b32 s55, 655360
    s_mov_b32 s57, 0
    v_lshrrev_b32 v8, 4, v0
    v_mul_u32_u24 v8, 144, v8
    v_and_b32 v9, 7, v0
    v_lshl_add_u32 v8, v9, 4, v8
    v_lshrrev_b32 v9, 4, v1
    v_lshl_add_u32 v9, s3, 1, v9
    v_lshlrev_b32 v9, 4, v9
    v_mul_u32_u24 v54, 144, v10
    v_add_u32 v9, v9, v54
    buffer_store_dwordx4 v[220:223], v5, s[40:43], 0 offen sc1
    v_and_b32_dpp v28, v143, v16 row_newbcast:0 row_mask:0xf bank_mask:0xf
    v_and_b32_dpp v29, v143, v17 row_newbcast:0 row_mask:0xf bank_mask:0xf
    v_and_b32_dpp v30, v143, v18 row_newbcast:0 row_mask:0xf bank_mask:0xf
    v_and_b32_dpp v31, v143, v19 row_newbcast:0 row_mask:0xf bank_mask:0xf
    v_and_b32_dpp v32, v143, v16 row_newbcast:4 row_mask:0xf bank_mask:0xf
    v_and_b32_dpp v33, v143, v17 row_newbcast:4 row_mask:0xf bank_mask:0xf
    v_and_b32_dpp v34, v143, v18 row_newbcast:4 row_mask:0xf bank_mask:0xf
    v_and_b32_dpp v35, v143, v19 row_newbcast:4 row_mask:0xf bank_mask:0xf
    v_mfma_f32_16x16x32_bf16 v[36:39], v[28:31], v[64:67], v[36:39]
    v_and_b32_dpp v28, v143, v16 row_newbcast:8 row_mask:0xf bank_mask:0xf
    v_and_b32_dpp v29, v143, v17 row_newbcast:8 row_mask:0xf bank_mask:0xf
    v_and_b32_dpp v30, v143, v18 row_newbcast:8 row_mask:0xf bank_mask:0xf
    v_and_b32_dpp v31, v143, v19 row_newbcast:8 row_mask:0xf bank_mask:0xf
    v_mfma_f32_16x16x32_bf16 v[36:39], v[32:35], v[68:71], v[36:39]
    v_and_b32_dpp v32, v143, v16 row_newbcast:12 row_mask:0xf bank_mask:0xf
    v_and_b32_dpp v33, v143, v17 row_newbcast:12 row_mask:0xf bank_mask:0xf
    v_and_b32_dpp v34, v143, v18 row_newbcast:12 row_mask:0xf bank_mask:0xf
    v_and_b32_dpp v35, v143, v19 row_newbcast:12 row_mask:0xf bank_mask:0xf
    v_mfma_f32_16x16x32_bf16 v[36:39], v[28:31], v[72:75], v[36:39]
    v_and_b32_dpp v28, v143, v16 row_newbcast:1 row_mask:0xf bank_mask:0xf
    v_and_b32_dpp v29, v143, v17 row_newbcast:1 row_mask:0xf bank_mask:0xf
    v_and_b32_dpp v30, v143, v18 row_newbcast:1 row_mask:0xf bank_mask:0xf
    v_and_b32_dpp v31, v143, v19 row_newbcast:1 row_mask:0xf bank_mask:0xf
    v_mfma_f32_16x16x32_bf16 v[36:39], v[32:35], v[76:79], v[36:39]
    v_and_b32_dpp v32, v143, v16 row_newbcast:5 row_mask:0xf bank_mask:0xf
    v_and_b32_dpp v33, v143, v17 row_newbcast:5 row_mask:0xf bank_mask:0xf
    v_and_b32_dpp v34, v143, v18 row_newbcast:5 row_mask:0xf bank_mask:0xf
    v_and_b32_dpp v35, v143, v19 row_newbcast:5 row_mask:0xf bank_mask:0xf
    v_mfma_f32_16x16x32_bf16 v[36:39], v[28:31], v[80:83], v[36:39]
    v_and_b32_dpp v28, v143, v16 row_newbcast:9 row_mask:0xf bank_mask:0xf
    v_and_b32_dpp v29, v143, v17 row_newbcast:9 row_mask:0xf bank_mask:0xf
    v_and_b32_dpp v30, v143, v18 row_newbcast:9 row_mask:0xf bank_mask:0xf
    v_and_b32_dpp v31, v143, v19 row_newbcast:9 row_mask:0xf bank_mask:0xf
    v_mfma_f32_16x16x32_bf16 v[36:39], v[32:35], v[84:87], v[36:39]
    v_and_b32_dpp v32, v143, v16 row_newbcast:13 row_mask:0xf bank_mask:0xf
    v_and_b32_dpp v33, v143, v17 row_newbcast:13 row_mask:0xf bank_mask:0xf
    v_and_b32_dpp v34, v143, v18 row_newbcast:13 row_mask:0xf bank_mask:0xf
    v_and_b32_dpp v35, v143, v19 row_newbcast:13 row_mask:0xf bank_mask:0xf
    v_mfma_f32_16x16x32_bf16 v[36:39], v[28:31], v[88:91], v[36:39]
    v_and_b32_dpp v28, v143, v16 row_newbcast:2 row_mask:0xf bank_mask:0xf
    v_and_b32_dpp v29, v143, v17 row_newbcast:2 row_mask:0xf bank_mask:0xf
    v_and_b32_dpp v30, v143, v18 row_newbcast:2 row_mask:0xf bank_mask:0xf
    v_and_b32_dpp v31, v143, v19 row_newbcast:2 row_mask:0xf bank_mask:0xf
    v_mfma_f32_16x16x32_bf16 v[36:39], v[32:35], v[92:95], v[36:39]
    v_and_b32_dpp v32, v143, v16 row_newbcast:6 row_mask:0xf bank_mask:0xf
    v_and_b32_dpp v33, v143, v17 row_newbcast:6 row_mask:0xf bank_mask:0xf
    v_and_b32_dpp v34, v143, v18 row_newbcast:6 row_mask:0xf bank_mask:0xf
    v_and_b32_dpp v35, v143, v19 row_newbcast:6 row_mask:0xf bank_mask:0xf
    s_waitcnt vmcnt(8)
    v_mfma_f32_16x16x32_bf16 v[36:39], v[28:31], v[96:99], v[36:39]
    v_and_b32_dpp v28, v143, v16 row_newbcast:10 row_mask:0xf bank_mask:0xf
    v_and_b32_dpp v29, v143, v17 row_newbcast:10 row_mask:0xf bank_mask:0xf
    v_and_b32_dpp v30, v143, v18 row_newbcast:10 row_mask:0xf bank_mask:0xf
    v_and_b32_dpp v31, v143, v19 row_newbcast:10 row_mask:0xf bank_mask:0xf
    s_waitcnt vmcnt(7)
    v_mfma_f32_16x16x32_bf16 v[36:39], v[32:35], v[100:103], v[36:39]
    v_and_b32_dpp v32, v143, v16 row_newbcast:14 row_mask:0xf bank_mask:0xf
    v_and_b32_dpp v33, v143, v17 row_newbcast:14 row_mask:0xf bank_mask:0xf
    v_and_b32_dpp v34, v143, v18 row_newbcast:14 row_mask:0xf bank_mask:0xf
    v_and_b32_dpp v35, v143, v19 row_newbcast:14 row_mask:0xf bank_mask:0xf
    s_waitcnt vmcnt(6)
    v_mfma_f32_16x16x32_bf16 v[36:39], v[28:31], v[104:107], v[36:39]
    v_and_b32_dpp v28, v143, v16 row_newbcast:3 row_mask:0xf bank_mask:0xf
    v_and_b32_dpp v29, v143, v17 row_newbcast:3 row_mask:0xf bank_mask:0xf
    v_and_b32_dpp v30, v143, v18 row_newbcast:3 row_mask:0xf bank_mask:0xf
    v_and_b32_dpp v31, v143, v19 row_newbcast:3 row_mask:0xf bank_mask:0xf
    s_waitcnt vmcnt(5)
    v_mfma_f32_16x16x32_bf16 v[36:39], v[32:35], v[108:111], v[36:39]
    v_and_b32_dpp v32, v143, v16 row_newbcast:7 row_mask:0xf bank_mask:0xf
    v_and_b32_dpp v33, v143, v17 row_newbcast:7 row_mask:0xf bank_mask:0xf
    v_and_b32_dpp v34, v143, v18 row_newbcast:7 row_mask:0xf bank_mask:0xf
    v_and_b32_dpp v35, v143, v19 row_newbcast:7 row_mask:0xf bank_mask:0xf
    s_waitcnt vmcnt(4)
    v_mfma_f32_16x16x32_bf16 v[36:39], v[28:31], v[112:115], v[36:39]
    v_and_b32_dpp v28, v143, v16 row_newbcast:11 row_mask:0xf bank_mask:0xf
    v_and_b32_dpp v29, v143, v17 row_newbcast:11 row_mask:0xf bank_mask:0xf
    v_and_b32_dpp v30, v143, v18 row_newbcast:11 row_mask:0xf bank_mask:0xf
    v_and_b32_dpp v31, v143, v19 row_newbcast:11 row_mask:0xf bank_mask:0xf
    s_waitcnt vmcnt(3)
    v_mfma_f32_16x16x32_bf16 v[36:39], v[32:35], v[116:119], v[36:39]
    v_and_b32_dpp v32, v143, v16 row_newbcast:15 row_mask:0xf bank_mask:0xf
    v_and_b32_dpp v33, v143, v17 row_newbcast:15 row_mask:0xf bank_mask:0xf
    v_and_b32_dpp v34, v143, v18 row_newbcast:15 row_mask:0xf bank_mask:0xf
    v_and_b32_dpp v35, v143, v19 row_newbcast:15 row_mask:0xf bank_mask:0xf
    s_waitcnt vmcnt(2)
    v_mfma_f32_16x16x32_bf16 v[36:39], v[28:31], v[120:123], v[36:39]
    s_waitcnt vmcnt(1)
    v_mfma_f32_16x16x32_bf16 v[36:39], v[32:35], v[124:127], v[36:39]
    s_mul_i32 s54, s3, 576
    v_add_u32 v62, s54, v11
    s_mov_b32 exec_hi, 0
    s_nop 4
    ds_write_b128 v62, v[36:39] offset:2048
    s_mov_b32 exec_hi, -1
    s_waitcnt lgkmcnt(0)
    s_barrier
    ds_read_b64 v[228:229], v12 offset:2048
    s_waitcnt lgkmcnt(0)
    v_add_f32_dpp v228, v228, v228 quad_perm:[1,0,3,2] row_mask:0xf bank_mask:0xf
    v_add_f32_dpp v229, v229, v229 quad_perm:[1,0,3,2] row_mask:0xf bank_mask:0xf
    s_nop 0
    v_add_f32_dpp v228, v228, v228 quad_perm:[2,3,0,1] row_mask:0xf bank_mask:0xf
    v_add_f32_dpp v229, v229, v229 quad_perm:[2,3,0,1] row_mask:0xf bank_mask:0xf
    v_mul_f32 v228, v228, v199
    v_mul_f32 v229, v229, v199
    v_cvt_pk_bf16_f32 v228, v228, v228
    v_cvt_pk_bf16_f32 v229, v229, v229
    s_nop 0
    v_and_b32_dpp v28, v228, v208 row_newbcast:0 row_mask:0xf bank_mask:0xf
    v_and_b32_dpp v29, v228, v209 row_newbcast:0 row_mask:0xf bank_mask:0xf
    v_and_b32_dpp v30, v229, v208 row_newbcast:0 row_mask:0xf bank_mask:0xf
    v_and_b32_dpp v31, v229, v209 row_newbcast:0 row_mask:0xf bank_mask:0xf
    s_nop 1
    v_smfmac_f32_16x16x64_bf16 v[176:179], v[28:31], a[0:7], v210
    v_and_b32_dpp v68, v228, v208 row_newbcast:4 row_mask:0xf bank_mask:0xf
    v_and_b32_dpp v69, v228, v209 row_newbcast:4 row_mask:0xf bank_mask:0xf
    v_and_b32_dpp v70, v229, v208 row_newbcast:4 row_mask:0xf bank_mask:0xf
    v_and_b32_dpp v71, v229, v209 row_newbcast:4 row_mask:0xf bank_mask:0xf
    v_smfmac_f32_16x16x64_bf16 v[180:183], v[28:31], a[8:15], v210
    s_nop 0
    v_smfmac_f32_16x16x64_bf16 v[176:179], v[68:71], a[40:47], v210
    v_and_b32_dpp v72, v228, v208 row_newbcast:8 row_mask:0xf bank_mask:0xf
    v_and_b32_dpp v73, v228, v209 row_newbcast:8 row_mask:0xf bank_mask:0xf
    v_and_b32_dpp v74, v229, v208 row_newbcast:8 row_mask:0xf bank_mask:0xf
    v_and_b32_dpp v75, v229, v209 row_newbcast:8 row_mask:0xf bank_mask:0xf
    v_smfmac_f32_16x16x64_bf16 v[180:183], v[68:71], a[48:55], v210
    s_nop 0
    v_smfmac_f32_16x16x64_bf16 v[176:179], v[72:75], a[80:87], v210
    v_and_b32_dpp v76, v228, v208 row_newbcast:12 row_mask:0xf bank_mask:0xf
    v_and_b32_dpp v77, v228, v209 row_newbcast:12 row_mask:0xf bank_mask:0xf
    v_and_b32_dpp v78, v229, v208 row_newbcast:12 row_mask:0xf bank_mask:0xf
    v_and_b32_dpp v79, v229, v209 row_newbcast:12 row_mask:0xf bank_mask:0xf
    v_smfmac_f32_16x16x64_bf16 v[180:183], v[72:75], a[88:95], v210
    s_nop 0
    v_smfmac_f32_16x16x64_bf16 v[176:179], v[76:79], a[120:127], v210
    v_smfmac_f32_16x16x64_bf16 v[180:183], v[76:79], a[128:135], v210
    s_mul_i32 s54, s3, 2560
    v_add_u32 v62, s54, v11
    v_smfmac_f32_16x16x64_bf16 v[184:187], v[28:31], a[16:23], v210
    v_smfmac_f32_16x16x64_bf16 v[184:187], v[68:71], a[56:63], v210
    v_smfmac_f32_16x16x64_bf16 v[184:187], v[72:75], a[96:103], v210
    v_smfmac_f32_16x16x64_bf16 v[184:187], v[76:79], a[136:143], v210
    v_smfmac_f32_16x16x64_bf16 v[188:191], v[28:31], a[24:31], v210
    v_smfmac_f32_16x16x64_bf16 v[188:191], v[68:71], a[64:71], v210
    v_smfmac_f32_16x16x64_bf16 v[188:191], v[72:75], a[104:111], v210
    v_smfmac_f32_16x16x64_bf16 v[188:191], v[76:79], a[144:151], v210
    s_mov_b32 exec_hi, 0
    ds_write_b128 v62, v[176:179] offset:4608
    s_mov_b32 exec_hi, -1
    s_mov_b32 exec_hi, 0
    ds_write_b128 v62, v[180:183] offset:5120
    s_mov_b32 exec_hi, -1
    v_smfmac_f32_16x16x64_bf16 v[192:195], v[28:31], a[32:39], v210
    v_smfmac_f32_16x16x64_bf16 v[192:195], v[68:71], a[72:79], v210
    v_smfmac_f32_16x16x64_bf16 v[192:195], v[72:75], a[112:119], v210
    v_smfmac_f32_16x16x64_bf16 v[192:195], v[76:79], a[152:159], v210
    s_mov_b32 exec_hi, 0
    ds_write_b128 v62, v[184:187] offset:5632
    s_mov_b32 exec_hi, -1
    s_mov_b32 exec_hi, 0
    ds_write_b128 v62, v[188:191] offset:6144
    s_mov_b32 exec_hi, -1
    s_mov_b32 exec_hi, 0
    s_nop 0
    ds_write_b128 v62, v[192:195] offset:6656
    s_mov_b32 exec_hi, -1
    v_lshlrev_b32 v62, 4, v0
    s_waitcnt lgkmcnt(0)
    s_barrier
    ds_read_b128 v[144:147], v62 offset:4608
    ds_read_b128 v[148:151], v62 offset:7168
    ds_read_b128 v[152:155], v62 offset:9728
    ds_read_b128 v[156:159], v62 offset:12288
    s_waitcnt lgkmcnt(2)
    v_add_f32 v144, v144, v148
    v_add_f32 v145, v145, v149
    v_add_f32 v146, v146, v150
    v_add_f32 v147, v147, v151
    s_waitcnt lgkmcnt(1)
    v_add_f32 v144, v144, v152
    v_add_f32 v145, v145, v153
    v_add_f32 v146, v146, v154
    v_add_f32 v147, v147, v155
    s_waitcnt lgkmcnt(0)
    v_add_f32 v144, v144, v156
    v_add_f32 v145, v145, v157
    v_add_f32 v146, v146, v158
    v_add_f32 v147, v147, v159
    v_bfi_b32 v160, 1, v244, v144
    v_bfi_b32 v161, 1, v245, v145
    v_bfi_b32 v162, 1, v246, v146
    v_bfi_b32 v163, 1, v247, v147
    buffer_store_dwordx4 v[160:163], v5, s[40:43], s55 offen sc1
    s_cmp_ge_u32 s49, 20
    s_cbranch_scc1 L_fin
    buffer_load_dwordx4 v[212:215], v6, s[40:43], s61 offen sc1
    buffer_load_dwordx4 v[216:219], v6, s[40:43], s62 offen sc1
    s_waitcnt vmcnt(0)
L_chk:
    v_xor_b32 v144, v212, v248
    v_xor_b32 v145, v213, v249
    v_xor_b32 v146, v214, v250
    v_xor_b32 v147, v215, v251
    v_xor_b32 v148, v216, v252
    v_xor_b32 v149, v217, v253
    v_xor_b32 v150, v218, v254
    v_xor_b32 v151, v219, v255
    v_and_b32 v144, v144, v145
    v_and_b32 v146, v146, v147
    v_and_b32 v148, v148, v149
    v_and_b32 v150, v150, v151
    v_and_b32 v144, v144, v146
    v_and_b32 v148, v148, v150
    v_and_b32 v144, v144, v148
    v_and_b32 v144, 1, v144
    v_cmp_eq_u32 vcc, 0, v144
    s_nop 0
    s_and_b64 exec, exec, vcc
    s_cbranch_execz L_got
    s_add_u32 s57, s57, 1
    s_cmp_ge_u32 s57, 0x60000
    s_cbranch_scc1 L_got
    s_bcnt1_i32_b64 s54, exec
    s_cmp_le_u32 s54, 16
    s_cbranch_scc1 L_pc
    s_cmp_le_u32 s54, 32
    s_cbranch_scc1 L_pb
    s_sleep 8
L_pb:
    s_sleep 3
L_pc:
    buffer_load_dwordx4 v[212:215], v6, s[40:43], s61 offen sc1
    buffer_load_dwordx4 v[216:219], v6, s[40:43], s62 offen sc1
    s_waitcnt vmcnt(0)
    s_branch L_chk
L_got:
    s_mov_b64 exec, -1
    v_and_b32 v212, -2, v212
    v_and_b32 v213, -2, v213
    v_and_b32 v214, -2, v214
    v_and_b32 v215, -2, v215
    v_and_b32 v216, -2, v216
    v_and_b32 v217, -2, v217
    v_and_b32 v218, -2, v218
    v_and_b32 v219, -2, v219
    v_add_f32 v212, v212, v216
    v_add_f32 v213, v213, v217
    v_add_f32 v214, v214, v218
    v_add_f32 v215, v215, v219
    v_add_f32_dpp v212, v212, v212 row_ror:8 row_mask:0xf bank_mask:0xf
    v_add_f32_dpp v213, v213, v213 row_ror:8 row_mask:0xf bank_mask:0xf
    v_add_f32_dpp v214, v214, v214 row_ror:8 row_mask:0xf bank_mask:0xf
    v_add_f32_dpp v215, v215, v215 row_ror:8 row_mask:0xf bank_mask:0xf
    s_mov_b32 exec_lo, 0x00ff00ff
    s_mov_b32 exec_hi, 0x00ff00ff
    ds_write_b128 v8, v[212:215] offset:0
    s_mov_b64 exec, -1
    s_waitcnt lgkmcnt(0)
    s_barrier
    ds_read_b128 v[212:215], v9 offset:0
    s_waitcnt lgkmcnt(0)
    v_add_f32_dpp v212, v212, v212 row_ror:8 row_mask:0xf bank_mask:0xf
    v_add_f32_dpp v213, v213, v213 row_ror:8 row_mask:0xf bank_mask:0xf
    v_add_f32_dpp v214, v214, v214 row_ror:8 row_mask:0xf bank_mask:0xf
    v_add_f32_dpp v215, v215, v215 row_ror:8 row_mask:0xf bank_mask:0xf
    v_add_f32_dpp v212, v212, v212 row_ror:4 row_mask:0xf bank_mask:0xf
    v_add_f32_dpp v213, v213, v213 row_ror:4 row_mask:0xf bank_mask:0xf
    v_add_f32_dpp v214, v214, v214 row_ror:4 row_mask:0xf bank_mask:0xf
    v_add_f32_dpp v215, v215, v215 row_ror:4 row_mask:0xf bank_mask:0xf
    v_add_f32_dpp v212, v212, v212 row_ror:2 row_mask:0xf bank_mask:0xf
    v_add_f32_dpp v213, v213, v213 row_ror:2 row_mask:0xf bank_mask:0xf
    v_add_f32_dpp v214, v214, v214 row_ror:2 row_mask:0xf bank_mask:0xf
    v_add_f32_dpp v215, v215, v215 row_ror:2 row_mask:0xf bank_mask:0xf
    v_add_f32_dpp v212, v212, v212 row_ror:1 row_mask:0xf bank_mask:0xf
    v_add_f32_dpp v213, v213, v213 row_ror:1 row_mask:0xf bank_mask:0xf
    v_add_f32_dpp v214, v214, v214 row_ror:1 row_mask:0xf bank_mask:0xf
    v_add_f32_dpp v215, v215, v215 row_ror:1 row_mask:0xf bank_mask:0xf
    v_cvt_pk_bf16_f32 v212, v212, v213
    v_cvt_pk_bf16_f32 v213, v214, v215
    s_mov_b32 exec_lo, 0x10001
    s_mov_b32 exec_hi, 0
    buffer_store_dwordx2 v[212:213], v7, s[44:47], 0 offen
L_fin:
L_end:
    s_endpgm
.section .rodata,"a"
.p2align 6
.amdhsa_kernel concat_heads__mha_block_cached__gqa_block_cached__decode_kernel
  .amdhsa_next_free_vgpr 480
  .amdhsa_next_free_sgpr 102
  .amdhsa_accum_offset 256
  .amdhsa_group_segment_fixed_size 0
  .amdhsa_kernarg_size 104
  .amdhsa_user_sgpr_count 2
  .amdhsa_user_sgpr_kernarg_segment_ptr 1
  .amdhsa_system_sgpr_workgroup_id_x 1
  .amdhsa_float_denorm_mode_32 3
.end_amdhsa_kernel
```
